```python
import torch

def _softmax(x, axis=-1):
    return torch.softmax(x, dim=axis)
def _gelu(x):
    return torch.nn.functional.gelu(x, approximate="tanh")
def _silu(x):
    return torch.nn.functional.silu(x)
def _sigmoid(x):
    return torch.sigmoid(x)
def _layernorm(x, axis=-1, eps=1e-5):
    m = x.mean(dim=axis, keepdim=True)
    v = x.var(dim=axis, keepdim=True, unbiased=False)
    return (x - m) / torch.sqrt(v + eps)
def _scatter_add(tgt, idx, src, axis=0):
    return tgt.clone().index_add_(axis, idx, src)
def _segment_sum(src, seg, n):
    out = torch.zeros((n,) + src.shape[1:], dtype=src.dtype)
    return out.index_add_(0, seg, src)
def _pad(x, pw):
    flat = tuple(v for pair in reversed(pw) for v in pair)
    return torch.nn.functional.pad(x, flat)

kernel_name = 'parallel_sum__sliding_local_dilated__mixer_channel_mlp__prompt'

def setup_inputs():

    _w = (lambda a: (lambda t: t.to(torch.bfloat16) if t.is_floating_point() else t)(torch.as_tensor(a)))
    def _A_setup():
        B, S, D = 1, 2048, 448
        return {
            "x": _w((lambda *s: torch.randn(*s, dtype=torch.bfloat16) * 0.05)(B, S, D)),
            "wqkv": _w((lambda *s: torch.randn(*s, dtype=torch.bfloat16) * 0.05)(D, 3 * D)),
            "wo": _w((lambda *s: torch.randn(*s, dtype=torch.bfloat16) * 0.05)(D, D)),
        }
    _A_in = _A_setup()

    def _B_setup():
        B, S, D, F = 1, 2048, 448, 1792
        return {
            "x": _w((lambda *s: torch.randn(*s, dtype=torch.bfloat16) * 0.05)(B, S, D)),
            "w1": _w((lambda *s: torch.randn(*s, dtype=torch.bfloat16) * 3.2)(D, F) * (D ** -0.5)),
            "b1": _w((lambda *s: torch.randn(*s, dtype=torch.bfloat16) * 1.6)(F)),
            "w2": _w((lambda *s: torch.randn(*s, dtype=torch.bfloat16) * 0.2)(F, D) * (F ** -0.5)),
            "b2": _w((lambda *s: torch.randn(*s, dtype=torch.bfloat16) * 0.2)(D)),
        }
    _B_in = _B_setup()

    return {
        "A_x": _A_in["x"],
        "A_wqkv": _A_in["wqkv"],
        "A_wo": _A_in["wo"],
        "B_x": _B_in["x"],
        "B_w1": _B_in["w1"],
        "B_b1": _B_in["b1"],
        "B_w2": _B_in["w2"],
        "B_b2": _B_in["b2"],
    }

def reference(A_x, A_wqkv, A_wo, B_x, B_w1, B_b1, B_w2, B_b2):
    def _A_ref(x, wqkv, wo):
        B, S, D = x.shape
        H = 16; Dh = D // H
        W, dil = 8, 2
        qkv = (lambda x, *d: x.permute(*d))((x @ wqkv).reshape(B, S, 3, H, Dh), 2, 0, 3, 1, 4)
        q, k, v = qkv[0], qkv[1], qkv[2]
        scale = Dh ** -0.5
        pos = torch.arange(S)
        off = torch.arange(W) * dil
        idx = pos[:, None] - off[None, :]
        mask = idx >= 0
        idx_c = torch.where(mask, idx, 0).reshape(-1)
        kg = k[:, :, idx_c, :].reshape(B, H, S, W, Dh)
        vg = v[:, :, idx_c, :].reshape(B, H, S, W, Dh)
        logits = torch.einsum("bhsd,bhswd->bhsw", q, kg) * scale
        logits = torch.where(mask[None, None, :, :], logits, -1e9)
        attn = _softmax(logits, axis=-1)
        o = torch.einsum("bhsw,bhswd->bhsd", attn, vg)
        return (lambda x, *d: x.permute(*d))(o, 0, 2, 1, 3).reshape(B, S, D) @ wo

    def _B_ref(x, w1, b1, w2, b2):
        y = _layernorm(x, axis=-1)
        h = _gelu(torch.einsum("bsd,df->bsf", y, w1) + b1)
        return torch.einsum("bsf,fd->bsd", h, w2) + b2

    x = A_x
    xn = _layernorm(x, axis=-1)
    return x + _A_ref(xn, A_wqkv, A_wo) + _B_ref(xn, B_w1, B_b1, B_w2, B_b2)
```

```asm
; @launch grid=(256,1,1) block=(256,1,1) lds=163840
.amdgcn_target "amdgcn-amd-amdhsa--gfx950"
.text
.globl parallel_sum__sliding_local_dilated__mixer_channel_mlp__prompt_kernel
.p2align 8
.type parallel_sum__sliding_local_dilated__mixer_channel_mlp__prompt_kernel,@function
parallel_sum__sliding_local_dilated__mixer_channel_mlp__prompt_kernel:
s_cmp_ge_u32 s2, 256
s_cbranch_scc1 Lend
s_load_dwordx8 s[8:15], s[0:1], 0
s_load_dwordx8 s[16:23], s[0:1], 32
s_load_dwordx4 s[24:27], s[0:1], 64
s_load_dwordx2 s[28:29], s[0:1], 80
s_getpc_b64 s[96:97]
Lpc:
s_lshr_b32 s98, s2, 3
v_lshrrev_b32 v1, 6, v0
s_mul_i32 s98, s98, 12
v_and_b32 v2, 63, v0
v_mad_u32_u24 v2, v1, 3, v2
v_add_lshl_u32 v2, v2, s98, 7
v_mov_b32 v3, 0
v_min_u32 v2, Lend-Lpc, v2
v_lshl_add_u64 v[2:3], v[2:3], 0, s[96:97]
s_mov_b64 exec, 7
global_load_dword v251, v[2:3], off
s_mov_b64 exec, -1
v_lshrrev_b32 v1, 6, v0
v_and_b32 v0, 63, v0
v_readfirstlane_b32 s3, v1
v_cmp_eq_u32 vcc, 0, v0
v_mov_b32 v2, 2147483632
s_nop 0
v_cndmask_b32 v7, v2, v0, vcc
s_and_b32 s96, s2, 7
s_lshr_b32 s97, s2, 3
s_and_b32 s98, s96, 3
s_lshr_b32 s96, s96, 2
s_lshr_b32 s99, 0x9, s98
s_and_b32 s99, s99, 1
s_xor_b32 s96, s96, s99
s_lshl_b32 s98, s98, 1
s_and_b32 s99, s97, 1
s_add_u32 s98, s98, s99
s_lshl_b32 s98, s98, 2
s_lshr_b32 s5, 0x62735140, s98
s_and_b32 s5, s5, 7
s_mul_i32 s96, s96, 16
s_lshr_b32 s97, s97, 1
s_add_u32 s4, s96, s97
s_min_u32 s6, s5, 6
s_lshl_b32 s72, s3, 12
s_lshl_b32 s89, s3, 11
s_mul_i32 s86, s4, 16384
s_lshl_b32 s96, s4, 6
s_lshl_b32 s97, s3, 4
s_add_u32 s96, s96, s97
v_lshrrev_b32 v1, 3, v0
v_and_b32 v2, 7, v0
v_lshrrev_b32 v4, 4, v0
v_add_u32 v3, s96, v1
v_xor_b32 v2, v2, v4
v_mul_u32_u24 v3, 896, v3
v_lshl_add_u32 v96, v2, 4, v3
v_xor_b32 v3, 64, v96
v_add_u32 v97, 6144, v3
s_cmp_ge_u32 s5, 4
s_cbranch_scc1 Lattn
v_lshrrev_b32 v1, 3, v0
v_mul_u32_u24 v1, 3584, v1
v_and_b32 v2, 7, v0
v_bfe_u32 v8, v0, 4, 1
v_lshlrev_b32 v8, 2, v8
v_xor_b32 v2, v2, v8
v_lshl_add_u32 v8, v2, 4, v1
v_add_u32 v9, 27648, v8
v_add_u32 v10, 55296, v8
v_add_u32 v11, 82944, v8
s_mul_i32 s96, s5, 6
s_lshr_b32 s97, s3, 1
s_add_u32 s96, s96, s97
s_lshl_b32 s96, s96, 7
s_and_b32 s97, s3, 1
s_mul_i32 s97, s97, 114688
s_add_u32 s73, s96, s97
s_and_b32 s95, s4, 15
s_lshl_b32 s95, s95, 2
s_add_u32 s95, s95, s3
s_lshl_b32 s96, s4, 6
s_lshl_b32 s97, s3, 4
s_add_u32 s96, s96, s97
v_and_or_b32 v1, v0, 15, s96
v_lshrrev_b32 v254, 4, v0
v_mul_u32_u24 v1, 7, v1
v_add_lshl_u32 v254, v254, v1, 7
v_bfe_u32 v1, v0, 1, 3
v_lshl_add_u32 v1, v1, 6, s95
v_mul_u32_u24 v1, 28, v1
v_lshrrev_b32 v2, 4, v0
v_lshlrev_b32 v2, 1, v2
v_and_or_b32 v2, v0, 1, v2
s_mul_i32 s96, s5, 6
v_add3_u32 v1, v1, v2, s96
v_lshlrev_b32 v250, 7, v1
s_waitcnt lgkmcnt(0)
s_mov_b32 s32, s8
s_mov_b32 s33, s9
s_mov_b32 s34, 1835008
s_mov_b32 s35, 0x20000
s_add_u32 m0, s89, 98304
s_nop 0
buffer_load_dwordx4 v96, s[32:35], 0 offen offset:0 lds
buffer_load_dwordx4 v97, s[32:35], 0 offen offset:1024 lds
s_mov_b32 s44, s16
s_mov_b32 s45, s17
s_mov_b32 s46, 1605632
s_mov_b32 s47, 0x20000
s_add_u32 s7, s73, 0
s_add_u32 m0, s72, 0
s_nop 0
buffer_load_dwordx4 v8, s[44:47], s7 offen offset:0 lds
buffer_load_dwordx4 v9, s[44:47], s7 offen offset:1024 lds
buffer_load_dwordx4 v10, s[44:47], s7 offen offset:2048 lds
buffer_load_dwordx4 v11, s[44:47], s7 offen offset:3072 lds
s_bfm_b64 exec, 10, 4
buffer_load_dword v248, v250, s[44:47], 0 offen
s_mov_b64 exec, -1
s_movk_i32 s7, 128
s_add_u32 m0, s89, 106496
s_nop 0
buffer_load_dwordx4 v96, s[32:35], s7 offen offset:0 lds
buffer_load_dwordx4 v97, s[32:35], s7 offen offset:1024 lds
s_add_u32 s7, s73, 229376
s_add_u32 m0, s72, 16384
s_nop 0
buffer_load_dwordx4 v8, s[44:47], s7 offen offset:0 lds
buffer_load_dwordx4 v9, s[44:47], s7 offen offset:1024 lds
buffer_load_dwordx4 v10, s[44:47], s7 offen offset:2048 lds
buffer_load_dwordx4 v11, s[44:47], s7 offen offset:3072 lds
s_mov_b32 s48, s18
s_mov_b32 s49, s19
s_mov_b32 s50, 3584
s_mov_b32 s51, 0x20000
s_mov_b32 s56, s22
s_mov_b32 s57, s23
s_mov_b32 s58, 896
s_mov_b32 s59, 0x20000
s_mov_b32 s68, s28
s_mov_b32 s69, s29
s_mov_b32 s70, 268435456
s_mov_b32 s71, 0x20000
s_mov_b32 s52, s20
s_mov_b32 s53, s21
s_mov_b32 s54, 1605632
s_mov_b32 s55, 0x20000
s_mov_b32 s60, s24
s_mov_b32 s61, s25
s_mov_b32 s62, 1835008
s_mov_b32 s63, 0x20000
s_mov_b32 s64, s26
s_mov_b32 s65, s27
s_mov_b32 s66, 256
s_mov_b32 s67, 0x20000
s_mov_b32 s82, 0xbdd2d3e8
s_mov_b32 s83, 0x3f803f80
s_mov_b32 s84, 0x00003f80
s_mov_b32 s85, 0x3f800000
v_bfe_u32 v1, v0, 2, 2
v_lshrrev_b32 v2, 5, v0
v_lshl_add_u32 v2, v2, 2, v1
v_lshlrev_b32 v2, 7, v2
v_and_b32 v3, 3, v0
v_lshlrev_b32 v3, 3, v3
v_bfe_u32 v1, v0, 4, 1
v_lshl_add_u32 v3, v1, 5, v3
v_bfe_u32 v1, v0, 3, 1
s_and_b32 s96, s3, 1
v_xor_b32 v1, s96, v1
v_lshl_add_u32 v3, v1, 6, v3
v_add_u32 v20, v2, v3
v_add_u32 v21, 0x10000, v20
s_lshr_b32 s97, s3, 1
s_lshl_b32 s98, s97, 13
v_add_u32 v18, s98, v20
v_add_u32 v19, 0x10000, v18
v_lshlrev_b32 v1, 4, v0
s_lshl_b32 s98, s97, 10
s_add_u32 s98, s98, 98304
v_add_u32 v24, s98, v1
v_xor_b32 v25, 1024, v24
s_lshl_b32 s98, s96, 12
s_lshl_b32 s99, s97, 11
s_add_u32 s98, s98, s99
v_add_u32 v27, s98, v1
v_xor_b32 v28, 2048, v27
s_lshl_b32 s98, s4, 6
s_lshl_b32 s99, s97, 5
s_add_u32 s98, s98, s99
v_and_b32 v1, 15, v0
v_add_u32 v1, s98, v1
v_mul_u32_u24 v1, 896, v1
v_lshrrev_b32 v2, 5, v0
s_lshl_b32 s98, s6, 7
s_lshl_b32 s99, s96, 6
s_add_u32 s98, s98, s99
v_lshl_add_u32 v2, v2, 4, s98
v_add_u32 v176, v1, v2
v_and_b32 v2, 16, v0
v_lshl_add_u32 v176, v2, 1, v176
v_and_b32 v1, 31, v0
v_lshrrev_b32 v2, 5, v0
v_bfe_u32 v128, v0, 1, 3
v_xor_b32 v2, v2, v128
v_lshlrev_b32 v1, 7, v1
v_lshl_add_u32 v1, v2, 4, v1
v_add_u32 v128, 98304, v1
v_xor_b32 v129, 32, v128
v_xor_b32 v130, 64, v128
v_xor_b32 v131, 96, v128
v_and_b32 v1, 15, v0
v_lshrrev_b32 v2, 4, v0
v_bfe_u32 v132, v0, 1, 3
v_xor_b32 v2, v2, v132
v_lshlrev_b32 v1, 7, v1
v_lshl_add_u32 v1, v2, 4, v1
v_add_u32 v132, 98304, v1
v_xor_b32 v133, 64, v132
v_add_u32 v132, s89, v132
v_add_u32 v133, s89, v133
v_lshrrev_b32 v1, 5, v0
v_lshl_add_u32 v16, v1, 9, v18
v_add_u32 v17, 0x10000, v16
v_lshrrev_b32 v1, 2, v0
v_xor_b32 v1, v1, v0
v_and_b32 v1, 4, v1
v_cmp_eq_u32 vcc, 0, v1
v_mov_b32 v2, s83
s_nop 0
v_cndmask_b32 v1, 0, v2, vcc
v_accvgpr_write_b32 a228, v2
v_accvgpr_write_b32 a229, v2
v_accvgpr_write_b32 a230, v2
v_accvgpr_write_b32 a231, v2
v_accvgpr_write_b32 a224, v1
v_accvgpr_write_b32 a225, v1
v_accvgpr_write_b32 a226, v1
v_accvgpr_write_b32 a227, v1
s_add_u32 s96, s72, 98304
v_lshl_add_u32 v22, v0, 4, s96
v_mov_b32 v171, 0
v_and_b32 v1, 31, v0
v_lshlrev_b32 v1, 4, v1
v_add_u32 v135, 155648, v1
s_lshl_b32 s96, s3, 8
s_add_u32 s96, s96, 155648
v_and_b32 v1, 15, v0
v_lshl_add_u32 v1, v1, 4, s96
v_lshlrev_b32 v2, 4, v0
v_add_u32 v2, 157696, v2
v_bfe_u32 v3, v0, 2, 2
v_lshrrev_b32 v134, 4, v0
v_cmp_eq_u32 vcc, v3, v134
s_nop 1
v_cndmask_b32 v134, v2, v1, vcc
s_add_u32 s86, s86, 524288
v_mov_b32 v208, 0
v_lshrrev_b32 v209, 2, v0
v_and_b32 v210, 3, v0
v_mul_u32_u24 v209, 512, v209
v_mul_u32_u24 v210, 128, v210
v_add_u32 v209, v209, v210
s_mul_i32 s96, s5, 2048
s_add_u32 s96, s96, s86
s_mul_i32 s97, s3, 512
s_add_u32 s24, s96, s97
s_cmp_eq_u32 s3, 0
s_cselect_b32 s96, s96, 2147483632
s_bfm_b64 exec, 16, 0
buffer_store_dword v208, v209, s[68:71], s96 offen sc1
s_mov_b64 exec, -1
s_movk_i32 s7, 256
s_add_u32 m0, s89, 114688
s_nop 0
buffer_load_dwordx4 v96, s[32:35], s7 offen offset:0 lds
buffer_load_dwordx4 v97, s[32:35], s7 offen offset:1024 lds
s_add_u32 s7, s73, 458752
s_add_u32 m0, s72, 32768
s_nop 0
buffer_load_dwordx4 v8, s[44:47], s7 offen offset:0 lds
buffer_load_dwordx4 v9, s[44:47], s7 offen offset:1024 lds
buffer_load_dwordx4 v10, s[44:47], s7 offen offset:2048 lds
buffer_load_dwordx4 v11, s[44:47], s7 offen offset:3072 lds
s_waitcnt vmcnt(14)
s_barrier
ds_read_b64_tr_b16 v[32:33], v16 offset:0
ds_read_b64_tr_b16 v[34:35], v16 offset:512
ds_read_b64_tr_b16 v[36:37], v16 offset:2048
ds_read_b64_tr_b16 v[38:39], v16 offset:2560
ds_read_b64_tr_b16 v[40:41], v16 offset:4096
ds_read_b64_tr_b16 v[42:43], v16 offset:4608
ds_read_b64_tr_b16 v[44:45], v16 offset:6144
ds_read_b64_tr_b16 v[46:47], v16 offset:6656
ds_read_b128 a[0:3], v128 offset:0
ds_read_b128 a[4:7], v128 offset:4096
ds_read_b128 a[8:11], v129 offset:0
ds_read_b128 a[12:15], v129 offset:4096
ds_read_b128 a[16:19], v130 offset:0
ds_read_b128 a[20:23], v130 offset:4096
ds_read_b128 a[24:27], v131 offset:0
ds_read_b128 a[28:31], v131 offset:4096
ds_read_b128 v[136:139], v132 offset:0
ds_read_b128 v[140:143], v133 offset:0
s_mul_i32 s96, s5, 768
s_lshl_b32 s97, s3, 6
s_add_u32 s96, s96, s97
s_lshl_b32 s97, s6, 7
v_and_b32 v1, 31, v0
v_lshlrev_b32 v1, 1, v1
v_lshlrev_b32 v2, 2, v0
buffer_load_ushort v172, v1, s[48:51], s96 offen
buffer_load_ushort v173, v1, s[48:51], s96 offen offset:256
buffer_load_ushort v174, v1, s[48:51], s96 offen offset:512
buffer_load_dword v179, v2, s[56:59], s97 offen
s_movk_i32 s7, 384
s_add_u32 m0, s89, 122880
s_nop 0
buffer_load_dwordx4 v96, s[32:35], s7 offen offset:0 lds
buffer_load_dwordx4 v97, s[32:35], s7 offen offset:1024 lds
s_add_u32 s7, s73, 688128
s_add_u32 m0, s72, 49152
s_nop 0
buffer_load_dwordx4 v8, s[44:47], s7 offen offset:0 lds
buffer_load_dwordx4 v9, s[44:47], s7 offen offset:1024 lds
buffer_load_dwordx4 v10, s[44:47], s7 offen offset:2048 lds
buffer_load_dwordx4 v11, s[44:47], s7 offen offset:3072 lds
s_waitcnt vmcnt(17) lgkmcnt(10)
s_barrier
s_waitcnt lgkmcnt(9)
v_mfma_f32_32x32x16_bf16 v[64:79], v[32:35], a[0:3], 0
ds_read_b64_tr_b16 v[48:49], v16 offset:16384
ds_read_b64_tr_b16 v[50:51], v16 offset:16896
ds_read_b128 a[32:35], v128 offset:8192
v_lshrrev_b32 v98, 3, v0
v_mul_u32_u24 v98, 896, v98
s_waitcnt lgkmcnt(11)
v_mfma_f32_32x32x16_bf16 v[80:95], v[32:35], a[4:7], 0
ds_read_b64_tr_b16 v[52:53], v16 offset:18432
ds_read_b64_tr_b16 v[54:55], v16 offset:18944
ds_read_b128 a[36:39], v128 offset:12288
v_and_b32 v99, 7, v0
v_bfe_u32 v12, v0, 4, 1
v_lshlrev_b32 v12, 2, v12
v_mfma_f32_16x16x32_bf16 v[160:163], a[224:227], v[32:35], 0
ds_read_b64_tr_b16 v[56:57], v16 offset:20480
v_xor_b32 v99, v99, v12
s_waitcnt lgkmcnt(8)
v_mfma_f32_16x16x32_bf16 v[152:155], v[136:139], v[136:139], 0
ds_read_b64_tr_b16 v[58:59], v16 offset:20992
s_movk_i32 s7, 512
s_add_u32 m0, s89, 131072
v_lshl_add_u32 v12, v99, 4, v98
v_mfma_f32_32x32x16_bf16 v[64:79], v[36:39], a[8:11], v[64:79]
ds_read_b64_tr_b16 v[60:61], v16 offset:22528
ds_read_b64_tr_b16 v[62:63], v16 offset:23040
ds_read_b128 a[40:43], v129 offset:8192
buffer_load_dwordx4 v96, s[32:35], s7 offen offset:0 lds
v_mfma_f32_32x32x16_bf16 v[80:95], v[36:39], a[12:15], v[80:95]
ds_read_b128 a[44:47], v129 offset:12288
ds_read_b128 a[48:51], v130 offset:8192
v_add_u32 v13, 6144, v12
v_add_u32 v14, 12288, v12
v_add_u32 v15, 18432, v12
v_mfma_f32_16x16x32_bf16 v[160:163], a[224:227], v[36:39], v[160:163]
ds_read_b128 a[52:55], v130 offset:12288
buffer_load_dwordx4 v97, s[32:35], s7 offen offset:1024 lds
v_mfma_f32_16x16x32_bf16 v[156:159], a[228:231], v[136:139], 0
ds_read_b128 a[56:59], v131 offset:8192
s_mul_i32 s30, s5, 384
v_mfma_f32_32x32x16_bf16 v[64:79], v[40:43], a[16:19], v[64:79]
ds_read_b128 a[60:63], v131 offset:12288
ds_read_b128 v[144:147], v132 offset:8192
s_add_u32 s7, s73, 917504
s_add_u32 m0, s72, 65536
s_nop 0
buffer_load_dwordx4 v8, s[44:47], s7 offen offset:0 lds
s_lshr_b32 s16, s3, 1
v_mfma_f32_32x32x16_bf16 v[80:95], v[40:43], a[20:23], v[80:95]
ds_read_b128 v[148:151], v133 offset:8192
s_add_u32 s16, s16, s6
s_add_u32 s16, s16, 1
s_sub_u32 s17, s16, 7
v_mfma_f32_16x16x32_bf16 v[160:163], a[224:227], v[40:43], v[160:163]
buffer_load_dwordx4 v9, s[44:47], s7 offen offset:1024 lds
s_waitcnt lgkmcnt(15)
v_mfma_f32_16x16x32_bf16 v[152:155], v[140:143], v[140:143], v[152:155]
s_cmp_ge_u32 s16, 7
s_cselect_b32 s16, s17, s16
v_mfma_f32_32x32x16_bf16 v[64:79], v[44:47], a[24:27], v[64:79]
buffer_load_dwordx4 v10, s[44:47], s7 offen offset:2048 lds
s_mul_i32 s17, s4, 7
s_add_u32 s17, s17, s16
v_mfma_f32_32x32x16_bf16 v[80:95], v[44:47], a[28:31], v[80:95]
s_lshl_b32 s17, s17, 3
s_add_u32 s17, s17, s5
s_mul_i32 s17, s17, 8192
s_add_u32 s78, s17, 1048576
v_mfma_f32_16x16x32_bf16 v[160:163], a[224:227], v[44:47], v[160:163]
buffer_load_dwordx4 v11, s[44:47], s7 offen offset:3072 lds
v_mfma_f32_16x16x32_bf16 v[156:159], a[228:231], v[140:143], v[156:159]
s_lshl_b32 s16, s16, 7
s_waitcnt vmcnt(16) lgkmcnt(8)
s_barrier
v_mfma_f32_32x32x16_bf16 v[64:79], v[48:51], a[32:35], v[64:79]
ds_read_b64_tr_b16 v[32:33], v16 offset:32768
ds_read_b64_tr_b16 v[34:35], v16 offset:33280
ds_read_b128 a[64:67], v128 offset:16384
s_and_b32 s17, s3, 1
s_lshl_b32 s18, s17, 5
s_add_u32 s18, s18, s30
v_mfma_f32_32x32x16_bf16 v[80:95], v[48:51], a[36:39], v[80:95]
ds_read_b64_tr_b16 v[36:37], v16 offset:34816
ds_read_b64_tr_b16 v[38:39], v16 offset:35328
ds_read_b128 a[68:71], v128 offset:20480
s_mul_i32 s18, s18, 896
s_add_u32 s74, s18, s16
v_mfma_f32_16x16x32_bf16 v[160:163], a[224:227], v[48:51], v[160:163]
ds_read_b64_tr_b16 v[40:41], v16 offset:36864
s_lshr_b32 s16, s3, 1
s_waitcnt lgkmcnt(8)
v_mfma_f32_16x16x32_bf16 v[152:155], v[144:147], v[144:147], v[152:155]
ds_read_b64_tr_b16 v[42:43], v16 offset:37376
s_movk_i32 s7, 640
s_add_u32 m0, s89, 139264
s_add_u32 s16, s16, s6
v_mfma_f32_32x32x16_bf16 v[64:79], v[52:55], a[40:43], v[64:79]
ds_read_b64_tr_b16 v[44:45], v16 offset:38912
ds_read_b64_tr_b16 v[46:47], v16 offset:39424
ds_read_b128 a[72:75], v129 offset:16384
buffer_load_dwordx4 v96, s[32:35], s7 offen offset:0 lds
v_mfma_f32_32x32x16_bf16 v[80:95], v[52:55], a[44:47], v[80:95]
ds_read_b128 a[76:79], v129 offset:20480
ds_read_b128 a[80:83], v130 offset:16384
s_add_u32 s16, s16, 3
s_sub_u32 s17, s16, 7
s_cmp_ge_u32 s16, 7
s_cselect_b32 s16, s17, s16
v_mfma_f32_16x16x32_bf16 v[160:163], a[224:227], v[52:55], v[160:163]
ds_read_b128 a[84:87], v130 offset:20480
buffer_load_dwordx4 v97, s[32:35], s7 offen offset:1024 lds
v_mfma_f32_16x16x32_bf16 v[156:159], a[228:231], v[144:147], v[156:159]
ds_read_b128 a[88:91], v131 offset:16384
s_mul_i32 s17, s4, 7
v_mfma_f32_32x32x16_bf16 v[64:79], v[56:59], a[48:51], v[64:79]
ds_read_b128 a[92:95], v131 offset:20480
ds_read_b128 v[136:139], v132 offset:16384
s_add_u32 s7, s73, 1146880
s_add_u32 m0, s72, 81920
s_nop 0
buffer_load_dwordx4 v8, s[44:47], s7 offen offset:0 lds
v_mfma_f32_32x32x16_bf16 v[80:95], v[56:59], a[52:55], v[80:95]
ds_read_b128 v[140:143], v133 offset:16384
s_add_u32 s17, s17, s16
s_lshl_b32 s17, s17, 3
s_add_u32 s17, s17, s5
s_mul_i32 s17, s17, 8192
v_mfma_f32_16x16x32_bf16 v[160:163], a[224:227], v[56:59], v[160:163]
buffer_load_dwordx4 v9, s[44:47], s7 offen offset:1024 lds
s_waitcnt lgkmcnt(15)
v_mfma_f32_16x16x32_bf16 v[152:155], v[148:151], v[148:151], v[152:155]
s_add_u32 s79, s17, 1048576
s_lshl_b32 s16, s16, 7
v_mfma_f32_32x32x16_bf16 v[64:79], v[60:63], a[56:59], v[64:79]
buffer_load_dwordx4 v10, s[44:47], s7 offen offset:2048 lds
s_and_b32 s17, s3, 1
s_lshl_b32 s18, s17, 5
v_mfma_f32_32x32x16_bf16 v[80:95], v[60:63], a[60:63], v[80:95]
s_add_u32 s18, s18, s30
s_mul_i32 s18, s18, 896
s_add_u32 s75, s18, s16
s_lshr_b32 s16, s3, 1
v_mfma_f32_16x16x32_bf16 v[160:163], a[224:227], v[60:63], v[160:163]
buffer_load_dwordx4 v11, s[44:47], s7 offen offset:3072 lds
v_mfma_f32_16x16x32_bf16 v[156:159], a[228:231], v[148:151], v[156:159]
s_bfm_b64 exec, 30, 16
buffer_load_dword v248, v250, s[44:47], 0 offen
s_mov_b64 exec, -1
v_lshlrev_b32 v4, 7, v0
s_bfm_b64 exec, 4, 0
buffer_load_dword v248, v4, s[68:71], s24 offen sc1
s_mov_b64 exec, -1
s_waitcnt vmcnt(14) lgkmcnt(8)
s_barrier
v_mfma_f32_32x32x16_bf16 v[64:79], v[32:35], a[64:67], v[64:79]
ds_read_b64_tr_b16 v[48:49], v16 offset:49152
ds_read_b64_tr_b16 v[50:51], v16 offset:49664
ds_read_b128 a[96:99], v128 offset:24576
s_add_u32 s16, s16, s6
s_add_u32 s16, s16, 5
v_mfma_f32_32x32x16_bf16 v[80:95], v[32:35], a[68:71], v[80:95]
ds_read_b64_tr_b16 v[52:53], v16 offset:51200
ds_read_b64_tr_b16 v[54:55], v16 offset:51712
ds_read_b128 a[100:103], v128 offset:28672
s_sub_u32 s17, s16, 7
s_cmp_ge_u32 s16, 7
s_cselect_b32 s16, s17, s16
v_mfma_f32_16x16x32_bf16 v[160:163], a[224:227], v[32:35], v[160:163]
ds_read_b64_tr_b16 v[56:57], v16 offset:53248
s_mul_i32 s17, s4, 7
s_waitcnt lgkmcnt(8)
v_mfma_f32_16x16x32_bf16 v[152:155], v[136:139], v[136:139], v[152:155]
ds_read_b64_tr_b16 v[58:59], v16 offset:53760
s_movk_i32 s7, 768
s_add_u32 m0, s89, 147456
v_mfma_f32_32x32x16_bf16 v[64:79], v[36:39], a[72:75], v[64:79]
ds_read_b64_tr_b16 v[60:61], v16 offset:55296
ds_read_b64_tr_b16 v[62:63], v16 offset:55808
ds_read_b128 a[104:107], v129 offset:24576
buffer_load_dwordx4 v96, s[32:35], s7 offen offset:0 lds
s_add_u32 s17, s17, s16
v_mfma_f32_32x32x16_bf16 v[80:95], v[36:39], a[76:79], v[80:95]
ds_read_b128 a[108:111], v129 offset:28672
ds_read_b128 a[112:115], v130 offset:24576
s_lshl_b32 s17, s17, 3
s_add_u32 s17, s17, s5
s_mul_i32 s17, s17, 8192
v_mfma_f32_16x16x32_bf16 v[160:163], a[224:227], v[36:39], v[160:163]
ds_read_b128 a[116:119], v130 offset:28672
buffer_load_dwordx4 v97, s[32:35], s7 offen offset:1024 lds
v_mfma_f32_16x16x32_bf16 v[156:159], a[228:231], v[136:139], v[156:159]
ds_read_b128 a[120:123], v131 offset:24576
s_add_u32 s80, s17, 1048576
v_mfma_f32_32x32x16_bf16 v[64:79], v[40:43], a[80:83], v[64:79]
ds_read_b128 a[124:127], v131 offset:28672
ds_read_b128 v[144:147], v132 offset:24576
s_add_u32 s7, s73, 1376256
s_add_u32 m0, s72, 0
s_nop 0
buffer_load_dwordx4 v8, s[44:47], s7 offen offset:0 lds
v_mfma_f32_32x32x16_bf16 v[80:95], v[40:43], a[84:87], v[80:95]
ds_read_b128 v[148:151], v133 offset:24576
s_lshl_b32 s16, s16, 7
s_and_b32 s17, s3, 1
s_lshl_b32 s18, s17, 5
v_mfma_f32_16x16x32_bf16 v[160:163], a[224:227], v[40:43], v[160:163]
buffer_load_dwordx4 v9, s[44:47], s7 offen offset:1024 lds
s_waitcnt lgkmcnt(15)
v_mfma_f32_16x16x32_bf16 v[152:155], v[140:143], v[140:143], v[152:155]
s_add_u32 s18, s18, s30
s_mul_i32 s18, s18, 896
v_mfma_f32_32x32x16_bf16 v[64:79], v[44:47], a[88:91], v[64:79]
buffer_load_dwordx4 v10, s[44:47], s7 offen offset:2048 lds
s_add_u32 s76, s18, s16
s_mul_i32 s17, s4, 7
v_mfma_f32_32x32x16_bf16 v[80:95], v[44:47], a[92:95], v[80:95]
s_add_u32 s17, s17, s6
s_mul_i32 s17, s17, 65536
s_add_u32 s87, s17, 1048576
s_mul_i32 s17, s5, 8192
v_mfma_f32_16x16x32_bf16 v[160:163], a[224:227], v[44:47], v[160:163]
buffer_load_dwordx4 v11, s[44:47], s7 offen offset:3072 lds
v_mfma_f32_16x16x32_bf16 v[156:159], a[228:231], v[140:143], v[156:159]
s_add_u32 s81, s87, s17
s_waitcnt vmcnt(14) lgkmcnt(8)
s_barrier
v_mfma_f32_32x32x16_bf16 v[64:79], v[48:51], a[96:99], v[64:79]
ds_read_b64_tr_b16 v[32:33], v17 offset:0
ds_read_b64_tr_b16 v[34:35], v17 offset:512
ds_read_b128 a[128:131], v128 offset:32768
s_lshl_b32 s16, s6, 7
s_lshl_b32 s18, s3, 5
v_mfma_f32_32x32x16_bf16 v[80:95], v[48:51], a[100:103], v[80:95]
ds_read_b64_tr_b16 v[36:37], v17 offset:2048
ds_read_b64_tr_b16 v[38:39], v17 offset:2560
ds_read_b128 a[132:135], v128 offset:36864
s_add_u32 s18, s18, s30
s_mul_i32 s18, s18, 896
s_add_u32 s77, s18, s16
v_mfma_f32_16x16x32_bf16 v[160:163], a[224:227], v[48:51], v[160:163]
ds_read_b64_tr_b16 v[40:41], v17 offset:4096
s_cmp_eq_u32 s5, 7
s_cselect_b32 s88, 2147483632, 0
s_waitcnt lgkmcnt(8)
v_mfma_f32_16x16x32_bf16 v[152:155], v[144:147], v[144:147], v[152:155]
ds_read_b64_tr_b16 v[42:43], v17 offset:4608
s_add_u32 s7, s73, 256
s_add_u32 m0, s72, 16384
v_mfma_f32_32x32x16_bf16 v[64:79], v[52:55], a[104:107], v[64:79]
ds_read_b64_tr_b16 v[44:45], v17 offset:6144
ds_read_b64_tr_b16 v[46:47], v17 offset:6656
ds_read_b128 a[136:139], v129 offset:32768
buffer_load_dwordx4 v8, s[44:47], s7 offen offset:0 lds
v_mfma_f32_32x32x16_bf16 v[80:95], v[52:55], a[108:111], v[80:95]
ds_read_b128 a[140:143], v129 offset:36864
ds_read_b128 a[144:147], v130 offset:32768
s_mov_b32 s16, 0x2134765
s_mov_b32 s17, 0x3ba2119
s_mov_b32 s9, 0
v_mfma_f32_16x16x32_bf16 v[160:163], a[224:227], v[52:55], v[160:163]
ds_read_b128 a[148:151], v130 offset:36864
buffer_load_dwordx4 v9, s[44:47], s7 offen offset:1024 lds
v_mfma_f32_16x16x32_bf16 v[156:159], a[228:231], v[144:147], v[156:159]
ds_read_b128 a[152:155], v131 offset:32768
v_mfma_f32_32x32x16_bf16 v[64:79], v[56:59], a[112:115], v[64:79]
ds_read_b128 a[156:159], v131 offset:36864
ds_read_b128 v[136:139], v132 offset:32768
buffer_load_dwordx4 v10, s[44:47], s7 offen offset:2048 lds
s_cmp_eq_u32 s5, 1
s_cselect_b32 s16, 0x3205476, s16
s_cselect_b32 s17, 0x3b12a99, s17
s_cselect_b32 s9, 0x0, s9
v_mfma_f32_32x32x16_bf16 v[80:95], v[56:59], a[116:119], v[80:95]
ds_read_b128 v[140:143], v133 offset:32768
s_cmp_eq_u32 s5, 2
s_cselect_b32 s16, 0x3410765, s16
s_cselect_b32 s17, 0xb31922a, s17
s_cselect_b32 s9, 0x0, s9
v_mfma_f32_16x16x32_bf16 v[160:163], a[224:227], v[56:59], v[160:163]
buffer_load_dwordx4 v11, s[44:47], s7 offen offset:3072 lds
s_waitcnt lgkmcnt(15)
v_mfma_f32_16x16x32_bf16 v[152:155], v[148:151], v[148:151], v[152:155]
v_mfma_f32_32x32x16_bf16 v[64:79], v[60:63], a[120:123], v[64:79]
s_add_u32 s7, s73, 229632
s_add_u32 m0, s72, 32768
s_nop 0
buffer_load_dwordx4 v8, s[44:47], s7 offen offset:0 lds
v_mfma_f32_32x32x16_bf16 v[80:95], v[60:63], a[124:127], v[80:95]
s_cmp_eq_u32 s5, 3
s_cselect_b32 s16, 0x542176, s16
s_cselect_b32 s17, 0x23b19aa, s17
s_cselect_b32 s9, 0x0, s9
v_lshlrev_b32 v98, 2, v0
v_mfma_f32_16x16x32_bf16 v[160:163], a[224:227], v[60:63], v[160:163]
buffer_load_dwordx4 v9, s[44:47], s7 offen offset:1024 lds
v_mfma_f32_16x16x32_bf16 v[156:159], a[228:231], v[148:151], v[156:159]
v_bfe_u32 v99, s16, v98, 3
s_waitcnt vmcnt(14) lgkmcnt(8)
s_barrier
v_mfma_f32_32x32x16_bf16 v[64:79], v[32:35], a[128:131], v[64:79]
ds_read_b64_tr_b16 v[48:49], v17 offset:16384
ds_read_b64_tr_b16 v[50:51], v17 offset:16896
ds_read_b128 a[160:163], v128 offset:40960
v_bfe_u32 v252, s17, v98, 3
v_add_u32 v98, 3, v98
v_bfe_u32 v98, s17, v98, 1
v_mfma_f32_32x32x16_bf16 v[80:95], v[32:35], a[132:135], v[80:95]
ds_read_b64_tr_b16 v[52:53], v17 offset:18432
ds_read_b64_tr_b16 v[54:55], v17 offset:18944
ds_read_b128 a[164:167], v128 offset:45056
s_and_b32 s18, s3, 1
v_lshl_add_u32 v98, v98, 1, s18
v_mul_u32_u24 v98, 512, v98
v_mfma_f32_16x16x32_bf16 v[160:163], a[224:227], v[32:35], v[160:163]
ds_read_b64_tr_b16 v[56:57], v17 offset:20480
v_mul_u32_u24 v99, 2048, v99
v_add_u32 v98, v98, v99
s_waitcnt lgkmcnt(8)
v_mfma_f32_16x16x32_bf16 v[152:155], v[136:139], v[136:139], v[152:155]
ds_read_b64_tr_b16 v[58:59], v17 offset:20992
s_add_u32 s7, s73, 229632
s_add_u32 m0, s72, 32768
v_mul_u32_u24 v99, 128, v252
v_mfma_f32_32x32x16_bf16 v[64:79], v[36:39], a[136:139], v[64:79]
ds_read_b64_tr_b16 v[60:61], v17 offset:22528
ds_read_b64_tr_b16 v[62:63], v17 offset:23040
ds_read_b128 a[168:171], v129 offset:40960
buffer_load_dwordx4 v10, s[44:47], s7 offen offset:2048 lds
v_add_u32 v98, v98, v99
v_mfma_f32_32x32x16_bf16 v[80:95], v[36:39], a[140:143], v[80:95]
ds_read_b128 a[172:175], v129 offset:45056
ds_read_b128 a[176:179], v130 offset:40960
s_and_b32 s96, s3, 1
s_lshl_b32 s97, s96, 2
v_bfe_u32 v2, v0, 1, 3
v_xor_b32 v2, s97, v2
s_lshl_b32 s96, s96, 7
s_add_u32 s96, s96, 159744
v_lshrrev_b32 v3, 5, v0
v_lshl_add_u32 v5, v3, 4, s96
s_lshr_b32 s96, s3, 1
s_lshl_b32 s97, s6, 1
s_add_u32 s96, s96, s97
s_lshl_b32 s96, s96, 12
s_add_u32 s96, s96, 98304
v_lshl_add_u32 v3, v3, 3, s96
v_mfma_f32_16x16x32_bf16 v[160:163], a[224:227], v[36:39], v[160:163]
ds_read_b128 a[180:183], v130 offset:45056
buffer_load_dwordx4 v11, s[44:47], s7 offen offset:3072 lds
v_mfma_f32_16x16x32_bf16 v[156:159], a[228:231], v[136:139], v[156:159]
ds_read_b128 a[184:187], v131 offset:40960
v_subrev_u32 v98, 128, v98
v_mfma_f32_32x32x16_bf16 v[64:79], v[40:43], a[144:147], v[64:79]
ds_read_b128 a[188:191], v131 offset:45056
ds_read_b128 v[144:147], v132 offset:40960
s_add_u32 s7, s73, 459008
s_add_u32 m0, s72, 49152
s_nop 0
buffer_load_dwordx4 v8, s[44:47], s7 offen offset:0 lds
v_mfma_f32_32x32x16_bf16 v[80:95], v[40:43], a[148:151], v[80:95]
ds_read_b128 v[148:151], v133 offset:40960
v_cmp_gt_u32 vcc, 7, v0
v_mov_b32 v99, 2147483632
s_nop 0
v_cndmask_b32 v249, v99, v98, vcc
s_mov_b32 s25, 0
s_mov_b32 s29, s16
v_mfma_f32_16x16x32_bf16 v[160:163], a[224:227], v[40:43], v[160:163]
buffer_load_dwordx4 v9, s[44:47], s7 offen offset:1024 lds
s_waitcnt lgkmcnt(15)
v_mfma_f32_16x16x32_bf16 v[152:155], v[140:143], v[140:143], v[152:155]
s_bfe_u32 s48, s29, 0x30000
s_mul_i32 s48, s48, 8192
s_add_u32 s48, s48, s87
v_mfma_f32_32x32x16_bf16 v[64:79], v[44:47], a[152:155], v[64:79]
buffer_load_dwordx4 v10, s[44:47], s7 offen offset:2048 lds
v_and_b32 v1, 31, v0
v_lshl_add_u32 v2, v2, 4, v3
s_bfe_u32 s49, s29, 0x30004
v_mfma_f32_32x32x16_bf16 v[80:95], v[44:47], a[156:159], v[80:95]
v_lshl_add_u32 v1, v1, 7, v2
v_xor_b32 v2, 16, v1
v_xor_b32 v3, 32, v1
s_mul_i32 s49, s49, 8192
s_add_u32 s49, s49, s87
s_bfe_u32 s50, s29, 0x30008
v_mfma_f32_16x16x32_bf16 v[160:163], a[224:227], v[44:47], v[160:163]
buffer_load_dwordx4 v11, s[44:47], s7 offen offset:3072 lds
s_mul_i32 s50, s50, 8192
v_mfma_f32_16x16x32_bf16 v[156:159], a[228:231], v[140:143], v[156:159]
v_xor_b32 v6, 48, v1
s_waitcnt vmcnt(12) lgkmcnt(8)
s_barrier
v_mfma_f32_32x32x16_bf16 v[64:79], v[48:51], a[160:163], v[64:79]
ds_read_b64_tr_b16 v[32:33], v16 offset:0
ds_read_b64_tr_b16 v[34:35], v16 offset:512
ds_read_b128 v[136:139], v132 offset:49152
s_add_u32 s50, s50, s87
v_mfma_f32_32x32x16_bf16 v[80:95], v[48:51], a[164:167], v[80:95]
ds_read_b64_tr_b16 v[36:37], v16 offset:2048
ds_read_b64_tr_b16 v[38:39], v16 offset:2560
ds_read_b128 v[140:143], v133 offset:49152
s_bfe_u32 s51, s29, 0x3000c
v_mfma_f32_16x16x32_bf16 v[160:163], a[224:227], v[48:51], v[160:163]
ds_read_b64_tr_b16 v[40:41], v16 offset:4096
s_waitcnt lgkmcnt(8)
v_mfma_f32_16x16x32_bf16 v[152:155], v[144:147], v[144:147], v[152:155]
ds_read_b64_tr_b16 v[42:43], v16 offset:4608
s_mul_i32 s51, s51, 8192
v_mfma_f32_32x32x16_bf16 v[64:79], v[52:55], a[168:171], v[64:79]
ds_read_b64_tr_b16 v[44:45], v16 offset:6144
ds_read_b64_tr_b16 v[46:47], v16 offset:6656
ds_read_b128 a[192:195], v128 offset:49152
s_add_u32 s51, s51, s87
v_mfma_f32_32x32x16_bf16 v[80:95], v[52:55], a[172:175], v[80:95]
ds_read_b128 a[196:199], v128 offset:53248
ds_read_b128 a[200:203], v129 offset:49152
s_bfe_u32 s56, s29, 0x30010
v_mfma_f32_16x16x32_bf16 v[160:163], a[224:227], v[52:55], v[160:163]
ds_read_b128 a[204:207], v129 offset:53248
s_mul_i32 s56, s56, 8192
v_mfma_f32_16x16x32_bf16 v[156:159], a[228:231], v[144:147], v[156:159]
ds_read_b128 a[208:211], v130 offset:49152
v_mfma_f32_32x32x16_bf16 v[64:79], v[56:59], a[176:179], v[64:79]
ds_read_b128 a[212:215], v130 offset:53248
ds_read_b128 a[216:219], v131 offset:49152
s_add_u32 s56, s56, s87
v_mfma_f32_32x32x16_bf16 v[80:95], v[56:59], a[180:183], v[80:95]
ds_read_b128 a[220:223], v131 offset:53248
ds_read_b64 v[240:241], v1
s_add_u32 s7, s73, 688384
s_add_u32 m0, s72, 65536
s_bfe_u32 s57, s29, 0x30014
v_mfma_f32_16x16x32_bf16 v[160:163], a[224:227], v[56:59], v[160:163]
ds_read_b64 v[242:243], v2
buffer_load_dwordx4 v8, s[44:47], s7 offen offset:0 lds
s_waitcnt lgkmcnt(15)
v_mfma_f32_16x16x32_bf16 v[152:155], v[148:151], v[148:151], v[152:155]
ds_read_b64 v[244:245], v3
v_mfma_f32_32x32x16_bf16 v[64:79], v[60:63], a[184:187], v[64:79]
ds_read_b64 v[246:247], v6
buffer_load_dwordx4 v9, s[44:47], s7 offen offset:1024 lds
s_mul_i32 s57, s57, 8192
v_mfma_f32_32x32x16_bf16 v[80:95], v[60:63], a[188:191], v[80:95]
s_add_u32 s57, s57, s87
s_bfe_u32 s58, s29, 0x30018
v_mfma_f32_16x16x32_bf16 v[160:163], a[224:227], v[60:63], v[160:163]
s_mul_i32 s58, s58, 8192
v_mfma_f32_16x16x32_bf16 v[156:159], a[228:231], v[148:151], v[156:159]
buffer_load_dwordx4 v10, s[44:47], s7 offen offset:2048 lds
v_mfma_f32_16x16x32_bf16 v[152:155], v[136:139], v[136:139], v[152:155]
v_mfma_f32_16x16x32_bf16 v[156:159], a[228:231], v[136:139], v[156:159]
buffer_load_dwordx4 v11, s[44:47], s7 offen offset:3072 lds
s_waitcnt lgkmcnt(15)
v_mfma_f32_16x16x32_bf16 v[152:155], v[140:143], v[140:143], v[152:155]
s_add_u32 s58, s58, s87
v_mfma_f32_16x16x32_bf16 v[156:159], a[228:231], v[140:143], v[156:159]
v_mov_b32 v4, 1
s_lshl_b32 s96, s4, 3
s_cmp_eq_u32 s3, 0
s_cselect_b32 s96, s96, 2147483632
buffer_atomic_add v4, v7, s[64:67], s96 offen sc1
s_waitcnt vmcnt(13) lgkmcnt(12)
s_barrier
s_waitcnt lgkmcnt(11)
v_mfma_f32_32x32x16_bf16 v[64:79], v[32:35], a[192:195], v[64:79]
ds_read_b64_tr_b16 v[48:49], v16 offset:16384
ds_read_b64_tr_b16 v[50:51], v16 offset:16896
s_mov_b32 vcc_lo, 0xaaaaaaaa
s_mov_b32 vcc_hi, 0xaaaaaaaa
v_cndmask_b32 v112, v152, v153, vcc
v_cndmask_b32 v113, v154, v155, vcc
s_mov_b32 vcc_lo, 0xcccccccc
s_mov_b32 vcc_hi, 0xcccccccc
v_cndmask_b32 v112, v112, v113, vcc
s_waitcnt lgkmcnt(12)
v_mfma_f32_32x32x16_bf16 v[80:95], v[32:35], a[196:199], v[80:95]
ds_read_b64_tr_b16 v[52:53], v16 offset:18432
ds_read_b64_tr_b16 v[54:55], v16 offset:18944
v_mul_f32 v113, 0xbb124925, v156
v_mul_f32 v112, 0x3b124925, v112
v_fma_f32 v112, -v113, v113, v112
v_max_f32 v112, 0, v112
v_add_f32 v114, 0x3727c5ac, v112
v_rsq_f32 v114, v114
s_nop 0
v_mul_f32 v112, v112, v114
v_mfma_f32_16x16x32_bf16 v[160:163], a[224:227], v[32:35], v[160:163]
ds_read_b64_tr_b16 v[56:57], v16 offset:20480
v_mul_f32 v112, v112, v114
v_add_f32 v112, 0x3727c5ac, v112
v_rsq_f32 v112, v112
s_waitcnt lgkmcnt(14)
v_mfma_f32_32x32x16_bf16 v[64:79], v[36:39], a[200:203], v[64:79]
ds_read_b64_tr_b16 v[58:59], v16 offset:20992
ds_read_b64_tr_b16 v[60:61], v16 offset:22528
v_mul_f32 v115, v114, v112
v_rcp_f32 v110, v115
v_mul_f32 v113, 0.5, v113
v_mul_f32 v108, 0xc0135761, v115
v_mul_f32 v112, v115, v115
v_mul_f32 v114, 0.5, v110
v_mul_f32 v112, v112, v108
s_waitcnt lgkmcnt(15)
v_mfma_f32_32x32x16_bf16 v[80:95], v[36:39], a[204:207], v[80:95]
ds_read_b64_tr_b16 v[62:63], v16 offset:23040
v_mov_b32 v107, 0
v_mul_f32 v109, 0x3d372713, v112
v_cvt_pk_bf16_f32 v116, v113, v113
v_cvt_pk_bf16_f32 v117, v114, v114
v_and_b32 v116, 0xffff0000, v116
v_and_b32 v117, 0xffff0000, v117
v_sub_f32 v116, v113, v116
v_sub_f32 v117, v114, v117
v_mfma_f32_16x16x32_bf16 v[160:163], a[224:227], v[36:39], v[160:163]
s_add_u32 s7, s73, 917760
s_add_u32 m0, s72, 81920
v_cvt_pk_bf16_f32 v104, v113, v116
v_cvt_pk_bf16_f32 v106, v114, v117
v_mov_b32 v105, v104
v_mov_b32 v111, 0
s_waitcnt lgkmcnt(15)
v_mfma_f32_32x32x16_bf16 v[64:79], v[40:43], a[208:211], v[64:79]
buffer_load_dwordx4 v8, s[44:47], s7 offen offset:0 lds
ds_write_b128 v134, v[104:107]
ds_write_b128 v134, v[108:111] offset:1024
s_waitcnt lgkmcnt(15)
v_mfma_f32_32x32x16_bf16 v[80:95], v[40:43], a[212:215], v[80:95]
buffer_load_dwordx4 v9, s[44:47], s7 offen offset:1024 lds
v_mfma_f32_16x16x32_bf16 v[160:163], a[224:227], v[40:43], v[160:163]
v_mfma_f32_32x32x16_bf16 v[64:79], v[44:47], a[216:219], v[64:79]
s_waitcnt lgkmcnt(14)
v_mfma_f32_32x32x16_bf16 v[80:95], v[44:47], a[220:223], v[80:95]
v_mfma_f32_16x16x32_bf16 v[160:163], a[224:227], v[44:47], v[160:163]
s_waitcnt vmcnt(11) lgkmcnt(0)
s_barrier
v_mfma_f32_32x32x16_bf16 v[96:111], v[48:51], a[0:3], 0
ds_read_b64_tr_b16 v[32:33], v16 offset:32768
ds_read_b64_tr_b16 v[34:35], v16 offset:33280
ds_read_b128 v[224:227], v135 offset:0
v_mfma_f32_32x32x16_bf16 v[112:127], v[48:51], a[4:7], 0
ds_read_b64_tr_b16 v[36:37], v16 offset:34816
ds_read_b64_tr_b16 v[38:39], v16 offset:35328
ds_read_b128 v[228:231], v135 offset:512
v_cvt_pk_bf16_f32 v168, v160, v160
v_mfma_f32_16x16x32_bf16 v[164:167], a[224:227], v[48:51], 0
ds_read_b64_tr_b16 v[40:41], v16 offset:36864
s_add_u32 s7, s73, 917760
s_add_u32 m0, s72, 81920
v_mfma_f32_32x32x16_bf16 v[96:111], v[52:55], a[8:11], v[96:111]
ds_read_b64_tr_b16 v[42:43], v16 offset:37376
ds_read_b64_tr_b16 v[44:45], v16 offset:38912
ds_read_b128 v[232:235], v135 offset:1024
buffer_load_dwordx4 v10, s[44:47], s7 offen offset:2048 lds
v_lshl_or_b32 v170, v172, 16, v172
v_mfma_f32_32x32x16_bf16 v[112:127], v[52:55], a[12:15], v[112:127]
ds_read_b64_tr_b16 v[46:47], v16 offset:39424
ds_read_b128 v[236:239], v135 offset:1536
v_and_b32 v175, 0xffff0000, v168
v_mfma_f32_16x16x32_bf16 v[164:167], a[224:227], v[52:55], v[164:167]
buffer_load_dwordx4 v11, s[44:47], s7 offen offset:3072 lds
v_mfma_f32_32x32x16_bf16 v[96:111], v[56:59], a[16:19], v[96:111]
v_sub_f32 v175, v160, v175
v_mfma_f32_32x32x16_bf16 v[112:127], v[56:59], a[20:23], v[112:127]
s_add_u32 s7, s73, 1147136
s_add_u32 m0, s72, 0
s_nop 0
buffer_load_dwordx4 v8, s[44:47], s7 offen offset:0 lds
v_cvt_pk_bf16_f32 v169, v175, v175
v_mfma_f32_16x16x32_bf16 v[164:167], a[224:227], v[56:59], v[164:167]
buffer_load_dwordx4 v9, s[44:47], s7 offen offset:1024 lds
v_mfma_f32_32x32x16_bf16 v[96:111], v[60:63], a[24:27], v[96:111]
v_mfma_f32_32x32x16_bf16 v[112:127], v[60:63], a[28:31], v[112:127]
buffer_load_dwordx4 v10, s[44:47], s7 offen offset:2048 lds
v_mfma_f32_16x16x32_bf16 v[164:167], a[224:227], v[60:63], v[164:167]
s_waitcnt lgkmcnt(9)
v_mfma_f32_32x32x16_bf16 v[64:79], v[168:171], v[224:227], v[64:79]
buffer_load_dwordx4 v11, s[44:47], s7 offen offset:3072 lds
s_waitcnt lgkmcnt(6)
v_mfma_f32_32x32x16_bf16 v[80:95], v[168:171], v[228:231], v[80:95]
s_waitcnt vmcnt(13) lgkmcnt(1)
s_barrier
v_mfma_f32_32x32x16_bf16 v[96:111], v[32:35], a[32:35], v[96:111]
ds_read_b64_tr_b16 v[48:49], v16 offset:49152
ds_read_b64_tr_b16 v[50:51], v16 offset:49664
s_nop 3
v_mul_f32 v184, v64, v64
v_mul_f32 v185, v65, v65
v_mul_f32 v186, v66, v66
v_mul_f32 v187, v67, v67
v_fma_f32 v184, v184, v233, v232
v_fma_f32 v185, v185, v233, v232
v_fma_f32 v186, v186, v233, v232
v_fma_f32 v187, v187, v233, v232
v_mfma_f32_32x32x16_bf16 v[112:127], v[32:35], a[36:39], v[112:127]
ds_read_b64_tr_b16 v[52:53], v16 offset:51200
ds_read_b64_tr_b16 v[54:55], v16 offset:51712
v_mul_f32 v184, v184, v64
v_mul_f32 v185, v185, v65
v_mul_f32 v186, v186, v66
v_mul_f32 v187, v187, v67
v_exp_f32 v184, v184
v_exp_f32 v185, v185
v_mfma_f32_16x16x32_bf16 v[164:167], a[224:227], v[32:35], v[164:167]
ds_read_b64_tr_b16 v[56:57], v16 offset:53248
s_add_u32 s7, s73, 1376512
s_add_u32 m0, s72, 16384
v_exp_f32 v186, v186
v_exp_f32 v187, v187
v_mfma_f32_32x32x16_bf16 v[96:111], v[36:39], a[40:43], v[96:111]
ds_read_b64_tr_b16 v[58:59], v16 offset:53760
ds_read_b64_tr_b16 v[60:61], v16 offset:55296
buffer_load_dwordx4 v8, s[44:47], s7 offen offset:0 lds
v_fma_f32 v184, v184, v234, v234
v_fma_f32 v185, v185, v234, v234
v_fma_f32 v186, v186, v234, v234
v_fma_f32 v187, v187, v234, v234
v_mfma_f32_32x32x16_bf16 v[112:127], v[36:39], a[44:47], v[112:127]
ds_read_b64_tr_b16 v[62:63], v16 offset:55808
buffer_load_dwordx4 v9, s[44:47], s7 offen offset:1024 lds
v_rcp_f32 v184, v184
v_rcp_f32 v185, v185
v_rcp_f32 v186, v186
v_mfma_f32_16x16x32_bf16 v[164:167], a[224:227], v[36:39], v[164:167]
v_rcp_f32 v187, v187
v_mul_f32 v184, v184, v64
v_mul_f32 v185, v185, v65
v_mul_f32 v186, v186, v66
v_mul_f32 v187, v187, v67
v_mfma_f32_32x32x16_bf16 v[96:111], v[40:43], a[48:51], v[96:111]
buffer_load_dwordx4 v10, s[44:47], s7 offen offset:2048 lds
v_cvt_pk_bf16_f32 v192, v184, v185
v_cvt_pk_bf16_f32 v193, v186, v187
v_mul_f32 v188, v68, v68
v_mul_f32 v189, v69, v69
v_mul_f32 v190, v70, v70
v_mul_f32 v191, v71, v71
v_mfma_f32_32x32x16_bf16 v[112:127], v[40:43], a[52:55], v[112:127]
buffer_load_dwordx4 v11, s[44:47], s7 offen offset:3072 lds
v_fma_f32 v188, v188, v233, v232
v_fma_f32 v189, v189, v233, v232
v_fma_f32 v190, v190, v233, v232
v_fma_f32 v191, v191, v233, v232
v_mul_f32 v188, v188, v68
v_mul_f32 v189, v189, v69
v_mul_f32 v190, v190, v70
v_mfma_f32_16x16x32_bf16 v[164:167], a[224:227], v[40:43], v[164:167]
v_mul_f32 v191, v191, v71
v_exp_f32 v188, v188
v_exp_f32 v189, v189
v_mfma_f32_32x32x16_bf16 v[96:111], v[44:47], a[56:59], v[96:111]
s_add_u32 s7, s73, 512
s_add_u32 m0, s72, 32768
s_nop 0
buffer_load_dwordx4 v8, s[44:47], s7 offen offset:0 lds
v_exp_f32 v190, v190
v_exp_f32 v191, v191
v_fma_f32 v188, v188, v234, v234
v_mfma_f32_32x32x16_bf16 v[112:127], v[44:47], a[60:63], v[112:127]
buffer_load_dwordx4 v9, s[44:47], s7 offen offset:1024 lds
v_fma_f32 v189, v189, v234, v234
v_fma_f32 v190, v190, v234, v234
v_fma_f32 v191, v191, v234, v234
v_rcp_f32 v188, v188
v_rcp_f32 v189, v189
v_mfma_f32_16x16x32_bf16 v[164:167], a[224:227], v[44:47], v[164:167]
v_rcp_f32 v190, v190
v_rcp_f32 v191, v191
s_waitcnt vmcnt(15) lgkmcnt(0)
s_barrier
v_mfma_f32_32x32x16_bf16 v[96:111], v[48:51], a[64:67], v[96:111]
ds_read_b64_tr_b16 v[32:33], v17 offset:0
ds_read_b64_tr_b16 v[34:35], v17 offset:512
v_mul_f32 v188, v188, v68
v_mul_f32 v189, v189, v69
v_mul_f32 v190, v190, v70
v_mul_f32 v191, v191, v71
v_cvt_pk_bf16_f32 v194, v188, v189
v_cvt_pk_bf16_f32 v195, v190, v191
v_mfma_f32_32x32x16_bf16 v[112:127], v[48:51], a[68:71], v[112:127]
ds_read_b64_tr_b16 v[36:37], v17 offset:2048
ds_read_b64_tr_b16 v[38:39], v17 offset:2560
v_mul_f32 v184, v72, v72
v_mul_f32 v185, v73, v73
v_mul_f32 v186, v74, v74
v_mul_f32 v187, v75, v75
v_fma_f32 v184, v184, v233, v232
v_fma_f32 v185, v185, v233, v232
v_fma_f32 v186, v186, v233, v232
v_mfma_f32_16x16x32_bf16 v[164:167], a[224:227], v[48:51], v[164:167]
ds_read_b64_tr_b16 v[40:41], v17 offset:4096
s_add_u32 s7, s73, 512
s_add_u32 m0, s72, 32768
v_fma_f32 v187, v187, v233, v232
v_mul_f32 v184, v184, v72
v_mul_f32 v185, v185, v73
v_mfma_f32_32x32x16_bf16 v[96:111], v[52:55], a[72:75], v[96:111]
ds_read_b64_tr_b16 v[42:43], v17 offset:4608
ds_read_b64_tr_b16 v[44:45], v17 offset:6144
buffer_load_dwordx4 v10, s[44:47], s7 offen offset:2048 lds
v_mul_f32 v186, v186, v74
v_mul_f32 v187, v187, v75
v_exp_f32 v184, v184
v_mfma_f32_32x32x16_bf16 v[112:127], v[52:55], a[76:79], v[112:127]
ds_read_b64_tr_b16 v[46:47], v17 offset:6656
buffer_load_dwordx4 v11, s[44:47], s7 offen offset:3072 lds
v_exp_f32 v185, v185
v_exp_f32 v186, v186
v_exp_f32 v187, v187
v_mfma_f32_16x16x32_bf16 v[164:167], a[224:227], v[52:55], v[164:167]
ds_write_b128 v22, v[192:195] offset:0
v_fma_f32 v184, v184, v234, v234
v_lshlrev_b32 v2, 16, v179
v_and_b32 v3, 0xffff0000, v179
v_lshlrev_b32 v1, 3, v0
v_add_u32 v1, 159744, v1
ds_write_b64 v1, v[2:3]
v_mfma_f32_32x32x16_bf16 v[96:111], v[56:59], a[80:83], v[96:111]
s_add_u32 s7, s73, 229888
s_add_u32 m0, s72, 49152
s_nop 0
buffer_load_dwordx4 v8, s[44:47], s7 offen offset:0 lds
v_fma_f32 v185, v185, v234, v234
v_fma_f32 v186, v186, v234, v234
v_fma_f32 v187, v187, v234, v234
v_mfma_f32_32x32x16_bf16 v[112:127], v[56:59], a[84:87], v[112:127]
buffer_load_dwordx4 v9, s[44:47], s7 offen offset:1024 lds
v_rcp_f32 v184, v184
v_rcp_f32 v185, v185
v_rcp_f32 v186, v186
v_rcp_f32 v187, v187
v_mfma_f32_16x16x32_bf16 v[164:167], a[224:227], v[56:59], v[164:167]
v_mul_f32 v184, v184, v72
v_mul_f32 v185, v185, v73
v_mul_f32 v186, v186, v74
v_mul_f32 v187, v187, v75
v_cvt_pk_bf16_f32 v196, v184, v185
v_mfma_f32_32x32x16_bf16 v[96:111], v[60:63], a[88:91], v[96:111]
buffer_load_dwordx4 v10, s[44:47], s7 offen offset:2048 lds
v_cvt_pk_bf16_f32 v197, v186, v187
v_mul_f32 v188, v76, v76
v_mul_f32 v189, v77, v77
v_mul_f32 v190, v78, v78
v_mul_f32 v191, v79, v79
v_fma_f32 v188, v188, v233, v232
v_fma_f32 v189, v189, v233, v232
v_mfma_f32_32x32x16_bf16 v[112:127], v[60:63], a[92:95], v[112:127]
buffer_load_dwordx4 v11, s[44:47], s7 offen offset:3072 lds
v_fma_f32 v190, v190, v233, v232
v_fma_f32 v191, v191, v233, v232
v_mul_f32 v188, v188, v76
v_mul_f32 v189, v189, v77
v_mul_f32 v190, v190, v78
v_mul_f32 v191, v191, v79
v_mfma_f32_16x16x32_bf16 v[164:167], a[224:227], v[60:63], v[164:167]
v_exp_f32 v188, v188
v_exp_f32 v189, v189
s_waitcnt vmcnt(16) lgkmcnt(2)
s_barrier
v_mfma_f32_32x32x16_bf16 v[96:111], v[32:35], a[96:99], v[96:111]
ds_read_b64_tr_b16 v[48:49], v17 offset:16384
ds_read_b64_tr_b16 v[50:51], v17 offset:16896
v_exp_f32 v190, v190
v_exp_f32 v191, v191
v_fma_f32 v188, v188, v234, v234
v_mfma_f32_32x32x16_bf16 v[112:127], v[32:35], a[100:103], v[112:127]
ds_read_b64_tr_b16 v[52:53], v17 offset:18432
ds_read_b64_tr_b16 v[54:55], v17 offset:18944
v_fma_f32 v189, v189, v234, v234
v_fma_f32 v190, v190, v234, v234
v_fma_f32 v191, v191, v234, v234
v_rcp_f32 v188, v188
v_mfma_f32_16x16x32_bf16 v[164:167], a[224:227], v[32:35], v[164:167]
ds_read_b64_tr_b16 v[56:57], v17 offset:20480
v_mfma_f32_32x32x16_bf16 v[96:111], v[36:39], a[104:107], v[96:111]
ds_read_b64_tr_b16 v[58:59], v17 offset:20992
ds_read_b64_tr_b16 v[60:61], v17 offset:22528
v_rcp_f32 v189, v189
v_rcp_f32 v190, v190
v_rcp_f32 v191, v191
v_mfma_f32_32x32x16_bf16 v[112:127], v[36:39], a[108:111], v[112:127]
ds_read_b64_tr_b16 v[62:63], v17 offset:23040
v_mul_f32 v188, v188, v76
v_mul_f32 v189, v189, v77
v_mul_f32 v190, v190, v78
v_mul_f32 v191, v191, v79
v_cvt_pk_bf16_f32 v198, v188, v189
v_mfma_f32_16x16x32_bf16 v[164:167], a[224:227], v[36:39], v[164:167]
s_add_u32 s7, s73, 459264
s_add_u32 m0, s72, 65536
v_mfma_f32_32x32x16_bf16 v[96:111], v[40:43], a[112:115], v[96:111]
buffer_load_dwordx4 v8, s[44:47], s7 offen offset:0 lds
v_cvt_pk_bf16_f32 v199, v190, v191
ds_write_b128 v22, v[196:199] offset:2048
v_mfma_f32_32x32x16_bf16 v[112:127], v[40:43], a[116:119], v[112:127]
buffer_load_dwordx4 v9, s[44:47], s7 offen offset:1024 lds
v_mul_f32 v184, v80, v80
v_mul_f32 v185, v81, v81
v_mfma_f32_16x16x32_bf16 v[164:167], a[224:227], v[40:43], v[164:167]
v_mul_f32 v186, v82, v82
v_mul_f32 v187, v83, v83
v_fma_f32 v184, v184, v237, v236
v_mfma_f32_32x32x16_bf16 v[96:111], v[44:47], a[120:123], v[96:111]
buffer_load_dwordx4 v10, s[44:47], s7 offen offset:2048 lds
v_fma_f32 v185, v185, v237, v236
v_fma_f32 v186, v186, v237, v236
v_fma_f32 v187, v187, v237, v236
v_mfma_f32_32x32x16_bf16 v[112:127], v[44:47], a[124:127], v[112:127]
buffer_load_dwordx4 v11, s[44:47], s7 offen offset:3072 lds
v_mul_f32 v184, v184, v80
v_mul_f32 v185, v185, v81
v_mul_f32 v186, v186, v82
v_mfma_f32_16x16x32_bf16 v[164:167], a[224:227], v[44:47], v[164:167]
s_waitcnt vmcnt(16) lgkmcnt(1)
s_barrier
v_mfma_f32_32x32x16_bf16 v[96:111], v[48:51], a[128:131], v[96:111]
ds_read_b64_tr_b16 v[32:33], v16 offset:0
ds_read_b64_tr_b16 v[34:35], v16 offset:512
v_mul_f32 v187, v187, v83
v_exp_f32 v184, v184
v_exp_f32 v185, v185
v_mfma_f32_32x32x16_bf16 v[112:127], v[48:51], a[132:135], v[112:127]
ds_read_b64_tr_b16 v[36:37], v16 offset:2048
ds_read_b64_tr_b16 v[38:39], v16 offset:2560
v_exp_f32 v186, v186
v_exp_f32 v187, v187
v_mfma_f32_16x16x32_bf16 v[164:167], a[224:227], v[48:51], v[164:167]
ds_read_b64_tr_b16 v[40:41], v16 offset:4096
v_fma_f32 v184, v184, v238, v238
v_mfma_f32_32x32x16_bf16 v[96:111], v[52:55], a[136:139], v[96:111]
ds_read_b64_tr_b16 v[42:43], v16 offset:4608
ds_read_b64_tr_b16 v[44:45], v16 offset:6144
v_fma_f32 v185, v185, v238, v238
v_fma_f32 v186, v186, v238, v238
v_fma_f32 v187, v187, v238, v238
v_rcp_f32 v184, v184
v_mfma_f32_32x32x16_bf16 v[112:127], v[52:55], a[140:143], v[112:127]
ds_read_b64_tr_b16 v[46:47], v16 offset:6656
v_rcp_f32 v185, v185
v_rcp_f32 v186, v186
v_rcp_f32 v187, v187
v_mfma_f32_16x16x32_bf16 v[164:167], a[224:227], v[52:55], v[164:167]
s_add_u32 s7, s73, 688640
s_add_u32 m0, s72, 81920
v_mfma_f32_32x32x16_bf16 v[96:111], v[56:59], a[144:147], v[96:111]
buffer_load_dwordx4 v8, s[44:47], s7 offen offset:0 lds
v_mul_f32 v184, v184, v80
v_mul_f32 v185, v185, v81
v_mfma_f32_32x32x16_bf16 v[112:127], v[56:59], a[148:151], v[112:127]
buffer_load_dwordx4 v9, s[44:47], s7 offen offset:1024 lds
v_mul_f32 v186, v186, v82
v_mul_f32 v187, v187, v83
v_cvt_pk_bf16_f32 v200, v184, v185
v_mfma_f32_16x16x32_bf16 v[164:167], a[224:227], v[56:59], v[164:167]
v_cvt_pk_bf16_f32 v201, v186, v187
v_mul_f32 v188, v84, v84
v_mul_f32 v189, v85, v85
v_mfma_f32_32x32x16_bf16 v[96:111], v[60:63], a[152:155], v[96:111]
buffer_load_dwordx4 v10, s[44:47], s7 offen offset:2048 lds
v_mul_f32 v190, v86, v86
v_mul_f32 v191, v87, v87
v_fma_f32 v188, v188, v237, v236
v_mfma_f32_32x32x16_bf16 v[112:127], v[60:63], a[156:159], v[112:127]
buffer_load_dwordx4 v11, s[44:47], s7 offen offset:3072 lds
v_fma_f32 v189, v189, v237, v236
v_fma_f32 v190, v190, v237, v236
v_fma_f32 v191, v191, v237, v236
v_mfma_f32_16x16x32_bf16 v[164:167], a[224:227], v[60:63], v[164:167]
s_waitcnt vmcnt(16) lgkmcnt(0)
s_barrier
v_mfma_f32_32x32x16_bf16 v[96:111], v[32:35], a[160:163], v[96:111]
ds_read_b64_tr_b16 v[48:49], v16 offset:16384
ds_read_b64_tr_b16 v[50:51], v16 offset:16896
v_mul_f32 v188, v188, v84
v_mul_f32 v189, v189, v85
v_mul_f32 v190, v190, v86
v_mul_f32 v191, v191, v87
v_mfma_f32_32x32x16_bf16 v[112:127], v[32:35], a[164:167], v[112:127]
ds_read_b64_tr_b16 v[52:53], v16 offset:18432
ds_read_b64_tr_b16 v[54:55], v16 offset:18944
v_exp_f32 v188, v188
v_exp_f32 v189, v189
v_mfma_f32_16x16x32_bf16 v[164:167], a[224:227], v[32:35], v[164:167]
ds_read_b64_tr_b16 v[56:57], v16 offset:20480
v_exp_f32 v190, v190
v_mfma_f32_32x32x16_bf16 v[96:111], v[36:39], a[168:171], v[96:111]
ds_read_b64_tr_b16 v[58:59], v16 offset:20992
ds_read_b64_tr_b16 v[60:61], v16 offset:22528
v_exp_f32 v191, v191
v_fma_f32 v188, v188, v238, v238
v_fma_f32 v189, v189, v238, v238
v_fma_f32 v190, v190, v238, v238
v_mfma_f32_32x32x16_bf16 v[112:127], v[36:39], a[172:175], v[112:127]
ds_read_b64_tr_b16 v[62:63], v16 offset:23040
v_fma_f32 v191, v191, v238, v238
v_rcp_f32 v188, v188
v_rcp_f32 v189, v189
v_mfma_f32_16x16x32_bf16 v[164:167], a[224:227], v[36:39], v[164:167]
s_add_u32 s7, s73, 918016
s_add_u32 m0, s72, 0
v_mfma_f32_32x32x16_bf16 v[96:111], v[40:43], a[176:179], v[96:111]
buffer_load_dwordx4 v8, s[44:47], s7 offen offset:0 lds
v_rcp_f32 v190, v190
v_rcp_f32 v191, v191
v_mfma_f32_32x32x16_bf16 v[112:127], v[40:43], a[180:183], v[112:127]
buffer_load_dwordx4 v9, s[44:47], s7 offen offset:1024 lds
v_mul_f32 v188, v188, v84
v_mul_f32 v189, v189, v85
v_mfma_f32_16x16x32_bf16 v[164:167], a[224:227], v[40:43], v[164:167]
v_mul_f32 v190, v190, v86
v_mul_f32 v191, v191, v87
v_cvt_pk_bf16_f32 v202, v188, v189
v_mfma_f32_32x32x16_bf16 v[96:111], v[44:47], a[184:187], v[96:111]
buffer_load_dwordx4 v10, s[44:47], s7 offen offset:2048 lds
v_cvt_pk_bf16_f32 v203, v190, v191
v_mfma_f32_32x32x16_bf16 v[112:127], v[44:47], a[188:191], v[112:127]
buffer_load_dwordx4 v11, s[44:47], s7 offen offset:3072 lds
v_mul_f32 v184, v88, v88
v_mul_f32 v185, v89, v89
v_mfma_f32_16x16x32_bf16 v[164:167], a[224:227], v[44:47], v[164:167]
s_waitcnt vmcnt(16) lgkmcnt(0)
s_barrier
v_mfma_f32_32x32x16_bf16 v[96:111], v[48:51], a[192:195], v[96:111]
ds_read_b64_tr_b16 v[32:33], v16 offset:32768
ds_read_b64_tr_b16 v[34:35], v16 offset:33280
v_mul_f32 v186, v90, v90
v_mul_f32 v187, v91, v91
v_fma_f32 v184, v184, v237, v236
v_fma_f32 v185, v185, v237, v236
v_fma_f32 v186, v186, v237, v236
v_mfma_f32_32x32x16_bf16 v[112:127], v[48:51], a[196:199], v[112:127]
ds_read_b64_tr_b16 v[36:37], v16 offset:34816
ds_read_b64_tr_b16 v[38:39], v16 offset:35328
v_fma_f32 v187, v187, v237, v236
v_mul_f32 v184, v184, v88
v_mul_f32 v185, v185, v89
v_mul_f32 v186, v186, v90
v_mfma_f32_16x16x32_bf16 v[164:167], a[224:227], v[48:51], v[164:167]
ds_read_b64_tr_b16 v[40:41], v16 offset:36864
v_mul_f32 v187, v187, v91
v_mfma_f32_32x32x16_bf16 v[96:111], v[52:55], a[200:203], v[96:111]
ds_read_b64_tr_b16 v[42:43], v16 offset:37376
ds_read_b64_tr_b16 v[44:45], v16 offset:38912
v_exp_f32 v184, v184
v_exp_f32 v185, v185
v_exp_f32 v186, v186
v_mfma_f32_32x32x16_bf16 v[112:127], v[52:55], a[204:207], v[112:127]
ds_read_b64_tr_b16 v[46:47], v16 offset:39424
v_exp_f32 v187, v187
v_fma_f32 v184, v184, v238, v238
v_fma_f32 v185, v185, v238, v238
v_fma_f32 v186, v186, v238, v238
v_mfma_f32_16x16x32_bf16 v[164:167], a[224:227], v[52:55], v[164:167]
ds_write_b128 v22, v[200:203] offset:1024
s_add_u32 s7, s73, 1147392
s_add_u32 m0, s72, 16384
v_mfma_f32_32x32x16_bf16 v[96:111], v[56:59], a[208:211], v[96:111]
buffer_load_dwordx4 v8, s[44:47], s7 offen offset:0 lds
v_fma_f32 v187, v187, v238, v238
v_rcp_f32 v184, v184
v_mfma_f32_32x32x16_bf16 v[112:127], v[56:59], a[212:215], v[112:127]
buffer_load_dwordx4 v9, s[44:47], s7 offen offset:1024 lds
v_rcp_f32 v185, v185
v_rcp_f32 v186, v186
v_mfma_f32_16x16x32_bf16 v[164:167], a[224:227], v[56:59], v[164:167]
v_rcp_f32 v187, v187
v_mfma_f32_32x32x16_bf16 v[96:111], v[60:63], a[216:219], v[96:111]
buffer_load_dwordx4 v10, s[44:47], s7 offen offset:2048 lds
v_mul_f32 v184, v184, v88
v_mul_f32 v185, v185, v89
v_mul_f32 v186, v186, v90
v_mfma_f32_32x32x16_bf16 v[112:127], v[60:63], a[220:223], v[112:127]
buffer_load_dwordx4 v11, s[44:47], s7 offen offset:3072 lds
v_mul_f32 v187, v187, v91
v_cvt_pk_bf16_f32 v204, v184, v185
v_cvt_pk_bf16_f32 v205, v186, v187
v_mfma_f32_16x16x32_bf16 v[164:167], a[224:227], v[60:63], v[164:167]
s_waitcnt vmcnt(16) lgkmcnt(1)
s_barrier
v_mfma_f32_32x32x16_bf16 v[128:143], v[32:35], a[0:3], 0
ds_read_b64_tr_b16 v[48:49], v16 offset:49152
ds_read_b64_tr_b16 v[50:51], v16 offset:49664
v_mul_f32 v188, v92, v92
v_mul_f32 v189, v93, v93
v_mul_f32 v190, v94, v94
v_mul_f32 v191, v95, v95
v_mfma_f32_32x32x16_bf16 v[144:159], v[32:35], a[4:7], 0
ds_read_b64_tr_b16 v[52:53], v16 offset:51200
ds_read_b64_tr_b16 v[54:55], v16 offset:51712
v_cvt_pk_bf16_f32 v168, v164, v164
v_fma_f32 v188, v188, v237, v236
v_fma_f32 v189, v189, v237, v236
v_fma_f32 v190, v190, v237, v236
v_mfma_f32_16x16x32_bf16 v[160:163], a[224:227], v[32:35], 0
ds_read_b64_tr_b16 v[56:57], v16 offset:53248
v_fma_f32 v191, v191, v237, v236
v_mul_f32 v188, v188, v92
v_mfma_f32_32x32x16_bf16 v[128:143], v[36:39], a[8:11], v[128:143]
ds_read_b64_tr_b16 v[58:59], v16 offset:53760
ds_read_b64_tr_b16 v[60:61], v16 offset:55296
v_lshl_or_b32 v170, v173, 16, v173
v_mul_f32 v189, v189, v93
v_mul_f32 v190, v190, v94
v_mul_f32 v191, v191, v95
v_mfma_f32_32x32x16_bf16 v[144:159], v[36:39], a[12:15], v[144:159]
ds_read_b64_tr_b16 v[62:63], v16 offset:55808
v_and_b32 v175, 0xffff0000, v168
v_exp_f32 v188, v188
v_exp_f32 v189, v189
v_mfma_f32_16x16x32_bf16 v[160:163], a[224:227], v[36:39], v[160:163]
v_sub_f32 v175, v164, v175
v_exp_f32 v190, v190
v_mfma_f32_32x32x16_bf16 v[128:143], v[40:43], a[16:19], v[128:143]
s_add_u32 s7, s73, 1376768
s_add_u32 m0, s72, 32768
v_exp_f32 v191, v191
v_fma_f32 v188, v188, v238, v238
v_mfma_f32_32x32x16_bf16 v[144:159], v[40:43], a[20:23], v[144:159]
buffer_load_dwordx4 v8, s[44:47], s7 offen offset:0 lds
v_cvt_pk_bf16_f32 v169, v175, v175
v_fma_f32 v189, v189, v238, v238
v_fma_f32 v190, v190, v238, v238
v_mfma_f32_16x16x32_bf16 v[160:163], a[224:227], v[40:43], v[160:163]
buffer_load_dwordx4 v9, s[44:47], s7 offen offset:1024 lds
v_mfma_f32_32x32x16_bf16 v[128:143], v[44:47], a[24:27], v[128:143]
v_fma_f32 v191, v191, v238, v238
v_rcp_f32 v188, v188
v_rcp_f32 v189, v189
v_rcp_f32 v190, v190
v_mfma_f32_32x32x16_bf16 v[144:159], v[44:47], a[28:31], v[144:159]
buffer_load_dwordx4 v10, s[44:47], s7 offen offset:2048 lds
v_rcp_f32 v191, v191
v_mfma_f32_16x16x32_bf16 v[160:163], a[224:227], v[44:47], v[160:163]
v_mul_f32 v188, v188, v92
v_mul_f32 v189, v189, v93
v_mfma_f32_32x32x16_bf16 v[96:111], v[168:171], v[224:227], v[96:111]
buffer_load_dwordx4 v11, s[44:47], s7 offen offset:3072 lds
v_mul_f32 v190, v190, v94
v_mul_f32 v191, v191, v95
v_cvt_pk_bf16_f32 v206, v188, v189
v_mfma_f32_32x32x16_bf16 v[112:127], v[168:171], v[228:231], v[112:127]
v_cvt_pk_bf16_f32 v207, v190, v191
ds_write_b128 v22, v[204:207] offset:3072
s_waitcnt vmcnt(16) lgkmcnt(1)
s_barrier
v_mfma_f32_32x32x16_bf16 v[128:143], v[48:51], a[32:35], v[128:143]
ds_read_b64_tr_b16 v[32:33], v17 offset:0
ds_read_b64_tr_b16 v[34:35], v17 offset:512
v_mul_f32 v184, v96, v96
v_mul_f32 v185, v97, v97
v_mul_f32 v186, v98, v98
v_mul_f32 v187, v99, v99
v_fma_f32 v184, v184, v233, v232
v_fma_f32 v185, v185, v233, v232
v_mfma_f32_32x32x16_bf16 v[144:159], v[48:51], a[36:39], v[144:159]
ds_read_b64_tr_b16 v[36:37], v17 offset:2048
ds_read_b64_tr_b16 v[38:39], v17 offset:2560
v_fma_f32 v186, v186, v233, v232
v_fma_f32 v187, v187, v233, v232
v_mul_f32 v184, v184, v96
v_mul_f32 v185, v185, v97
v_mul_f32 v186, v186, v98
v_mfma_f32_16x16x32_bf16 v[160:163], a[224:227], v[48:51], v[160:163]
ds_read_b64_tr_b16 v[40:41], v17 offset:4096
v_mul_f32 v187, v187, v99
v_exp_f32 v184, v184
v_mfma_f32_32x32x16_bf16 v[128:143], v[52:55], a[40:43], v[128:143]
ds_read_b64_tr_b16 v[42:43], v17 offset:4608
ds_read_b64_tr_b16 v[44:45], v17 offset:6144
v_exp_f32 v185, v185
v_exp_f32 v186, v186
v_exp_f32 v187, v187
v_mfma_f32_32x32x16_bf16 v[144:159], v[52:55], a[44:47], v[144:159]
ds_read_b64_tr_b16 v[46:47], v17 offset:6656
v_fma_f32 v184, v184, v234, v234
v_fma_f32 v185, v185, v234, v234
v_fma_f32 v186, v186, v234, v234
v_fma_f32 v187, v187, v234, v234
v_rcp_f32 v184, v184
v_mfma_f32_16x16x32_bf16 v[160:163], a[224:227], v[52:55], v[160:163]
s_add_u32 s7, s74, 0
s_add_u32 m0, s72, 49152
v_rcp_f32 v185, v185
v_mfma_f32_32x32x16_bf16 v[128:143], v[56:59], a[48:51], v[128:143]
buffer_load_dwordx4 v12, s[52:55], s7 offen offset:0 lds
v_rcp_f32 v186, v186
v_rcp_f32 v187, v187
v_mfma_f32_32x32x16_bf16 v[144:159], v[56:59], a[52:55], v[144:159]
buffer_load_dwordx4 v13, s[52:55], s7 offen offset:1024 lds
v_mul_f32 v184, v184, v96
v_mul_f32 v185, v185, v97
v_mul_f32 v186, v186, v98
v_mfma_f32_16x16x32_bf16 v[160:163], a[224:227], v[56:59], v[160:163]
v_mul_f32 v187, v187, v99
v_cvt_pk_bf16_f32 v192, v184, v185
v_cvt_pk_bf16_f32 v193, v186, v187
v_mul_f32 v188, v100, v100
v_mfma_f32_32x32x16_bf16 v[128:143], v[60:63], a[56:59], v[128:143]
buffer_load_dwordx4 v14, s[52:55], s7 offen offset:2048 lds
v_mul_f32 v189, v101, v101
v_mul_f32 v190, v102, v102
v_mul_f32 v191, v103, v103
v_fma_f32 v188, v188, v233, v232
v_mfma_f32_32x32x16_bf16 v[144:159], v[60:63], a[60:63], v[144:159]
buffer_load_dwordx4 v15, s[52:55], s7 offen offset:3072 lds
v_fma_f32 v189, v189, v233, v232
v_fma_f32 v190, v190, v233, v232
v_fma_f32 v191, v191, v233, v232
v_mul_f32 v188, v188, v100
v_mfma_f32_16x16x32_bf16 v[160:163], a[224:227], v[60:63], v[160:163]
v_mul_f32 v189, v189, v101
s_lshl_b32 s96, s4, 3
buffer_load_dword v178, v7, s[64:67], s96 offen sc1
s_waitcnt vmcnt(17) lgkmcnt(0)
s_barrier
v_mfma_f32_32x32x16_bf16 v[128:143], v[32:35], a[64:67], v[128:143]
ds_read_b64_tr_b16 v[48:49], v17 offset:16384
ds_read_b64_tr_b16 v[50:51], v17 offset:16896
ds_read_b128 a[0:3], v24 offset:0
ds_read_b128 a[32:35], v24 offset:8192
v_mul_f32 v190, v190, v102
v_mul_f32 v191, v191, v103
v_exp_f32 v188, v188
v_mfma_f32_32x32x16_bf16 v[144:159], v[32:35], a[68:71], v[144:159]
ds_read_b64_tr_b16 v[52:53], v17 offset:18432
ds_read_b64_tr_b16 v[54:55], v17 offset:18944
v_exp_f32 v189, v189
v_exp_f32 v190, v190
v_exp_f32 v191, v191
v_mfma_f32_16x16x32_bf16 v[160:163], a[224:227], v[32:35], v[160:163]
ds_read_b64_tr_b16 v[56:57], v17 offset:20480
v_fma_f32 v188, v188, v234, v234
v_fma_f32 v189, v189, v234, v234
v_mfma_f32_32x32x16_bf16 v[128:143], v[36:39], a[72:75], v[128:143]
ds_read_b64_tr_b16 v[58:59], v17 offset:20992
ds_read_b64_tr_b16 v[60:61], v17 offset:22528
v_fma_f32 v190, v190, v234, v234
v_fma_f32 v191, v191, v234, v234
v_rcp_f32 v188, v188
v_rcp_f32 v189, v189
v_mfma_f32_32x32x16_bf16 v[144:159], v[36:39], a[76:79], v[144:159]
ds_read_b64_tr_b16 v[62:63], v17 offset:23040
v_rcp_f32 v190, v190
v_rcp_f32 v191, v191
v_mul_f32 v188, v188, v100
ds_read_b128 a[4:7], v25 offset:0
v_mfma_f32_16x16x32_bf16 v[160:163], a[224:227], v[36:39], v[160:163]
s_add_u32 s7, s74, 57344
s_add_u32 m0, s72, 65536
v_mul_f32 v189, v189, v101
v_mfma_f32_32x32x16_bf16 v[128:143], v[40:43], a[80:83], v[128:143]
buffer_load_dwordx4 v12, s[52:55], s7 offen offset:0 lds
v_mul_f32 v190, v190, v102
v_mul_f32 v191, v191, v103
v_cvt_pk_bf16_f32 v194, v188, v189
v_cvt_pk_bf16_f32 v195, v190, v191
v_mfma_f32_32x32x16_bf16 v[144:159], v[40:43], a[84:87], v[144:159]
buffer_load_dwordx4 v13, s[52:55], s7 offen offset:1024 lds
ds_write_b128 v22, v[192:195] offset:16384
v_mul_f32 v184, v104, v104
v_mfma_f32_16x16x32_bf16 v[160:163], a[224:227], v[40:43], v[160:163]
v_mul_f32 v185, v105, v105
v_mul_f32 v186, v106, v106
v_mul_f32 v187, v107, v107
v_fma_f32 v184, v184, v233, v232
v_mfma_f32_32x32x16_bf16 v[128:143], v[44:47], a[88:91], v[128:143]
buffer_load_dwordx4 v14, s[52:55], s7 offen offset:2048 lds
v_fma_f32 v185, v185, v233, v232
v_fma_f32 v186, v186, v233, v232
v_fma_f32 v187, v187, v233, v232
v_mul_f32 v184, v184, v104
v_mfma_f32_32x32x16_bf16 v[144:159], v[44:47], a[92:95], v[144:159]
buffer_load_dwordx4 v15, s[52:55], s7 offen offset:3072 lds
v_mul_f32 v185, v185, v105
v_mul_f32 v186, v186, v106
v_mul_f32 v187, v187, v107
v_mfma_f32_16x16x32_bf16 v[160:163], a[224:227], v[44:47], v[160:163]
v_exp_f32 v184, v184
s_waitcnt vmcnt(17) lgkmcnt(2)
s_barrier
v_mfma_f32_32x32x16_bf16 v[128:143], v[48:51], a[96:99], v[128:143]
ds_read_b64_tr_b16 v[32:33], v16 offset:0
ds_read_b64_tr_b16 v[34:35], v16 offset:512
ds_read_b128 a[8:11], v24 offset:2048
ds_read_b128 a[36:39], v25 offset:8192
v_exp_f32 v185, v185
v_exp_f32 v186, v186
v_mfma_f32_32x32x16_bf16 v[144:159], v[48:51], a[100:103], v[144:159]
ds_read_b64_tr_b16 v[36:37], v16 offset:2048
ds_read_b64_tr_b16 v[38:39], v16 offset:2560
v_exp_f32 v187, v187
v_fma_f32 v184, v184, v234, v234
v_fma_f32 v185, v185, v234, v234
v_fma_f32 v186, v186, v234, v234
v_mfma_f32_16x16x32_bf16 v[160:163], a[224:227], v[48:51], v[160:163]
ds_read_b64_tr_b16 v[40:41], v16 offset:4096
v_fma_f32 v187, v187, v234, v234
v_rcp_f32 v184, v184
v_mfma_f32_32x32x16_bf16 v[128:143], v[52:55], a[104:107], v[128:143]
ds_read_b64_tr_b16 v[42:43], v16 offset:4608
ds_read_b64_tr_b16 v[44:45], v16 offset:6144
v_rcp_f32 v185, v185
v_rcp_f32 v186, v186
v_mfma_f32_32x32x16_bf16 v[144:159], v[52:55], a[108:111], v[144:159]
ds_read_b64_tr_b16 v[46:47], v16 offset:6656
v_rcp_f32 v187, v187
v_mul_f32 v184, v184, v104
v_mul_f32 v185, v185, v105
v_mul_f32 v186, v186, v106
v_mul_f32 v187, v187, v107
ds_read_b128 a[12:15], v25 offset:2048
v_mfma_f32_16x16x32_bf16 v[160:163], a[224:227], v[52:55], v[160:163]
s_add_u32 s7, s74, 114688
s_add_u32 m0, s72, 81920
v_cvt_pk_bf16_f32 v196, v184, v185
v_cvt_pk_bf16_f32 v197, v186, v187
v_mfma_f32_32x32x16_bf16 v[128:143], v[56:59], a[112:115], v[128:143]
buffer_load_dwordx4 v12, s[52:55], s7 offen offset:0 lds
v_mul_f32 v188, v108, v108
v_mul_f32 v189, v109, v109
v_mul_f32 v190, v110, v110
v_mfma_f32_32x32x16_bf16 v[144:159], v[56:59], a[116:119], v[144:159]
buffer_load_dwordx4 v13, s[52:55], s7 offen offset:1024 lds
v_mul_f32 v191, v111, v111
v_fma_f32 v188, v188, v233, v232
v_fma_f32 v189, v189, v233, v232
v_fma_f32 v190, v190, v233, v232
v_mfma_f32_16x16x32_bf16 v[160:163], a[224:227], v[56:59], v[160:163]
v_fma_f32 v191, v191, v233, v232
v_mul_f32 v188, v188, v108
v_mul_f32 v189, v189, v109
v_mul_f32 v190, v190, v110
v_mfma_f32_32x32x16_bf16 v[128:143], v[60:63], a[120:123], v[128:143]
buffer_load_dwordx4 v14, s[52:55], s7 offen offset:2048 lds
v_mul_f32 v191, v191, v111
v_exp_f32 v188, v188
v_mfma_f32_32x32x16_bf16 v[144:159], v[60:63], a[124:127], v[144:159]
buffer_load_dwordx4 v15, s[52:55], s7 offen offset:3072 lds
v_exp_f32 v189, v189
v_exp_f32 v190, v190
v_mfma_f32_16x16x32_bf16 v[160:163], a[224:227], v[60:63], v[160:163]
v_exp_f32 v191, v191
s_waitcnt vmcnt(17) lgkmcnt(1)
s_barrier
v_mfma_f32_32x32x16_bf16 v[128:143], v[32:35], a[128:131], v[128:143]
ds_read_b64_tr_b16 v[48:49], v16 offset:16384
ds_read_b64_tr_b16 v[50:51], v16 offset:16896
ds_read_b128 a[16:19], v24 offset:4096
ds_read_b128 a[40:43], v24 offset:10240
v_fma_f32 v188, v188, v234, v234
v_fma_f32 v189, v189, v234, v234
v_fma_f32 v190, v190, v234, v234
v_mfma_f32_32x32x16_bf16 v[144:159], v[32:35], a[132:135], v[144:159]
ds_read_b64_tr_b16 v[52:53], v16 offset:18432
ds_read_b64_tr_b16 v[54:55], v16 offset:18944
v_fma_f32 v191, v191, v234, v234
v_rcp_f32 v188, v188
v_rcp_f32 v189, v189
v_mfma_f32_16x16x32_bf16 v[160:163], a[224:227], v[32:35], v[160:163]
ds_read_b64_tr_b16 v[56:57], v16 offset:20480
v_rcp_f32 v190, v190
v_rcp_f32 v191, v191
v_mfma_f32_32x32x16_bf16 v[128:143], v[36:39], a[136:139], v[128:143]
ds_read_b64_tr_b16 v[58:59], v16 offset:20992
ds_read_b64_tr_b16 v[60:61], v16 offset:22528
v_mul_f32 v188, v188, v108
v_mul_f32 v189, v189, v109
v_mul_f32 v190, v190, v110
v_mul_f32 v191, v191, v111
v_cvt_pk_bf16_f32 v198, v188, v189
v_mfma_f32_32x32x16_bf16 v[144:159], v[36:39], a[140:143], v[144:159]
ds_read_b64_tr_b16 v[62:63], v16 offset:23040
v_cvt_pk_bf16_f32 v199, v190, v191
v_mul_f32 v184, v112, v112
ds_read_b128 a[20:23], v25 offset:4096
v_mfma_f32_16x16x32_bf16 v[160:163], a[224:227], v[36:39], v[160:163]
ds_write_b128 v22, v[196:199] offset:18432
s_add_u32 s7, s74, 172032
s_add_u32 m0, s72, 0
ds_read_b128 a[44:47], v25 offset:10240
v_mul_f32 v185, v113, v113
v_mfma_f32_32x32x16_bf16 v[128:143], v[40:43], a[144:147], v[128:143]
buffer_load_dwordx4 v12, s[52:55], s7 offen offset:0 lds
v_mul_f32 v186, v114, v114
v_mul_f32 v187, v115, v115
v_fma_f32 v184, v184, v237, v236
v_mfma_f32_32x32x16_bf16 v[144:159], v[40:43], a[148:151], v[144:159]
buffer_load_dwordx4 v13, s[52:55], s7 offen offset:1024 lds
v_fma_f32 v185, v185, v237, v236
v_fma_f32 v186, v186, v237, v236
v_fma_f32 v187, v187, v237, v236
v_mul_f32 v184, v184, v112
v_mfma_f32_16x16x32_bf16 v[160:163], a[224:227], v[40:43], v[160:163]
v_mul_f32 v185, v185, v113
v_mul_f32 v186, v186, v114
v_mul_f32 v187, v187, v115
v_mfma_f32_32x32x16_bf16 v[128:143], v[44:47], a[152:155], v[128:143]
buffer_load_dwordx4 v14, s[52:55], s7 offen offset:2048 lds
v_exp_f32 v184, v184
v_exp_f32 v185, v185
v_mfma_f32_32x32x16_bf16 v[144:159], v[44:47], a[156:159], v[144:159]
buffer_load_dwordx4 v15, s[52:55], s7 offen offset:3072 lds
v_exp_f32 v186, v186
v_exp_f32 v187, v187
v_fma_f32 v184, v184, v238, v238
v_mfma_f32_16x16x32_bf16 v[160:163], a[224:227], v[44:47], v[160:163]
v_fma_f32 v185, v185, v238, v238
s_waitcnt vmcnt(17) lgkmcnt(3)
s_barrier
v_mfma_f32_32x32x16_bf16 v[128:143], v[48:51], a[160:163], v[128:143]
ds_read_b64_tr_b16 v[32:33], v16 offset:32768
ds_read_b64_tr_b16 v[34:35], v16 offset:33280
ds_read_b128 a[24:27], v24 offset:6144
ds_read_b128 a[48:51], v24 offset:12288
v_fma_f32 v186, v186, v238, v238
v_fma_f32 v187, v187, v238, v238
v_rcp_f32 v184, v184
v_mfma_f32_32x32x16_bf16 v[144:159], v[48:51], a[164:167], v[144:159]
ds_read_b64_tr_b16 v[36:37], v16 offset:34816
ds_read_b64_tr_b16 v[38:39], v16 offset:35328
v_rcp_f32 v185, v185
v_rcp_f32 v186, v186
v_mfma_f32_16x16x32_bf16 v[160:163], a[224:227], v[48:51], v[160:163]
ds_read_b64_tr_b16 v[40:41], v16 offset:36864
v_rcp_f32 v187, v187
v_mul_f32 v184, v184, v112
v_mfma_f32_32x32x16_bf16 v[128:143], v[52:55], a[168:171], v[128:143]
ds_read_b64_tr_b16 v[42:43], v16 offset:37376
ds_read_b64_tr_b16 v[44:45], v16 offset:38912
v_mul_f32 v185, v185, v113
v_mul_f32 v186, v186, v114
v_mul_f32 v187, v187, v115
v_cvt_pk_bf16_f32 v200, v184, v185
v_cvt_pk_bf16_f32 v201, v186, v187
v_mul_f32 v188, v116, v116
v_mfma_f32_32x32x16_bf16 v[144:159], v[52:55], a[172:175], v[144:159]
ds_read_b64_tr_b16 v[46:47], v16 offset:39424
v_mul_f32 v189, v117, v117
v_mul_f32 v190, v118, v118
v_mul_f32 v191, v119, v119
v_fma_f32 v188, v188, v237, v236
v_fma_f32 v189, v189, v237, v236
ds_read_b128 a[28:31], v25 offset:6144
v_mfma_f32_16x16x32_bf16 v[160:163], a[224:227], v[52:55], v[160:163]
s_add_u32 s7, s75, 0
s_add_u32 m0, s72, 16384
v_fma_f32 v190, v190, v237, v236
v_fma_f32 v191, v191, v237, v236
v_mfma_f32_32x32x16_bf16 v[128:143], v[56:59], a[176:179], v[128:143]
buffer_load_dwordx4 v12, s[52:55], s7 offen offset:0 lds
v_mul_f32 v188, v188, v116
v_mul_f32 v189, v189, v117
v_mul_f32 v190, v190, v118
v_mfma_f32_32x32x16_bf16 v[144:159], v[56:59], a[180:183], v[144:159]
buffer_load_dwordx4 v13, s[52:55], s7 offen offset:1024 lds
v_mul_f32 v191, v191, v119
v_exp_f32 v188, v188
v_exp_f32 v189, v189
v_mfma_f32_16x16x32_bf16 v[160:163], a[224:227], v[56:59], v[160:163]
v_exp_f32 v190, v190
v_mfma_f32_32x32x16_bf16 v[128:143], v[60:63], a[184:187], v[128:143]
buffer_load_dwordx4 v14, s[52:55], s7 offen offset:2048 lds
v_exp_f32 v191, v191
v_fma_f32 v188, v188, v238, v238
v_fma_f32 v189, v189, v238, v238
v_fma_f32 v190, v190, v238, v238
v_mfma_f32_32x32x16_bf16 v[144:159], v[60:63], a[188:191], v[144:159]
buffer_load_dwordx4 v15, s[52:55], s7 offen offset:3072 lds
v_fma_f32 v191, v191, v238, v238
v_rcp_f32 v188, v188
v_mfma_f32_16x16x32_bf16 v[160:163], a[224:227], v[60:63], v[160:163]
v_rcp_f32 v189, v189
s_waitcnt vmcnt(17) lgkmcnt(1)
s_barrier
v_mfma_f32_32x32x16_bf16 v[128:143], v[32:35], a[192:195], v[128:143]
ds_read_b64_tr_b16 v[48:49], v18 offset:49152
ds_read_b64_tr_b16 v[50:51], v18 offset:50176
ds_read_b128 a[52:55], v25 offset:12288
v_rcp_f32 v190, v190
v_rcp_f32 v191, v191
v_mul_f32 v188, v188, v116
v_mfma_f32_32x32x16_bf16 v[144:159], v[32:35], a[196:199], v[144:159]
ds_read_b64_tr_b16 v[52:53], v18 offset:51200
ds_read_b64_tr_b16 v[54:55], v18 offset:52224
v_mul_f32 v189, v189, v117
v_mul_f32 v190, v190, v118
v_mul_f32 v191, v191, v119
v_cvt_pk_bf16_f32 v202, v188, v189
v_cvt_pk_bf16_f32 v203, v190, v191
v_mfma_f32_16x16x32_bf16 v[160:163], a[224:227], v[32:35], v[160:163]
ds_read_b64_tr_b16 v[56:57], v18 offset:53248
v_mfma_f32_32x32x16_bf16 v[128:143], v[36:39], a[200:203], v[128:143]
ds_read_b64_tr_b16 v[58:59], v18 offset:54272
ds_read_b64_tr_b16 v[60:61], v18 offset:55296
v_mul_f32 v184, v120, v120
v_mul_f32 v185, v121, v121
ds_read_b128 a[56:59], v24 offset:14336
v_mul_f32 v186, v122, v122
v_mul_f32 v187, v123, v123
v_mfma_f32_32x32x16_bf16 v[144:159], v[36:39], a[204:207], v[144:159]
ds_read_b64_tr_b16 v[62:63], v18 offset:56320
v_fma_f32 v184, v184, v237, v236
v_fma_f32 v185, v185, v237, v236
v_fma_f32 v186, v186, v237, v236
v_fma_f32 v187, v187, v237, v236
v_mul_f32 v184, v184, v120
v_mul_f32 v185, v185, v121
v_mul_f32 v186, v186, v122
v_mfma_f32_16x16x32_bf16 v[160:163], a[224:227], v[36:39], v[160:163]
ds_write_b128 v22, v[200:203] offset:17408
s_add_u32 s7, s75, 57344
s_add_u32 m0, s72, 32768
v_mul_f32 v187, v187, v123
v_mfma_f32_32x32x16_bf16 v[128:143], v[40:43], a[208:211], v[128:143]
buffer_load_dwordx4 v12, s[52:55], s7 offen offset:0 lds
v_exp_f32 v184, v184
v_exp_f32 v185, v185
v_mfma_f32_32x32x16_bf16 v[144:159], v[40:43], a[212:215], v[144:159]
buffer_load_dwordx4 v13, s[52:55], s7 offen offset:1024 lds
v_exp_f32 v186, v186
ds_read_b128 a[60:63], v25 offset:14336
v_exp_f32 v187, v187
v_mfma_f32_16x16x32_bf16 v[160:163], a[224:227], v[40:43], v[160:163]
v_fma_f32 v184, v184, v238, v238
v_fma_f32 v185, v185, v238, v238
v_fma_f32 v186, v186, v238, v238
v_mfma_f32_32x32x16_bf16 v[128:143], v[44:47], a[216:219], v[128:143]
buffer_load_dwordx4 v14, s[52:55], s7 offen offset:2048 lds
v_fma_f32 v187, v187, v238, v238
v_rcp_f32 v184, v184
v_mfma_f32_32x32x16_bf16 v[144:159], v[44:47], a[220:223], v[144:159]
buffer_load_dwordx4 v15, s[52:55], s7 offen offset:3072 lds
v_rcp_f32 v185, v185
v_rcp_f32 v186, v186
v_mfma_f32_16x16x32_bf16 v[160:163], a[224:227], v[44:47], v[160:163]
v_rcp_f32 v187, v187
s_waitcnt vmcnt(16) lgkmcnt(2)
s_barrier
v_mfma_f32_32x32x16_bf16 v[64:79], v[48:51], a[0:3], 0
ds_read_b64_tr_b16 v[32:33], v19 offset:0
ds_read_b64_tr_b16 v[34:35], v19 offset:1024
v_mul_f32 v184, v184, v120
v_mul_f32 v185, v185, v121
v_mul_f32 v186, v186, v122
v_mul_f32 v187, v187, v123
v_cvt_pk_bf16_f32 v204, v184, v185
v_cvt_pk_bf16_f32 v205, v186, v187
v_mul_f32 v188, v124, v124
v_mul_f32 v189, v125, v125
v_mfma_f32_32x32x16_bf16 v[80:95], v[48:51], a[4:7], 0
ds_read_b64_tr_b16 v[36:37], v19 offset:2048
ds_read_b64_tr_b16 v[38:39], v19 offset:3072
v_cvt_pk_bf16_f32 v168, v160, v160
v_mul_f32 v190, v126, v126
v_mul_f32 v191, v127, v127
v_fma_f32 v188, v188, v237, v236
v_fma_f32 v189, v189, v237, v236
v_fma_f32 v190, v190, v237, v236
v_fma_f32 v191, v191, v237, v236
v_mul_f32 v188, v188, v124
v_mfma_f32_32x32x16_bf16 v[64:79], v[52:55], a[8:11], v[64:79]
ds_read_b64_tr_b16 v[40:41], v19 offset:4096
ds_read_b64_tr_b16 v[42:43], v19 offset:5120
v_lshl_or_b32 v170, v174, 16, v174
v_mul_f32 v189, v189, v125
v_mul_f32 v190, v190, v126
v_mul_f32 v191, v191, v127
v_exp_f32 v188, v188
v_exp_f32 v189, v189
v_mfma_f32_32x32x16_bf16 v[80:95], v[52:55], a[12:15], v[80:95]
ds_read_b64_tr_b16 v[44:45], v19 offset:6144
ds_read_b64_tr_b16 v[46:47], v19 offset:7168
v_and_b32 v175, 0xffff0000, v168
v_exp_f32 v190, v190
v_exp_f32 v191, v191
v_fma_f32 v188, v188, v238, v238
v_fma_f32 v189, v189, v238, v238
v_mfma_f32_32x32x16_bf16 v[64:79], v[56:59], a[16:19], v[64:79]
s_add_u32 s7, s75, 114688
s_add_u32 m0, s72, 49152
v_sub_f32 v175, v160, v175
v_fma_f32 v190, v190, v238, v238
v_fma_f32 v191, v191, v238, v238
v_rcp_f32 v188, v188
v_rcp_f32 v189, v189
v_rcp_f32 v190, v190
v_mfma_f32_32x32x16_bf16 v[80:95], v[56:59], a[20:23], v[80:95]
buffer_load_dwordx4 v12, s[52:55], s7 offen offset:0 lds
v_cvt_pk_bf16_f32 v169, v175, v175
v_rcp_f32 v191, v191
v_mul_f32 v188, v188, v124
v_mul_f32 v189, v189, v125
v_mul_f32 v190, v190, v126
v_mfma_f32_32x32x16_bf16 v[64:79], v[60:63], a[24:27], v[64:79]
buffer_load_dwordx4 v13, s[52:55], s7 offen offset:1024 lds
v_mul_f32 v191, v191, v127
v_cvt_pk_bf16_f32 v206, v188, v189
v_cvt_pk_bf16_f32 v207, v190, v191
ds_write_b128 v22, v[204:207] offset:19456
v_mfma_f32_32x32x16_bf16 v[80:95], v[60:63], a[28:31], v[80:95]
buffer_load_dwordx4 v14, s[52:55], s7 offen offset:2048 lds
v_mfma_f32_32x32x16_bf16 v[128:143], v[168:171], v[224:227], v[128:143]
buffer_load_dwordx4 v15, s[52:55], s7 offen offset:3072 lds
v_mfma_f32_32x32x16_bf16 v[144:159], v[168:171], v[228:231], v[144:159]
s_waitcnt vmcnt(16) lgkmcnt(0)
s_barrier
v_mfma_f32_32x32x16_bf16 v[64:79], v[32:35], a[32:35], v[64:79]
ds_read_b64_tr_b16 v[48:49], v19 offset:16384
ds_read_b64_tr_b16 v[50:51], v19 offset:17408
ds_read_b128 a[64:67], v24 offset:16384
s_nop 3
v_mul_f32 v184, v128, v128
v_mul_f32 v185, v129, v129
v_mul_f32 v186, v130, v130
v_mul_f32 v187, v131, v131
v_fma_f32 v184, v184, v233, v232
v_fma_f32 v185, v185, v233, v232
v_fma_f32 v186, v186, v233, v232
v_mfma_f32_32x32x16_bf16 v[80:95], v[32:35], a[36:39], v[80:95]
ds_read_b64_tr_b16 v[52:53], v19 offset:18432
ds_read_b64_tr_b16 v[54:55], v19 offset:19456
ds_read_b128 a[68:71], v25 offset:16384
v_fma_f32 v187, v187, v233, v232
v_mul_f32 v184, v184, v128
v_mul_f32 v185, v185, v129
v_mul_f32 v186, v186, v130
v_mul_f32 v187, v187, v131
v_exp_f32 v184, v184
v_mfma_f32_32x32x16_bf16 v[64:79], v[36:39], a[40:43], v[64:79]
ds_read_b64_tr_b16 v[56:57], v19 offset:20480
ds_read_b64_tr_b16 v[58:59], v19 offset:21504
ds_read_b128 a[72:75], v24 offset:18432
v_exp_f32 v185, v185
v_exp_f32 v186, v186
v_exp_f32 v187, v187
v_fma_f32 v184, v184, v234, v234
v_mfma_f32_32x32x16_bf16 v[80:95], v[36:39], a[44:47], v[80:95]
ds_read_b64_tr_b16 v[60:61], v19 offset:22528
ds_read_b64_tr_b16 v[62:63], v19 offset:23552
ds_read_b128 a[76:79], v25 offset:18432
s_add_u32 s7, s75, 172032
s_add_u32 m0, s72, 65536
v_fma_f32 v185, v185, v234, v234
v_fma_f32 v186, v186, v234, v234
v_fma_f32 v187, v187, v234, v234
v_rcp_f32 v184, v184
v_mfma_f32_32x32x16_bf16 v[64:79], v[40:43], a[48:51], v[64:79]
ds_read_b128 a[80:83], v24 offset:20480
ds_read_b128 a[84:87], v25 offset:20480
buffer_load_dwordx4 v12, s[52:55], s7 offen offset:0 lds
v_rcp_f32 v185, v185
v_rcp_f32 v186, v186
v_rcp_f32 v187, v187
v_mfma_f32_32x32x16_bf16 v[80:95], v[40:43], a[52:55], v[80:95]
ds_read_b128 a[88:91], v24 offset:22528
ds_read_b128 a[92:95], v25 offset:22528
buffer_load_dwordx4 v13, s[52:55], s7 offen offset:1024 lds
v_mul_f32 v184, v184, v128
v_mul_f32 v185, v185, v129
v_mul_f32 v186, v186, v130
v_mul_f32 v187, v187, v131
v_mfma_f32_32x32x16_bf16 v[64:79], v[44:47], a[56:59], v[64:79]
buffer_load_dwordx4 v14, s[52:55], s7 offen offset:2048 lds
v_cvt_pk_bf16_f32 v192, v184, v185
v_cvt_pk_bf16_f32 v193, v186, v187
v_mul_f32 v188, v132, v132
v_mul_f32 v189, v133, v133
v_mul_f32 v190, v134, v134
v_mul_f32 v191, v135, v135
v_mfma_f32_32x32x16_bf16 v[80:95], v[44:47], a[60:63], v[80:95]
buffer_load_dwordx4 v15, s[52:55], s7 offen offset:3072 lds
v_fma_f32 v188, v188, v233, v232
v_fma_f32 v189, v189, v233, v232
v_fma_f32 v190, v190, v233, v232
v_fma_f32 v191, v191, v233, v232
v_mul_f32 v188, v188, v132
s_waitcnt vmcnt(16) lgkmcnt(5)
s_barrier
v_mfma_f32_32x32x16_bf16 v[64:79], v[48:51], a[64:67], v[64:79]
ds_read_b64_tr_b16 v[32:33], v18 offset:0
ds_read_b64_tr_b16 v[34:35], v18 offset:1024
ds_read_b128 a[96:99], v24 offset:24576
v_mul_f32 v189, v189, v133
v_mul_f32 v190, v190, v134
v_mul_f32 v191, v191, v135
v_exp_f32 v188, v188
v_exp_f32 v189, v189
v_mfma_f32_32x32x16_bf16 v[80:95], v[48:51], a[68:71], v[80:95]
ds_read_b64_tr_b16 v[36:37], v18 offset:2048
ds_read_b64_tr_b16 v[38:39], v18 offset:3072
ds_read_b128 a[100:103], v25 offset:24576
v_exp_f32 v190, v190
v_exp_f32 v191, v191
v_fma_f32 v188, v188, v234, v234
v_fma_f32 v189, v189, v234, v234
v_fma_f32 v190, v190, v234, v234
v_fma_f32 v191, v191, v234, v234
v_mfma_f32_32x32x16_bf16 v[64:79], v[52:55], a[72:75], v[64:79]
ds_read_b64_tr_b16 v[40:41], v18 offset:4096
ds_read_b64_tr_b16 v[42:43], v18 offset:5120
ds_read_b128 a[104:107], v24 offset:26624
v_rcp_f32 v188, v188
v_rcp_f32 v189, v189
v_rcp_f32 v190, v190
s_waitcnt lgkmcnt(13)
v_mfma_f32_32x32x16_bf16 v[80:95], v[52:55], a[76:79], v[80:95]
ds_read_b64_tr_b16 v[44:45], v18 offset:6144
ds_read_b64_tr_b16 v[46:47], v18 offset:7168
ds_read_b128 a[108:111], v25 offset:26624
s_add_u32 s7, s74, 229376
s_add_u32 m0, s72, 81920
v_rcp_f32 v191, v191
v_mul_f32 v188, v188, v132
v_mul_f32 v189, v189, v133
v_mul_f32 v190, v190, v134
v_mul_f32 v191, v191, v135
s_waitcnt lgkmcnt(15)
v_mfma_f32_32x32x16_bf16 v[64:79], v[56:59], a[80:83], v[64:79]
ds_read_b128 a[112:115], v24 offset:28672
ds_read_b128 a[116:119], v25 offset:28672
buffer_load_dwordx4 v12, s[52:55], s7 offen offset:0 lds
v_cvt_pk_bf16_f32 v194, v188, v189
v_cvt_pk_bf16_f32 v195, v190, v191
ds_write_b128 v22, v[192:195] offset:32768
s_waitcnt lgkmcnt(15)
v_mfma_f32_32x32x16_bf16 v[80:95], v[56:59], a[84:87], v[80:95]
ds_read_b128 a[120:123], v24 offset:30720
ds_read_b128 a[124:127], v25 offset:30720
buffer_load_dwordx4 v13, s[52:55], s7 offen offset:1024 lds
v_mul_f32 v184, v136, v136
v_mul_f32 v185, v137, v137
v_mul_f32 v186, v138, v138
v_mul_f32 v187, v139, v139
v_fma_f32 v184, v184, v233, v232
v_mfma_f32_32x32x16_bf16 v[64:79], v[60:63], a[88:91], v[64:79]
buffer_load_dwordx4 v14, s[52:55], s7 offen offset:2048 lds
v_fma_f32 v185, v185, v233, v232
v_fma_f32 v186, v186, v233, v232
v_fma_f32 v187, v187, v233, v232
v_mul_f32 v184, v184, v136
v_mul_f32 v185, v185, v137
v_mul_f32 v186, v186, v138
v_mfma_f32_32x32x16_bf16 v[80:95], v[60:63], a[92:95], v[80:95]
buffer_load_dwordx4 v15, s[52:55], s7 offen offset:3072 lds
v_mul_f32 v187, v187, v139
v_exp_f32 v184, v184
v_exp_f32 v185, v185
s_waitcnt vmcnt(16) lgkmcnt(6)
s_barrier
v_mfma_f32_32x32x16_bf16 v[64:79], v[32:35], a[96:99], v[64:79]
ds_read_b64_tr_b16 v[48:49], v18 offset:16384
ds_read_b64_tr_b16 v[50:51], v18 offset:17408
v_exp_f32 v186, v186
v_exp_f32 v187, v187
v_fma_f32 v184, v184, v234, v234
v_fma_f32 v185, v185, v234, v234
v_fma_f32 v186, v186, v234, v234
v_fma_f32 v187, v187, v234, v234
v_mfma_f32_32x32x16_bf16 v[80:95], v[32:35], a[100:103], v[80:95]
ds_read_b64_tr_b16 v[52:53], v18 offset:18432
ds_read_b64_tr_b16 v[54:55], v18 offset:19456
v_rcp_f32 v184, v184
v_rcp_f32 v185, v185
v_rcp_f32 v186, v186
v_rcp_f32 v187, v187
v_mfma_f32_32x32x16_bf16 v[64:79], v[36:39], a[104:107], v[64:79]
ds_read_b64_tr_b16 v[56:57], v18 offset:20480
ds_read_b64_tr_b16 v[58:59], v18 offset:21504
v_mul_f32 v184, v184, v136
v_mul_f32 v185, v185, v137
v_mul_f32 v186, v186, v138
v_mul_f32 v187, v187, v139
v_cvt_pk_bf16_f32 v196, v184, v185
v_cvt_pk_bf16_f32 v197, v186, v187
v_mul_f32 v188, v140, v140
v_mul_f32 v189, v141, v141
s_waitcnt lgkmcnt(11)
v_mfma_f32_32x32x16_bf16 v[80:95], v[36:39], a[108:111], v[80:95]
ds_read_b64_tr_b16 v[60:61], v18 offset:22528
ds_read_b64_tr_b16 v[62:63], v18 offset:23552
s_add_u32 s7, s74, 286720
s_add_u32 m0, s72, 0
v_mul_f32 v190, v142, v142
v_mul_f32 v191, v143, v143
v_fma_f32 v188, v188, v233, v232
v_fma_f32 v189, v189, v233, v232
v_fma_f32 v190, v190, v233, v232
v_fma_f32 v191, v191, v233, v232
v_mul_f32 v188, v188, v140
s_waitcnt lgkmcnt(12)
v_mfma_f32_32x32x16_bf16 v[64:79], v[40:43], a[112:115], v[64:79]
buffer_load_dwordx4 v12, s[52:55], s7 offen offset:0 lds
v_mul_f32 v189, v189, v141
v_mul_f32 v190, v190, v142
v_mul_f32 v191, v191, v143
v_exp_f32 v188, v188
v_exp_f32 v189, v189
s_waitcnt lgkmcnt(11)
v_mfma_f32_32x32x16_bf16 v[80:95], v[40:43], a[116:119], v[80:95]
buffer_load_dwordx4 v13, s[52:55], s7 offen offset:1024 lds
v_exp_f32 v190, v190
v_exp_f32 v191, v191
v_fma_f32 v188, v188, v234, v234
v_fma_f32 v189, v189, v234, v234
s_waitcnt lgkmcnt(9)
v_mfma_f32_32x32x16_bf16 v[64:79], v[44:47], a[120:123], v[64:79]
buffer_load_dwordx4 v14, s[52:55], s7 offen offset:2048 lds
v_fma_f32 v190, v190, v234, v234
v_fma_f32 v191, v191, v234, v234
v_rcp_f32 v188, v188
v_rcp_f32 v189, v189
s_waitcnt lgkmcnt(8)
v_mfma_f32_32x32x16_bf16 v[80:95], v[44:47], a[124:127], v[80:95]
buffer_load_dwordx4 v15, s[52:55], s7 offen offset:3072 lds
v_rcp_f32 v190, v190
v_rcp_f32 v191, v191
v_mul_f32 v188, v188, v140
s_waitcnt vmcnt(16) lgkmcnt(0)
s_barrier
v_mfma_f32_32x32x16_bf16 v[96:111], v[48:51], a[0:3], 0
ds_read_b64_tr_b16 v[32:33], v18 offset:32768
ds_read_b64_tr_b16 v[34:35], v18 offset:33792
v_mul_f32 v189, v189, v141
v_mul_f32 v190, v190, v142
v_mul_f32 v191, v191, v143
v_cvt_pk_bf16_f32 v198, v188, v189
v_cvt_pk_bf16_f32 v199, v190, v191
v_mfma_f32_32x32x16_bf16 v[112:127], v[48:51], a[4:7], 0
ds_read_b64_tr_b16 v[36:37], v18 offset:34816
ds_read_b64_tr_b16 v[38:39], v18 offset:35840
v_mul_f32 v184, v144, v144
v_mul_f32 v185, v145, v145
v_mul_f32 v186, v146, v146
v_mul_f32 v187, v147, v147
v_fma_f32 v184, v184, v237, v236
v_fma_f32 v185, v185, v237, v236
v_fma_f32 v186, v186, v237, v236
v_fma_f32 v187, v187, v237, v236
v_mfma_f32_32x32x16_bf16 v[96:111], v[52:55], a[8:11], v[96:111]
ds_read_b64_tr_b16 v[40:41], v18 offset:36864
ds_read_b64_tr_b16 v[42:43], v18 offset:37888
v_mul_f32 v184, v184, v144
v_mul_f32 v185, v185, v145
v_mul_f32 v186, v186, v146
v_mul_f32 v187, v187, v147
v_exp_f32 v184, v184
v_exp_f32 v185, v185
v_mfma_f32_32x32x16_bf16 v[112:127], v[52:55], a[12:15], v[112:127]
ds_read_b64_tr_b16 v[44:45], v18 offset:38912
ds_read_b64_tr_b16 v[46:47], v18 offset:39936
s_add_u32 s7, s75, 229376
s_add_u32 m0, s72, 16384
v_exp_f32 v186, v186
v_exp_f32 v187, v187
v_fma_f32 v184, v184, v238, v238
v_fma_f32 v185, v185, v238, v238
v_fma_f32 v186, v186, v238, v238
v_mfma_f32_32x32x16_bf16 v[96:111], v[56:59], a[16:19], v[96:111]
ds_write_b128 v22, v[196:199] offset:34816
buffer_load_dwordx4 v12, s[52:55], s7 offen offset:0 lds
v_fma_f32 v187, v187, v238, v238
v_rcp_f32 v184, v184
v_rcp_f32 v185, v185
v_rcp_f32 v186, v186
v_mfma_f32_32x32x16_bf16 v[112:127], v[56:59], a[20:23], v[112:127]
buffer_load_dwordx4 v13, s[52:55], s7 offen offset:1024 lds
v_rcp_f32 v187, v187
v_mul_f32 v184, v184, v144
v_mul_f32 v185, v185, v145
v_mul_f32 v186, v186, v146
v_mul_f32 v187, v187, v147
v_mfma_f32_32x32x16_bf16 v[96:111], v[60:63], a[24:27], v[96:111]
buffer_load_dwordx4 v14, s[52:55], s7 offen offset:2048 lds
v_cvt_pk_bf16_f32 v200, v184, v185
v_cvt_pk_bf16_f32 v201, v186, v187
v_mul_f32 v188, v148, v148
v_mul_f32 v189, v149, v149
v_mul_f32 v190, v150, v150
v_mul_f32 v191, v151, v151
v_mfma_f32_32x32x16_bf16 v[112:127], v[60:63], a[28:31], v[112:127]
buffer_load_dwordx4 v15, s[52:55], s7 offen offset:3072 lds
v_fma_f32 v188, v188, v237, v236
v_fma_f32 v189, v189, v237, v236
v_fma_f32 v190, v190, v237, v236
v_fma_f32 v191, v191, v237, v236
v_mul_f32 v188, v188, v148
s_waitcnt vmcnt(16) lgkmcnt(1)
s_barrier
v_mfma_f32_32x32x16_bf16 v[96:111], v[32:35], a[32:35], v[96:111]
ds_read_b64_tr_b16 v[48:49], v18 offset:49152
ds_read_b64_tr_b16 v[50:51], v18 offset:50176
v_mul_f32 v189, v189, v149
v_mul_f32 v190, v190, v150
v_mul_f32 v191, v191, v151
v_exp_f32 v188, v188
v_exp_f32 v189, v189
v_exp_f32 v190, v190
v_mfma_f32_32x32x16_bf16 v[112:127], v[32:35], a[36:39], v[112:127]
ds_read_b64_tr_b16 v[52:53], v18 offset:51200
ds_read_b64_tr_b16 v[54:55], v18 offset:52224
v_exp_f32 v191, v191
v_fma_f32 v188, v188, v238, v238
v_fma_f32 v189, v189, v238, v238
v_fma_f32 v190, v190, v238, v238
v_fma_f32 v191, v191, v238, v238
v_rcp_f32 v188, v188
v_mfma_f32_32x32x16_bf16 v[96:111], v[36:39], a[40:43], v[96:111]
ds_read_b64_tr_b16 v[56:57], v18 offset:53248
ds_read_b64_tr_b16 v[58:59], v18 offset:54272
v_rcp_f32 v189, v189
v_rcp_f32 v190, v190
v_rcp_f32 v191, v191
v_mul_f32 v188, v188, v148
v_mul_f32 v189, v189, v149
v_mfma_f32_32x32x16_bf16 v[112:127], v[36:39], a[44:47], v[112:127]
ds_read_b64_tr_b16 v[60:61], v18 offset:55296
ds_read_b64_tr_b16 v[62:63], v18 offset:56320
s_add_u32 s7, s75, 286720
s_add_u32 m0, s72, 32768
v_mul_f32 v190, v190, v150
v_mul_f32 v191, v191, v151
v_cvt_pk_bf16_f32 v202, v188, v189
v_cvt_pk_bf16_f32 v203, v190, v191
v_mfma_f32_32x32x16_bf16 v[96:111], v[40:43], a[48:51], v[96:111]
ds_write_b128 v22, v[200:203] offset:33792
buffer_load_dwordx4 v12, s[52:55], s7 offen offset:0 lds
v_mul_f32 v184, v152, v152
v_mul_f32 v185, v153, v153
v_mul_f32 v186, v154, v154
v_mul_f32 v187, v155, v155
v_fma_f32 v184, v184, v237, v236
v_fma_f32 v185, v185, v237, v236
v_mfma_f32_32x32x16_bf16 v[112:127], v[40:43], a[52:55], v[112:127]
buffer_load_dwordx4 v13, s[52:55], s7 offen offset:1024 lds
v_fma_f32 v186, v186, v237, v236
v_fma_f32 v187, v187, v237, v236
v_mul_f32 v184, v184, v152
v_mul_f32 v185, v185, v153
v_mul_f32 v186, v186, v154
v_mul_f32 v187, v187, v155
v_mfma_f32_32x32x16_bf16 v[96:111], v[44:47], a[56:59], v[96:111]
buffer_load_dwordx4 v14, s[52:55], s7 offen offset:2048 lds
v_exp_f32 v184, v184
v_exp_f32 v185, v185
v_exp_f32 v186, v186
v_exp_f32 v187, v187
v_mfma_f32_32x32x16_bf16 v[112:127], v[44:47], a[60:63], v[112:127]
buffer_load_dwordx4 v15, s[52:55], s7 offen offset:3072 lds
v_fma_f32 v184, v184, v238, v238
v_fma_f32 v185, v185, v238, v238
v_fma_f32 v186, v186, v238, v238
v_fma_f32 v187, v187, v238, v238
s_waitcnt vmcnt(16) lgkmcnt(1)
s_barrier
v_mfma_f32_32x32x16_bf16 v[96:111], v[48:51], a[64:67], v[96:111]
ds_read_b64_tr_b16 v[32:33], v19 offset:0
ds_read_b64_tr_b16 v[34:35], v19 offset:1024
v_rcp_f32 v184, v184
v_rcp_f32 v185, v185
v_rcp_f32 v186, v186
v_rcp_f32 v187, v187
v_mul_f32 v184, v184, v152
v_mul_f32 v185, v185, v153
v_mfma_f32_32x32x16_bf16 v[112:127], v[48:51], a[68:71], v[112:127]
ds_read_b64_tr_b16 v[36:37], v19 offset:2048
ds_read_b64_tr_b16 v[38:39], v19 offset:3072
v_mul_f32 v186, v186, v154
v_mul_f32 v187, v187, v155
v_cvt_pk_bf16_f32 v204, v184, v185
v_cvt_pk_bf16_f32 v205, v186, v187
v_mul_f32 v188, v156, v156
v_mul_f32 v189, v157, v157
v_mul_f32 v190, v158, v158
v_mul_f32 v191, v159, v159
v_fma_f32 v188, v188, v237, v236
v_fma_f32 v189, v189, v237, v236
v_mfma_f32_32x32x16_bf16 v[96:111], v[52:55], a[72:75], v[96:111]
ds_read_b64_tr_b16 v[40:41], v19 offset:4096
ds_read_b64_tr_b16 v[42:43], v19 offset:5120
v_fma_f32 v190, v190, v237, v236
v_fma_f32 v191, v191, v237, v236
v_mul_f32 v188, v188, v156
v_mul_f32 v189, v189, v157
v_mul_f32 v190, v190, v158
v_mul_f32 v191, v191, v159
v_exp_f32 v188, v188
v_exp_f32 v189, v189
v_mfma_f32_32x32x16_bf16 v[112:127], v[52:55], a[76:79], v[112:127]
ds_read_b64_tr_b16 v[44:45], v19 offset:6144
ds_read_b64_tr_b16 v[46:47], v19 offset:7168
s_add_u32 s7, s76, 0
s_add_u32 m0, s72, 49152
v_exp_f32 v190, v190
v_exp_f32 v191, v191
v_fma_f32 v188, v188, v238, v238
v_fma_f32 v189, v189, v238, v238
v_fma_f32 v190, v190, v238, v238
v_fma_f32 v191, v191, v238, v238
v_mfma_f32_32x32x16_bf16 v[96:111], v[56:59], a[80:83], v[96:111]
buffer_load_dwordx4 v12, s[52:55], s7 offen offset:0 lds
v_rcp_f32 v188, v188
v_rcp_f32 v189, v189
v_rcp_f32 v190, v190
v_rcp_f32 v191, v191
v_mul_f32 v188, v188, v156
v_mfma_f32_32x32x16_bf16 v[112:127], v[56:59], a[84:87], v[112:127]
buffer_load_dwordx4 v13, s[52:55], s7 offen offset:1024 lds
v_mul_f32 v189, v189, v157
v_mul_f32 v190, v190, v158
v_mul_f32 v191, v191, v159
v_cvt_pk_bf16_f32 v206, v188, v189
v_cvt_pk_bf16_f32 v207, v190, v191
ds_write_b128 v22, v[204:207] offset:35840
v_mfma_f32_32x32x16_bf16 v[96:111], v[60:63], a[88:91], v[96:111]
buffer_load_dwordx4 v14, s[52:55], s7 offen offset:2048 lds
v_mfma_f32_32x32x16_bf16 v[112:127], v[60:63], a[92:95], v[112:127]
buffer_load_dwordx4 v15, s[52:55], s7 offen offset:3072 lds
s_waitcnt vmcnt(16) lgkmcnt(0)
s_barrier
v_mfma_f32_32x32x16_bf16 v[96:111], v[32:35], a[96:99], v[96:111]
ds_read_b64_tr_b16 v[48:49], v19 offset:16384
ds_read_b64_tr_b16 v[50:51], v19 offset:17408
ds_read_b128 a[128:131], v24 offset:32768
v_mfma_f32_32x32x16_bf16 v[112:127], v[32:35], a[100:103], v[112:127]
ds_read_b64_tr_b16 v[52:53], v19 offset:18432
ds_read_b64_tr_b16 v[54:55], v19 offset:19456
ds_read_b128 a[132:135], v25 offset:32768
v_mfma_f32_32x32x16_bf16 v[96:111], v[36:39], a[104:107], v[96:111]
ds_read_b64_tr_b16 v[56:57], v19 offset:20480
ds_read_b64_tr_b16 v[58:59], v19 offset:21504
ds_read_b128 a[136:139], v24 offset:34816
v_mfma_f32_32x32x16_bf16 v[112:127], v[36:39], a[108:111], v[112:127]
ds_read_b64_tr_b16 v[60:61], v19 offset:22528
ds_read_b64_tr_b16 v[62:63], v19 offset:23552
ds_read_b128 a[140:143], v25 offset:34816
s_add_u32 s7, s76, 57344
s_add_u32 m0, s72, 65536
v_mfma_f32_32x32x16_bf16 v[96:111], v[40:43], a[112:115], v[96:111]
ds_read_b128 a[144:147], v24 offset:36864
ds_read_b128 a[148:151], v25 offset:36864
buffer_load_dwordx4 v12, s[52:55], s7 offen offset:0 lds
v_mfma_f32_32x32x16_bf16 v[112:127], v[40:43], a[116:119], v[112:127]
ds_read_b128 a[152:155], v24 offset:38912
ds_read_b128 a[156:159], v25 offset:38912
buffer_load_dwordx4 v13, s[52:55], s7 offen offset:1024 lds
v_mfma_f32_32x32x16_bf16 v[96:111], v[44:47], a[120:123], v[96:111]
buffer_load_dwordx4 v14, s[52:55], s7 offen offset:2048 lds
v_mfma_f32_32x32x16_bf16 v[112:127], v[44:47], a[124:127], v[112:127]
buffer_load_dwordx4 v15, s[52:55], s7 offen offset:3072 lds
s_waitcnt vmcnt(16) lgkmcnt(5)
s_barrier
v_mfma_f32_32x32x16_bf16 v[64:79], v[48:51], a[128:131], v[64:79]
ds_read_b64_tr_b16 v[32:33], v18 offset:0
ds_read_b64_tr_b16 v[34:35], v18 offset:1024
ds_read_b128 a[160:163], v24 offset:40960
v_mfma_f32_32x32x16_bf16 v[80:95], v[48:51], a[132:135], v[80:95]
ds_read_b64_tr_b16 v[36:37], v18 offset:2048
ds_read_b64_tr_b16 v[38:39], v18 offset:3072
ds_read_b128 a[164:167], v25 offset:40960
v_mfma_f32_32x32x16_bf16 v[64:79], v[52:55], a[136:139], v[64:79]
ds_read_b64_tr_b16 v[40:41], v18 offset:4096
ds_read_b64_tr_b16 v[42:43], v18 offset:5120
ds_read_b128 a[168:171], v24 offset:43008
s_waitcnt lgkmcnt(13)
v_mfma_f32_32x32x16_bf16 v[80:95], v[52:55], a[140:143], v[80:95]
ds_read_b64_tr_b16 v[44:45], v18 offset:6144
ds_read_b64_tr_b16 v[46:47], v18 offset:7168
ds_read_b128 a[172:175], v25 offset:43008
s_add_u32 s7, s76, 114688
s_add_u32 m0, s72, 81920
s_waitcnt lgkmcnt(15)
v_mfma_f32_32x32x16_bf16 v[64:79], v[56:59], a[144:147], v[64:79]
ds_read_b128 a[176:179], v24 offset:45056
ds_read_b128 a[180:183], v25 offset:45056
buffer_load_dwordx4 v12, s[52:55], s7 offen offset:0 lds
s_waitcnt lgkmcnt(15)
v_mfma_f32_32x32x16_bf16 v[80:95], v[56:59], a[148:151], v[80:95]
ds_read_b128 a[184:187], v24 offset:47104
ds_read_b128 a[188:191], v25 offset:47104
buffer_load_dwordx4 v13, s[52:55], s7 offen offset:1024 lds
v_mfma_f32_32x32x16_bf16 v[64:79], v[60:63], a[152:155], v[64:79]
buffer_load_dwordx4 v14, s[52:55], s7 offen offset:2048 lds
s_waitcnt lgkmcnt(15)
v_mfma_f32_32x32x16_bf16 v[80:95], v[60:63], a[156:159], v[80:95]
buffer_load_dwordx4 v15, s[52:55], s7 offen offset:3072 lds
s_waitcnt vmcnt(16) lgkmcnt(5)
s_barrier
v_mfma_f32_32x32x16_bf16 v[64:79], v[32:35], a[160:163], v[64:79]
ds_read_b64_tr_b16 v[48:49], v18 offset:16384
ds_read_b64_tr_b16 v[50:51], v18 offset:17408
ds_read_b128 v[208:211], v5 offset:0
v_mfma_f32_32x32x16_bf16 v[80:95], v[32:35], a[164:167], v[80:95]
ds_read_b64_tr_b16 v[52:53], v18 offset:18432
ds_read_b64_tr_b16 v[54:55], v18 offset:19456
ds_read_b128 v[212:215], v5 offset:32
v_mfma_f32_32x32x16_bf16 v[64:79], v[36:39], a[168:171], v[64:79]
ds_read_b64_tr_b16 v[56:57], v18 offset:20480
ds_read_b64_tr_b16 v[58:59], v18 offset:21504
ds_read_b128 v[216:219], v5 offset:64
s_waitcnt lgkmcnt(13)
v_mfma_f32_32x32x16_bf16 v[80:95], v[36:39], a[172:175], v[80:95]
ds_read_b64_tr_b16 v[60:61], v18 offset:22528
ds_read_b64_tr_b16 v[62:63], v18 offset:23552
ds_read_b128 v[220:223], v5 offset:96
s_add_u32 s7, s76, 172032
s_add_u32 m0, s72, 0
s_waitcnt lgkmcnt(15)
v_mfma_f32_32x32x16_bf16 v[64:79], v[40:43], a[176:179], v[64:79]
buffer_load_dwordx4 v12, s[52:55], s7 offen offset:0 lds
s_waitcnt lgkmcnt(14)
v_mfma_f32_32x32x16_bf16 v[80:95], v[40:43], a[180:183], v[80:95]
buffer_load_dwordx4 v13, s[52:55], s7 offen offset:1024 lds
s_waitcnt lgkmcnt(13)
v_mfma_f32_32x32x16_bf16 v[64:79], v[44:47], a[184:187], v[64:79]
buffer_load_dwordx4 v14, s[52:55], s7 offen offset:2048 lds
s_waitcnt lgkmcnt(12)
v_mfma_f32_32x32x16_bf16 v[80:95], v[44:47], a[188:191], v[80:95]
buffer_load_dwordx4 v15, s[52:55], s7 offen offset:3072 lds
s_waitcnt vmcnt(16) lgkmcnt(1)
s_barrier
v_mfma_f32_32x32x16_bf16 v[96:111], v[48:51], a[128:131], v[96:111]
ds_read_b64_tr_b16 v[32:33], v18 offset:32768
ds_read_b64_tr_b16 v[34:35], v18 offset:33792
v_mfma_f32_32x32x16_bf16 v[112:127], v[48:51], a[132:135], v[112:127]
ds_read_b64_tr_b16 v[36:37], v18 offset:34816
ds_read_b64_tr_b16 v[38:39], v18 offset:35840
v_cvt_pk_bf16_f32 v192, v64, v65
v_cvt_pk_bf16_f32 v193, v66, v67
v_lshlrev_b32 v224, 16, v240
v_mfma_f32_32x32x16_bf16 v[96:111], v[52:55], a[136:139], v[96:111]
ds_read_b64_tr_b16 v[40:41], v18 offset:36864
ds_read_b64_tr_b16 v[42:43], v18 offset:37888
v_cvt_pk_bf16_f32 v194, v68, v69
v_cvt_pk_bf16_f32 v195, v70, v71
v_mfma_f32_32x32x16_bf16 v[112:127], v[52:55], a[140:143], v[112:127]
ds_read_b64_tr_b16 v[44:45], v18 offset:38912
ds_read_b64_tr_b16 v[46:47], v18 offset:39936
s_add_u32 s7, s76, 229376
s_add_u32 m0, s72, 16384
buffer_store_dwordx4 v[192:195], v27, s[68:71], s78 offen offset:0 sc1
v_mfma_f32_32x32x16_bf16 v[96:111], v[56:59], a[144:147], v[96:111]
buffer_load_dwordx4 v12, s[52:55], s7 offen offset:0 lds
v_and_b32 v225, 0xffff0000, v240
v_mfma_f32_32x32x16_bf16 v[112:127], v[56:59], a[148:151], v[112:127]
buffer_load_dwordx4 v13, s[52:55], s7 offen offset:1024 lds
v_cvt_pk_bf16_f32 v196, v72, v73
v_cvt_pk_bf16_f32 v197, v74, v75
v_mfma_f32_32x32x16_bf16 v[96:111], v[60:63], a[152:155], v[96:111]
buffer_load_dwordx4 v14, s[52:55], s7 offen offset:2048 lds
v_cvt_pk_bf16_f32 v198, v76, v77
v_cvt_pk_bf16_f32 v199, v78, v79
v_mfma_f32_32x32x16_bf16 v[112:127], v[60:63], a[156:159], v[112:127]
buffer_load_dwordx4 v15, s[52:55], s7 offen offset:3072 lds
buffer_store_dwordx4 v[196:199], v27, s[68:71], s78 offen offset:1024 sc1
s_waitcnt vmcnt(18) lgkmcnt(0)
s_barrier
v_mfma_f32_32x32x16_bf16 v[96:111], v[32:35], a[160:163], v[96:111]
ds_read_b64_tr_b16 v[48:49], v18 offset:49152
ds_read_b64_tr_b16 v[50:51], v18 offset:50176
v_mfma_f32_32x32x16_bf16 v[112:127], v[32:35], a[164:167], v[112:127]
ds_read_b64_tr_b16 v[52:53], v18 offset:51200
ds_read_b64_tr_b16 v[54:55], v18 offset:52224
v_cvt_pk_bf16_f32 v200, v80, v81
v_cvt_pk_bf16_f32 v201, v82, v83
v_add_f32 v208, v208, v224
v_mfma_f32_32x32x16_bf16 v[96:111], v[36:39], a[168:171], v[96:111]
ds_read_b64_tr_b16 v[56:57], v18 offset:53248
ds_read_b64_tr_b16 v[58:59], v18 offset:54272
v_cvt_pk_bf16_f32 v202, v84, v85
v_cvt_pk_bf16_f32 v203, v86, v87
v_mfma_f32_32x32x16_bf16 v[112:127], v[36:39], a[172:175], v[112:127]
ds_read_b64_tr_b16 v[60:61], v18 offset:55296
ds_read_b64_tr_b16 v[62:63], v18 offset:56320
s_add_u32 s7, s76, 286720
s_add_u32 m0, s72, 32768
buffer_store_dwordx4 v[200:203], v28, s[68:71], s78 offen offset:0 sc1
v_mfma_f32_32x32x16_bf16 v[96:111], v[40:43], a[176:179], v[96:111]
buffer_load_dwordx4 v12, s[52:55], s7 offen offset:0 lds
v_add_f32 v209, v209, v225
v_mfma_f32_32x32x16_bf16 v[112:127], v[40:43], a[180:183], v[112:127]
buffer_load_dwordx4 v13, s[52:55], s7 offen offset:1024 lds
v_cvt_pk_bf16_f32 v204, v88, v89
v_cvt_pk_bf16_f32 v205, v90, v91
v_mfma_f32_32x32x16_bf16 v[96:111], v[44:47], a[184:187], v[96:111]
buffer_load_dwordx4 v14, s[52:55], s7 offen offset:2048 lds
v_cvt_pk_bf16_f32 v206, v92, v93
v_cvt_pk_bf16_f32 v207, v94, v95
v_mfma_f32_32x32x16_bf16 v[112:127], v[44:47], a[188:191], v[112:127]
buffer_load_dwordx4 v15, s[52:55], s7 offen offset:3072 lds
buffer_store_dwordx4 v[204:207], v28, s[68:71], s78 offen offset:1024 sc1
s_waitcnt vmcnt(20) lgkmcnt(0)
s_barrier
v_mfma_f32_32x32x16_bf16 v[128:143], v[48:51], a[0:3], 0
ds_read_b64_tr_b16 v[32:33], v19 offset:0
ds_read_b64_tr_b16 v[34:35], v19 offset:1024
v_lshlrev_b32 v226, 16, v241
v_mfma_f32_32x32x16_bf16 v[144:159], v[48:51], a[4:7], 0
ds_read_b64_tr_b16 v[36:37], v19 offset:2048
ds_read_b64_tr_b16 v[38:39], v19 offset:3072
v_cvt_pk_bf16_f32 v192, v96, v97
v_cvt_pk_bf16_f32 v193, v98, v99
v_mfma_f32_32x32x16_bf16 v[128:143], v[52:55], a[8:11], v[128:143]
ds_read_b64_tr_b16 v[40:41], v19 offset:4096
ds_read_b64_tr_b16 v[42:43], v19 offset:5120
v_cvt_pk_bf16_f32 v194, v100, v101
v_cvt_pk_bf16_f32 v195, v102, v103
v_mfma_f32_32x32x16_bf16 v[144:159], v[52:55], a[12:15], v[144:159]
ds_read_b64_tr_b16 v[44:45], v19 offset:6144
ds_read_b64_tr_b16 v[46:47], v19 offset:7168
s_add_u32 s7, s77, 0
s_add_u32 m0, s72, 49152
v_and_b32 v227, 0xffff0000, v241
buffer_store_dwordx4 v[192:195], v27, s[68:71], s79 offen offset:0 sc1
v_mfma_f32_32x32x16_bf16 v[128:143], v[56:59], a[16:19], v[128:143]
buffer_load_dwordx4 v12, s[52:55], s7 offen offset:0 lds
v_mfma_f32_32x32x16_bf16 v[144:159], v[56:59], a[20:23], v[144:159]
buffer_load_dwordx4 v13, s[52:55], s7 offen offset:1024 lds
v_cvt_pk_bf16_f32 v196, v104, v105
v_cvt_pk_bf16_f32 v197, v106, v107
v_add_f32 v210, v210, v226
v_mfma_f32_32x32x16_bf16 v[128:143], v[60:63], a[24:27], v[128:143]
buffer_load_dwordx4 v14, s[52:55], s7 offen offset:2048 lds
v_cvt_pk_bf16_f32 v198, v108, v109
v_cvt_pk_bf16_f32 v199, v110, v111
v_mfma_f32_32x32x16_bf16 v[144:159], v[60:63], a[28:31], v[144:159]
buffer_load_dwordx4 v15, s[52:55], s7 offen offset:3072 lds
buffer_store_dwordx4 v[196:199], v27, s[68:71], s79 offen offset:1024 sc1
s_waitcnt vmcnt(22) lgkmcnt(0)
s_barrier
v_mfma_f32_32x32x16_bf16 v[128:143], v[32:35], a[32:35], v[128:143]
ds_read_b64_tr_b16 v[48:49], v19 offset:16384
ds_read_b64_tr_b16 v[50:51], v19 offset:17408
v_mfma_f32_32x32x16_bf16 v[144:159], v[32:35], a[36:39], v[144:159]
ds_read_b64_tr_b16 v[52:53], v19 offset:18432
ds_read_b64_tr_b16 v[54:55], v19 offset:19456
v_cvt_pk_bf16_f32 v200, v112, v113
v_cvt_pk_bf16_f32 v201, v114, v115
v_add_f32 v211, v211, v227
v_mfma_f32_32x32x16_bf16 v[128:143], v[36:39], a[40:43], v[128:143]
ds_read_b64_tr_b16 v[56:57], v19 offset:20480
ds_read_b64_tr_b16 v[58:59], v19 offset:21504
v_cvt_pk_bf16_f32 v202, v116, v117
v_cvt_pk_bf16_f32 v203, v118, v119
v_mfma_f32_32x32x16_bf16 v[144:159], v[36:39], a[44:47], v[144:159]
ds_read_b64_tr_b16 v[60:61], v19 offset:22528
ds_read_b64_tr_b16 v[62:63], v19 offset:23552
s_add_u32 s7, s77, 114688
s_add_u32 m0, s72, 65536
buffer_store_dwordx4 v[200:203], v28, s[68:71], s79 offen offset:0 sc1
v_mfma_f32_32x32x16_bf16 v[128:143], v[40:43], a[48:51], v[128:143]
buffer_load_dwordx4 v12, s[52:55], s7 offen offset:0 lds
v_lshlrev_b32 v224, 16, v242
v_mfma_f32_32x32x16_bf16 v[144:159], v[40:43], a[52:55], v[144:159]
buffer_load_dwordx4 v13, s[52:55], s7 offen offset:1024 lds
v_cvt_pk_bf16_f32 v204, v120, v121
v_cvt_pk_bf16_f32 v205, v122, v123
v_mfma_f32_32x32x16_bf16 v[128:143], v[44:47], a[56:59], v[128:143]
buffer_load_dwordx4 v14, s[52:55], s7 offen offset:2048 lds
v_cvt_pk_bf16_f32 v206, v124, v125
v_cvt_pk_bf16_f32 v207, v126, v127
v_mfma_f32_32x32x16_bf16 v[144:159], v[44:47], a[60:63], v[144:159]
buffer_load_dwordx4 v15, s[52:55], s7 offen offset:3072 lds
buffer_store_dwordx4 v[204:207], v28, s[68:71], s79 offen offset:1024 sc1
s_waitcnt vmcnt(24) lgkmcnt(0)
s_barrier
v_mfma_f32_32x32x16_bf16 v[128:143], v[48:51], a[64:67], v[128:143]
ds_read_b64_tr_b16 v[32:33], v18 offset:0
ds_read_b64_tr_b16 v[34:35], v18 offset:1024
v_and_b32 v225, 0xffff0000, v242
v_add_f32 v212, v212, v224
v_mfma_f32_32x32x16_bf16 v[144:159], v[48:51], a[68:71], v[144:159]
ds_read_b64_tr_b16 v[36:37], v18 offset:2048
ds_read_b64_tr_b16 v[38:39], v18 offset:3072
v_add_f32 v213, v213, v225
v_lshlrev_b32 v226, 16, v243
v_mfma_f32_32x32x16_bf16 v[128:143], v[52:55], a[72:75], v[128:143]
ds_read_b64_tr_b16 v[40:41], v18 offset:4096
ds_read_b64_tr_b16 v[42:43], v18 offset:5120
v_and_b32 v227, 0xffff0000, v243
v_add_f32 v214, v214, v226
v_mfma_f32_32x32x16_bf16 v[144:159], v[52:55], a[76:79], v[144:159]
ds_read_b64_tr_b16 v[44:45], v18 offset:6144
ds_read_b64_tr_b16 v[46:47], v18 offset:7168
s_add_u32 s7, s77, 229376
s_add_u32 m0, s72, 81920
v_add_f32 v215, v215, v227
v_mfma_f32_32x32x16_bf16 v[128:143], v[56:59], a[80:83], v[128:143]
buffer_load_dwordx4 v12, s[52:55], s7 offen offset:0 lds
v_lshlrev_b32 v224, 16, v244
v_and_b32 v225, 0xffff0000, v244
v_mfma_f32_32x32x16_bf16 v[144:159], v[56:59], a[84:87], v[144:159]
buffer_load_dwordx4 v13, s[52:55], s7 offen offset:1024 lds
v_add_f32 v216, v216, v224
v_mfma_f32_32x32x16_bf16 v[128:143], v[60:63], a[88:91], v[128:143]
buffer_load_dwordx4 v14, s[52:55], s7 offen offset:2048 lds
v_add_f32 v217, v217, v225
v_lshlrev_b32 v226, 16, v245
v_mfma_f32_32x32x16_bf16 v[144:159], v[60:63], a[92:95], v[144:159]
buffer_load_dwordx4 v15, s[52:55], s7 offen offset:3072 lds
v_mov_b32 v4, 1
s_waitcnt vmcnt(16)
buffer_store_dword v4, v7, s[68:71], s24 offen sc1
s_waitcnt lgkmcnt(0)
s_barrier
v_mfma_f32_32x32x16_bf16 v[128:143], v[32:35], a[96:99], v[128:143]
ds_read_b64_tr_b16 v[48:49], v18 offset:16384
ds_read_b64_tr_b16 v[50:51], v18 offset:17408
v_and_b32 v227, 0xffff0000, v245
v_mfma_f32_32x32x16_bf16 v[144:159], v[32:35], a[100:103], v[144:159]
ds_read_b64_tr_b16 v[52:53], v18 offset:18432
ds_read_b64_tr_b16 v[54:55], v18 offset:19456
v_add_f32 v218, v218, v226
v_mfma_f32_32x32x16_bf16 v[128:143], v[36:39], a[104:107], v[128:143]
ds_read_b64_tr_b16 v[56:57], v18 offset:20480
ds_read_b64_tr_b16 v[58:59], v18 offset:21504
v_add_f32 v219, v219, v227
v_mfma_f32_32x32x16_bf16 v[144:159], v[36:39], a[108:111], v[144:159]
ds_read_b64_tr_b16 v[60:61], v18 offset:22528
ds_read_b64_tr_b16 v[62:63], v18 offset:23552
v_lshlrev_b32 v224, 16, v246
v_and_b32 v225, 0xffff0000, v246
v_mfma_f32_32x32x16_bf16 v[128:143], v[40:43], a[112:115], v[128:143]
v_add_f32 v220, v220, v224
v_mfma_f32_32x32x16_bf16 v[144:159], v[40:43], a[116:119], v[144:159]
v_add_f32 v221, v221, v225
v_lshlrev_b32 v226, 16, v247
v_mfma_f32_32x32x16_bf16 v[128:143], v[44:47], a[120:123], v[128:143]
v_and_b32 v227, 0xffff0000, v247
v_add_f32 v222, v222, v226
v_mfma_f32_32x32x16_bf16 v[144:159], v[44:47], a[124:127], v[144:159]
v_add_f32 v223, v223, v227
s_waitcnt lgkmcnt(0)
s_barrier
v_mfma_f32_32x32x16_bf16 v[128:143], v[48:51], a[128:131], v[128:143]
ds_read_b64_tr_b16 v[32:33], v18 offset:32768
ds_read_b64_tr_b16 v[34:35], v18 offset:33792
v_mfma_f32_32x32x16_bf16 v[144:159], v[48:51], a[132:135], v[144:159]
ds_read_b64_tr_b16 v[36:37], v18 offset:34816
ds_read_b64_tr_b16 v[38:39], v18 offset:35840
v_mfma_f32_32x32x16_bf16 v[128:143], v[52:55], a[136:139], v[128:143]
ds_read_b64_tr_b16 v[40:41], v18 offset:36864
ds_read_b64_tr_b16 v[42:43], v18 offset:37888
v_mfma_f32_32x32x16_bf16 v[144:159], v[52:55], a[140:143], v[144:159]
ds_read_b64_tr_b16 v[44:45], v18 offset:38912
ds_read_b64_tr_b16 v[46:47], v18 offset:39936
v_mfma_f32_32x32x16_bf16 v[128:143], v[56:59], a[144:147], v[128:143]
v_mfma_f32_32x32x16_bf16 v[144:159], v[56:59], a[148:151], v[144:159]
v_mfma_f32_32x32x16_bf16 v[128:143], v[60:63], a[152:155], v[128:143]
v_mfma_f32_32x32x16_bf16 v[144:159], v[60:63], a[156:159], v[144:159]
v_mov_b32 v4, 2
s_waitcnt vmcnt(5)
buffer_store_dword v4, v7, s[68:71], s24 offen offset:128 sc1
s_waitcnt lgkmcnt(0)
s_barrier
v_mfma_f32_32x32x16_bf16 v[128:143], v[32:35], a[160:163], v[128:143]
ds_read_b64_tr_b16 a[224:225], v20 offset:49152
ds_read_b64_tr_b16 a[226:227], v20 offset:50176
v_mfma_f32_32x32x16_bf16 v[144:159], v[32:35], a[164:167], v[144:159]
ds_read_b64_tr_b16 a[228:229], v20 offset:51200
ds_read_b64_tr_b16 a[230:231], v20 offset:52224
v_mfma_f32_32x32x16_bf16 v[128:143], v[36:39], a[168:171], v[128:143]
ds_read_b64_tr_b16 a[232:233], v20 offset:53248
ds_read_b64_tr_b16 a[234:235], v20 offset:54272
v_mfma_f32_32x32x16_bf16 v[144:159], v[36:39], a[172:175], v[144:159]
ds_read_b64_tr_b16 a[236:237], v20 offset:55296
ds_read_b64_tr_b16 a[238:239], v20 offset:56320
v_mfma_f32_32x32x16_bf16 v[128:143], v[40:43], a[176:179], v[128:143]
ds_read_b64_tr_b16 a[240:241], v20 offset:57344
ds_read_b64_tr_b16 a[242:243], v20 offset:58368
v_mfma_f32_32x32x16_bf16 v[144:159], v[40:43], a[180:183], v[144:159]
ds_read_b64_tr_b16 a[244:245], v20 offset:59392
ds_read_b64_tr_b16 a[246:247], v20 offset:60416
v_mfma_f32_32x32x16_bf16 v[128:143], v[44:47], a[184:187], v[128:143]
ds_read_b64_tr_b16 a[248:249], v20 offset:61440
ds_read_b64_tr_b16 a[250:251], v20 offset:62464
v_mfma_f32_32x32x16_bf16 v[144:159], v[44:47], a[188:191], v[144:159]
ds_read_b64_tr_b16 a[252:253], v20 offset:63488
ds_read_b64_tr_b16 a[254:255], v20 offset:64512
s_waitcnt lgkmcnt(0)
s_barrier
v_mfma_f32_32x32x16_bf16 v[208:223], a[224:227], a[0:3], v[208:223]
ds_read_b64_tr_b16 a[192:193], v21 offset:0
ds_read_b64_tr_b16 a[194:195], v21 offset:1024
v_mfma_f32_32x32x16_bf16 v[208:223], a[228:231], a[8:11], v[208:223]
ds_read_b64_tr_b16 a[196:197], v21 offset:2048
ds_read_b64_tr_b16 a[198:199], v21 offset:3072
v_cvt_pk_bf16_f32 v192, v128, v129
v_cvt_pk_bf16_f32 v196, v136, v137
v_cvt_pk_bf16_f32 v200, v144, v145
v_cvt_pk_bf16_f32 v193, v130, v131
v_cvt_pk_bf16_f32 v197, v138, v139
v_cvt_pk_bf16_f32 v201, v146, v147
v_mfma_f32_32x32x16_bf16 v[208:223], a[232:235], a[16:19], v[208:223]
ds_read_b64_tr_b16 a[200:201], v21 offset:4096
ds_read_b64_tr_b16 a[202:203], v21 offset:5120
v_cvt_pk_bf16_f32 v194, v132, v133
v_cvt_pk_bf16_f32 v198, v140, v141
v_cvt_pk_bf16_f32 v202, v148, v149
v_cvt_pk_bf16_f32 v195, v134, v135
v_cvt_pk_bf16_f32 v199, v142, v143
v_cvt_pk_bf16_f32 v203, v150, v151
v_mfma_f32_32x32x16_bf16 v[208:223], a[236:239], a[24:27], v[208:223]
ds_read_b64_tr_b16 a[204:205], v21 offset:6144
ds_read_b64_tr_b16 a[206:207], v21 offset:7168
buffer_store_dwordx4 v[192:195], v27, s[68:71], s80 offen offset:0 sc1
buffer_store_dwordx4 v[196:199], v27, s[68:71], s80 offen offset:1024 sc1
buffer_store_dwordx4 v[200:203], v28, s[68:71], s80 offen offset:0 sc1
v_mfma_f32_32x32x16_bf16 v[208:223], a[240:243], a[32:35], v[208:223]
ds_read_b64_tr_b16 a[208:209], v21 offset:8192
ds_read_b64_tr_b16 a[210:211], v21 offset:9216
v_mfma_f32_32x32x16_bf16 v[208:223], a[244:247], a[40:43], v[208:223]
ds_read_b64_tr_b16 a[212:213], v21 offset:10240
ds_read_b64_tr_b16 a[214:215], v21 offset:11264
v_cvt_pk_bf16_f32 v204, v152, v153
v_cvt_pk_bf16_f32 v205, v154, v155
v_mfma_f32_32x32x16_bf16 v[208:223], a[248:251], a[48:51], v[208:223]
ds_read_b64_tr_b16 a[216:217], v21 offset:12288
ds_read_b64_tr_b16 a[218:219], v21 offset:13312
v_cvt_pk_bf16_f32 v206, v156, v157
v_cvt_pk_bf16_f32 v207, v158, v159
v_mfma_f32_32x32x16_bf16 v[208:223], a[252:255], a[56:59], v[208:223]
ds_read_b64_tr_b16 a[220:221], v21 offset:14336
ds_read_b64_tr_b16 a[222:223], v21 offset:15360
buffer_store_dwordx4 v[204:207], v28, s[68:71], s80 offen offset:1024 sc1
s_waitcnt vmcnt(6) lgkmcnt(0)
s_barrier
v_mfma_f32_32x32x16_bf16 v[208:223], a[192:195], a[64:67], v[208:223]
ds_read_b64_tr_b16 a[224:225], v21 offset:16384
ds_read_b64_tr_b16 a[226:227], v21 offset:17408
v_mfma_f32_32x32x16_bf16 v[208:223], a[196:199], a[72:75], v[208:223]
ds_read_b64_tr_b16 a[228:229], v21 offset:18432
ds_read_b64_tr_b16 a[230:231], v21 offset:19456
v_mfma_f32_32x32x16_bf16 v[208:223], a[200:203], a[80:83], v[208:223]
ds_read_b64_tr_b16 a[232:233], v21 offset:20480
ds_read_b64_tr_b16 a[234:235], v21 offset:21504
v_mfma_f32_32x32x16_bf16 v[208:223], a[204:207], a[88:91], v[208:223]
ds_read_b64_tr_b16 a[236:237], v21 offset:22528
ds_read_b64_tr_b16 a[238:239], v21 offset:23552
v_mfma_f32_32x32x16_bf16 v[208:223], a[208:211], a[96:99], v[208:223]
ds_read_b64_tr_b16 a[240:241], v21 offset:24576
ds_read_b64_tr_b16 a[242:243], v21 offset:25600
v_mfma_f32_32x32x16_bf16 v[208:223], a[212:215], a[104:107], v[208:223]
ds_read_b64_tr_b16 a[244:245], v21 offset:26624
ds_read_b64_tr_b16 a[246:247], v21 offset:27648
v_mfma_f32_32x32x16_bf16 v[208:223], a[216:219], a[112:115], v[208:223]
ds_read_b64_tr_b16 a[248:249], v21 offset:28672
ds_read_b64_tr_b16 a[250:251], v21 offset:29696
v_mfma_f32_32x32x16_bf16 v[208:223], a[220:223], a[120:123], v[208:223]
ds_read_b64_tr_b16 a[252:253], v21 offset:30720
ds_read_b64_tr_b16 a[254:255], v21 offset:31744
s_waitcnt lgkmcnt(14)
v_mfma_f32_32x32x16_bf16 v[208:223], a[224:227], a[128:131], v[208:223]
s_waitcnt lgkmcnt(12)
v_mfma_f32_32x32x16_bf16 v[208:223], a[228:231], a[136:139], v[208:223]
s_waitcnt lgkmcnt(10)
v_mfma_f32_32x32x16_bf16 v[208:223], a[232:235], a[144:147], v[208:223]
s_waitcnt lgkmcnt(8)
v_mfma_f32_32x32x16_bf16 v[208:223], a[236:239], a[152:155], v[208:223]
s_waitcnt lgkmcnt(6)
v_mfma_f32_32x32x16_bf16 v[208:223], a[240:243], a[160:163], v[208:223]
s_waitcnt lgkmcnt(4)
v_mfma_f32_32x32x16_bf16 v[208:223], a[244:247], a[168:171], v[208:223]
s_waitcnt lgkmcnt(2)
v_mfma_f32_32x32x16_bf16 v[208:223], a[248:251], a[176:179], v[208:223]
s_waitcnt lgkmcnt(0)
v_mfma_f32_32x32x16_bf16 v[208:223], a[252:255], a[184:187], v[208:223]
s_nop 7
s_nop 3
v_readfirstlane_b32 s28, v178
v_mov_b32 v4, 3
s_waitcnt vmcnt(0)
buffer_load_dword v253, v249, s[68:71], s86 offen sc1
buffer_store_dword v4, v7, s[68:71], s24 offen offset:256 sc1
s_mov_b32 s30, 2097152
s_mov_b32 s59, 127
s_mov_b32 s26, 0
s_mov_b32 s27, 0
s_cmp_ge_u32 s28, 8
s_waitcnt vmcnt(1)
s_cbranch_scc1 Lm_see
s_lshl_b32 s97, s4, 3
Lm_dbg:
v_readfirstlane_b32 s96, v178
s_sub_u32 s30, s30, 1
s_cselect_b32 s96, 8, s96
s_cmp_ge_u32 s96, 8
s_cbranch_scc1 Lm_go
buffer_load_dword v178, v7, s[64:67], s97 offen sc1
s_waitcnt vmcnt(0)
s_branch Lm_dbg
Lm_go:
s_mov_b32 s30, 2097152
s_mov_b32 s27, 0
buffer_load_dword v253, v249, s[68:71], s86 offen sc1
Lm_wait:
s_waitcnt vmcnt(0)
Lm_see:
s_and_b32 s98, s27, s9
s_or_b32 s25, s25, s27
s_andn2_b32 s59, s59, s27
s_cbranch_scc0 Lm_disp
v_cmp_le_u32 vcc, v252, v253
s_sub_u32 s30, s30, 1
s_cselect_b32 s96, -1, 0
s_andn2_b32 s9, s9, s96
s_or_b32 s27, vcc_lo, s96
s_and_b32 s27, s27, s59
s_cbranch_scc0 Lm_nl6
s_cmp_eq_u32 s27, s59
s_cbranch_scc1 Lm_last
s_bitcmp1_b32 s27, 0
s_cbranch_scc0 Lm_nl0
buffer_load_dwordx4 v[96:99], v27, s[68:71], s48 offen offset:0 sc1
buffer_load_dwordx4 v[100:103], v27, s[68:71], s48 offen offset:1024 sc1
Lm_nl0:
s_bitcmp1_b32 s27, 1
s_cbranch_scc0 Lm_nl1
buffer_load_dwordx4 v[104:107], v27, s[68:71], s49 offen offset:0 sc1
buffer_load_dwordx4 v[108:111], v27, s[68:71], s49 offen offset:1024 sc1
Lm_nl1:
s_bitcmp1_b32 s27, 2
s_cbranch_scc0 Lm_nl2
buffer_load_dwordx4 v[112:115], v27, s[68:71], s50 offen offset:0 sc1
buffer_load_dwordx4 v[116:119], v27, s[68:71], s50 offen offset:1024 sc1
Lm_nl2:
s_bitcmp1_b32 s27, 3
s_cbranch_scc0 Lm_nl3
buffer_load_dwordx4 v[120:123], v27, s[68:71], s51 offen offset:0 sc1
buffer_load_dwordx4 v[124:127], v27, s[68:71], s51 offen offset:1024 sc1
Lm_nl3:
s_bitcmp1_b32 s27, 4
s_cbranch_scc0 Lm_nl4
buffer_load_dwordx4 v[128:131], v27, s[68:71], s56 offen offset:0 sc1
buffer_load_dwordx4 v[132:135], v27, s[68:71], s56 offen offset:1024 sc1
Lm_nl4:
s_bitcmp1_b32 s27, 5
s_cbranch_scc0 Lm_nl5
buffer_load_dwordx4 v[136:139], v27, s[68:71], s57 offen offset:0 sc1
buffer_load_dwordx4 v[140:143], v27, s[68:71], s57 offen offset:1024 sc1
Lm_nl5:
s_bitcmp1_b32 s27, 6
s_cbranch_scc0 Lm_nl6
buffer_load_dwordx4 v[144:147], v27, s[68:71], s58 offen offset:0 sc1
buffer_load_dwordx4 v[148:151], v27, s[68:71], s58 offen offset:1024 sc1
Lm_nl6:
buffer_load_dword v253, v249, s[68:71], s86 offen sc1
Lm_disp:
s_cmp_eq_u32 s26, 5
s_cbranch_scc1 Lm_sum5
s_cmp_eq_u32 s26, 6
s_cbranch_scc1 Lm_sum6
s_cmp_eq_u32 s26, 4
s_cbranch_scc1 Lm_sum4
s_cmp_eq_u32 s26, 3
s_cbranch_scc1 Lm_sum3
s_cmp_eq_u32 s26, 2
s_cbranch_scc1 Lm_sum2
s_cmp_eq_u32 s26, 1
s_cbranch_scc1 Lm_sum1
Lm_sum0:
s_mov_b32 s26, 0
s_bitcmp1_b32 s25, 0
s_cbranch_scc0 Lm_wait
v_dot2_f32_bf16 v208, v96, s84, v208
v_dot2_f32_bf16 v209, v96, s85, v209
v_dot2_f32_bf16 v210, v97, s84, v210
v_dot2_f32_bf16 v211, v97, s85, v211
v_dot2_f32_bf16 v212, v98, s84, v212
v_dot2_f32_bf16 v213, v98, s85, v213
v_dot2_f32_bf16 v214, v99, s84, v214
v_dot2_f32_bf16 v215, v99, s85, v215
v_dot2_f32_bf16 v216, v100, s84, v216
v_dot2_f32_bf16 v217, v100, s85, v217
v_dot2_f32_bf16 v218, v101, s84, v218
v_dot2_f32_bf16 v219, v101, s85, v219
v_dot2_f32_bf16 v220, v102, s84, v220
v_dot2_f32_bf16 v221, v102, s85, v221
v_dot2_f32_bf16 v222, v103, s84, v222
v_dot2_f32_bf16 v223, v103, s85, v223
Lm_sum1:
s_mov_b32 s26, 1
s_bitcmp1_b32 s25, 1
s_cbranch_scc0 Lm_wait
v_dot2_f32_bf16 v208, v104, s84, v208
v_dot2_f32_bf16 v209, v104, s85, v209
v_dot2_f32_bf16 v210, v105, s84, v210
v_dot2_f32_bf16 v211, v105, s85, v211
v_dot2_f32_bf16 v212, v106, s84, v212
v_dot2_f32_bf16 v213, v106, s85, v213
v_dot2_f32_bf16 v214, v107, s84, v214
v_dot2_f32_bf16 v215, v107, s85, v215
v_dot2_f32_bf16 v216, v108, s84, v216
v_dot2_f32_bf16 v217, v108, s85, v217
v_dot2_f32_bf16 v218, v109, s84, v218
v_dot2_f32_bf16 v219, v109, s85, v219
v_dot2_f32_bf16 v220, v110, s84, v220
v_dot2_f32_bf16 v221, v110, s85, v221
v_dot2_f32_bf16 v222, v111, s84, v222
v_dot2_f32_bf16 v223, v111, s85, v223
Lm_sum2:
s_mov_b32 s26, 2
s_bitcmp1_b32 s25, 2
s_cbranch_scc0 Lm_wait
v_dot2_f32_bf16 v208, v112, s84, v208
v_dot2_f32_bf16 v209, v112, s85, v209
v_dot2_f32_bf16 v210, v113, s84, v210
v_dot2_f32_bf16 v211, v113, s85, v211
v_dot2_f32_bf16 v212, v114, s84, v212
v_dot2_f32_bf16 v213, v114, s85, v213
v_dot2_f32_bf16 v214, v115, s84, v214
v_dot2_f32_bf16 v215, v115, s85, v215
v_dot2_f32_bf16 v216, v116, s84, v216
v_dot2_f32_bf16 v217, v116, s85, v217
v_dot2_f32_bf16 v218, v117, s84, v218
v_dot2_f32_bf16 v219, v117, s85, v219
v_dot2_f32_bf16 v220, v118, s84, v220
v_dot2_f32_bf16 v221, v118, s85, v221
v_dot2_f32_bf16 v222, v119, s84, v222
v_dot2_f32_bf16 v223, v119, s85, v223
Lm_sum3:
s_mov_b32 s26, 3
s_bitcmp1_b32 s25, 3
s_cbranch_scc0 Lm_wait
v_dot2_f32_bf16 v208, v120, s84, v208
v_dot2_f32_bf16 v209, v120, s85, v209
v_dot2_f32_bf16 v210, v121, s84, v210
v_dot2_f32_bf16 v211, v121, s85, v211
v_dot2_f32_bf16 v212, v122, s84, v212
v_dot2_f32_bf16 v213, v122, s85, v213
v_dot2_f32_bf16 v214, v123, s84, v214
v_dot2_f32_bf16 v215, v123, s85, v215
v_dot2_f32_bf16 v216, v124, s84, v216
v_dot2_f32_bf16 v217, v124, s85, v217
v_dot2_f32_bf16 v218, v125, s84, v218
v_dot2_f32_bf16 v219, v125, s85, v219
v_dot2_f32_bf16 v220, v126, s84, v220
v_dot2_f32_bf16 v221, v126, s85, v221
v_dot2_f32_bf16 v222, v127, s84, v222
v_dot2_f32_bf16 v223, v127, s85, v223
Lm_sum4:
s_mov_b32 s26, 4
s_bitcmp1_b32 s25, 4
s_cbranch_scc0 Lm_wait
v_dot2_f32_bf16 v208, v128, s84, v208
v_dot2_f32_bf16 v209, v128, s85, v209
v_dot2_f32_bf16 v210, v129, s84, v210
v_dot2_f32_bf16 v211, v129, s85, v211
v_dot2_f32_bf16 v212, v130, s84, v212
v_dot2_f32_bf16 v213, v130, s85, v213
v_dot2_f32_bf16 v214, v131, s84, v214
v_dot2_f32_bf16 v215, v131, s85, v215
v_dot2_f32_bf16 v216, v132, s84, v216
v_dot2_f32_bf16 v217, v132, s85, v217
v_dot2_f32_bf16 v218, v133, s84, v218
v_dot2_f32_bf16 v219, v133, s85, v219
v_dot2_f32_bf16 v220, v134, s84, v220
v_dot2_f32_bf16 v221, v134, s85, v221
v_dot2_f32_bf16 v222, v135, s84, v222
v_dot2_f32_bf16 v223, v135, s85, v223
Lm_sum5:
s_mov_b32 s26, 5
s_bitcmp1_b32 s25, 5
s_cbranch_scc0 Lm_wait
v_dot2_f32_bf16 v208, v136, s84, v208
v_dot2_f32_bf16 v209, v136, s85, v209
v_dot2_f32_bf16 v210, v137, s84, v210
v_dot2_f32_bf16 v211, v137, s85, v211
v_dot2_f32_bf16 v212, v138, s84, v212
v_dot2_f32_bf16 v213, v138, s85, v213
v_dot2_f32_bf16 v214, v139, s84, v214
v_dot2_f32_bf16 v215, v139, s85, v215
v_dot2_f32_bf16 v216, v140, s84, v216
v_dot2_f32_bf16 v217, v140, s85, v217
v_dot2_f32_bf16 v218, v141, s84, v218
v_dot2_f32_bf16 v219, v141, s85, v219
v_dot2_f32_bf16 v220, v142, s84, v220
v_dot2_f32_bf16 v221, v142, s85, v221
v_dot2_f32_bf16 v222, v143, s84, v222
v_dot2_f32_bf16 v223, v143, s85, v223
Lm_sum6:
s_mov_b32 s26, 6
s_bitcmp1_b32 s25, 6
s_cbranch_scc0 Lm_wait
v_dot2_f32_bf16 v208, v144, s84, v208
v_dot2_f32_bf16 v209, v144, s85, v209
v_dot2_f32_bf16 v210, v145, s84, v210
v_dot2_f32_bf16 v211, v145, s85, v211
v_dot2_f32_bf16 v212, v146, s84, v212
v_dot2_f32_bf16 v213, v146, s85, v213
v_dot2_f32_bf16 v214, v147, s84, v214
v_dot2_f32_bf16 v215, v147, s85, v215
v_dot2_f32_bf16 v216, v148, s84, v216
v_dot2_f32_bf16 v217, v148, s85, v217
v_dot2_f32_bf16 v218, v149, s84, v218
v_dot2_f32_bf16 v219, v149, s85, v219
v_dot2_f32_bf16 v220, v150, s84, v220
v_dot2_f32_bf16 v221, v150, s85, v221
v_dot2_f32_bf16 v222, v151, s84, v222
v_dot2_f32_bf16 v223, v151, s85, v223
s_branch Lm_done
Lm_last:
s_ff1_i32_b32 s97, s27
s_mov_b32 s96, 2147483632
s_cmp_eq_u32 s97, 5
s_cbranch_scc1 Lm_r5
s_cmp_eq_u32 s97, 6
s_cbranch_scc1 Lm_r6
s_cmp_eq_u32 s97, 2
s_cbranch_scc1 Lm_r2
s_cmp_eq_u32 s97, 3
s_cbranch_scc1 Lm_r3
s_cmp_eq_u32 s97, 4
s_cbranch_scc1 Lm_r4
s_cmp_eq_u32 s97, 1
s_cbranch_scc1 Lm_r1
buffer_load_dwordx4 v[96:99], v27, s[68:71], s48 offen offset:0 sc1
buffer_load_dwordx4 v[100:103], v27, s[68:71], s48 offen offset:1024 sc1
Lm_f0:
s_bitcmp1_b32 s27, 1
s_cbranch_scc1 Lm_r1
buffer_load_dword v253, v7, s[68:71], s96 offen
buffer_load_dword v253, v7, s[68:71], s96 offen
s_branch Lm_f1
Lm_r1:
buffer_load_dwordx4 v[104:107], v27, s[68:71], s49 offen offset:0 sc1
buffer_load_dwordx4 v[108:111], v27, s[68:71], s49 offen offset:1024 sc1
Lm_f1:
s_bitcmp1_b32 s27, 2
s_cbranch_scc1 Lm_r2
buffer_load_dword v253, v7, s[68:71], s96 offen
buffer_load_dword v253, v7, s[68:71], s96 offen
s_branch Lm_f2
Lm_r2:
buffer_load_dwordx4 v[112:115], v27, s[68:71], s50 offen offset:0 sc1
buffer_load_dwordx4 v[116:119], v27, s[68:71], s50 offen offset:1024 sc1
Lm_f2:
s_bitcmp1_b32 s27, 3
s_cbranch_scc1 Lm_r3
buffer_load_dword v253, v7, s[68:71], s96 offen
buffer_load_dword v253, v7, s[68:71], s96 offen
s_branch Lm_f3
Lm_r3:
buffer_load_dwordx4 v[120:123], v27, s[68:71], s51 offen offset:0 sc1
buffer_load_dwordx4 v[124:127], v27, s[68:71], s51 offen offset:1024 sc1
Lm_f3:
s_bitcmp1_b32 s27, 4
s_cbranch_scc1 Lm_r4
buffer_load_dword v253, v7, s[68:71], s96 offen
buffer_load_dword v253, v7, s[68:71], s96 offen
s_branch Lm_f4
Lm_r4:
buffer_load_dwordx4 v[128:131], v27, s[68:71], s56 offen offset:0 sc1
buffer_load_dwordx4 v[132:135], v27, s[68:71], s56 offen offset:1024 sc1
Lm_f4:
s_bitcmp1_b32 s27, 5
s_cbranch_scc1 Lm_r5
buffer_load_dword v253, v7, s[68:71], s96 offen
buffer_load_dword v253, v7, s[68:71], s96 offen
s_branch Lm_f5
Lm_r5:
buffer_load_dwordx4 v[136:139], v27, s[68:71], s57 offen offset:0 sc1
buffer_load_dwordx4 v[140:143], v27, s[68:71], s57 offen offset:1024 sc1
Lm_f5:
s_bitcmp1_b32 s27, 6
s_cbranch_scc1 Lm_r6
buffer_load_dword v253, v7, s[68:71], s96 offen
buffer_load_dword v253, v7, s[68:71], s96 offen
s_branch Lm_f6
Lm_r6:
buffer_load_dwordx4 v[144:147], v27, s[68:71], s58 offen offset:0 sc1
buffer_load_dwordx4 v[148:151], v27, s[68:71], s58 offen offset:1024 sc1
Lm_f6:
s_cmp_eq_u32 s26, 6
s_cbranch_scc1 Lm_ls6
s_cmp_eq_u32 s26, 5
s_cbranch_scc1 Lm_ls5
s_cmp_eq_u32 s26, 4
s_cbranch_scc1 Lm_ls4
s_cmp_eq_u32 s26, 3
s_cbranch_scc1 Lm_ls3
s_cmp_eq_u32 s26, 2
s_cbranch_scc1 Lm_ls2
s_cmp_eq_u32 s26, 1
s_cbranch_scc1 Lm_ls1
Lm_ls0:
s_waitcnt vmcnt(12)
v_dot2_f32_bf16 v208, v96, s84, v208
v_dot2_f32_bf16 v209, v96, s85, v209
v_dot2_f32_bf16 v210, v97, s84, v210
v_dot2_f32_bf16 v211, v97, s85, v211
v_dot2_f32_bf16 v212, v98, s84, v212
v_dot2_f32_bf16 v213, v98, s85, v213
v_dot2_f32_bf16 v214, v99, s84, v214
v_dot2_f32_bf16 v215, v99, s85, v215
v_dot2_f32_bf16 v216, v100, s84, v216
v_dot2_f32_bf16 v217, v100, s85, v217
v_dot2_f32_bf16 v218, v101, s84, v218
v_dot2_f32_bf16 v219, v101, s85, v219
v_dot2_f32_bf16 v220, v102, s84, v220
v_dot2_f32_bf16 v221, v102, s85, v221
v_dot2_f32_bf16 v222, v103, s84, v222
v_dot2_f32_bf16 v223, v103, s85, v223
Lm_ls1:
s_waitcnt vmcnt(10)
v_dot2_f32_bf16 v208, v104, s84, v208
v_dot2_f32_bf16 v209, v104, s85, v209
v_dot2_f32_bf16 v210, v105, s84, v210
v_dot2_f32_bf16 v211, v105, s85, v211
v_dot2_f32_bf16 v212, v106, s84, v212
v_dot2_f32_bf16 v213, v106, s85, v213
v_dot2_f32_bf16 v214, v107, s84, v214
v_dot2_f32_bf16 v215, v107, s85, v215
v_dot2_f32_bf16 v216, v108, s84, v216
v_dot2_f32_bf16 v217, v108, s85, v217
v_dot2_f32_bf16 v218, v109, s84, v218
v_dot2_f32_bf16 v219, v109, s85, v219
v_dot2_f32_bf16 v220, v110, s84, v220
v_dot2_f32_bf16 v221, v110, s85, v221
v_dot2_f32_bf16 v222, v111, s84, v222
v_dot2_f32_bf16 v223, v111, s85, v223
Lm_ls2:
s_waitcnt vmcnt(8)
v_dot2_f32_bf16 v208, v112, s84, v208
v_dot2_f32_bf16 v209, v112, s85, v209
v_dot2_f32_bf16 v210, v113, s84, v210
v_dot2_f32_bf16 v211, v113, s85, v211
v_dot2_f32_bf16 v212, v114, s84, v212
v_dot2_f32_bf16 v213, v114, s85, v213
v_dot2_f32_bf16 v214, v115, s84, v214
v_dot2_f32_bf16 v215, v115, s85, v215
v_dot2_f32_bf16 v216, v116, s84, v216
v_dot2_f32_bf16 v217, v116, s85, v217
v_dot2_f32_bf16 v218, v117, s84, v218
v_dot2_f32_bf16 v219, v117, s85, v219
v_dot2_f32_bf16 v220, v118, s84, v220
v_dot2_f32_bf16 v221, v118, s85, v221
v_dot2_f32_bf16 v222, v119, s84, v222
v_dot2_f32_bf16 v223, v119, s85, v223
Lm_ls3:
s_waitcnt vmcnt(6)
v_dot2_f32_bf16 v208, v120, s84, v208
v_dot2_f32_bf16 v209, v120, s85, v209
v_dot2_f32_bf16 v210, v121, s84, v210
v_dot2_f32_bf16 v211, v121, s85, v211
v_dot2_f32_bf16 v212, v122, s84, v212
v_dot2_f32_bf16 v213, v122, s85, v213
v_dot2_f32_bf16 v214, v123, s84, v214
v_dot2_f32_bf16 v215, v123, s85, v215
v_dot2_f32_bf16 v216, v124, s84, v216
v_dot2_f32_bf16 v217, v124, s85, v217
v_dot2_f32_bf16 v218, v125, s84, v218
v_dot2_f32_bf16 v219, v125, s85, v219
v_dot2_f32_bf16 v220, v126, s84, v220
v_dot2_f32_bf16 v221, v126, s85, v221
v_dot2_f32_bf16 v222, v127, s84, v222
v_dot2_f32_bf16 v223, v127, s85, v223
Lm_ls4:
s_waitcnt vmcnt(4)
v_dot2_f32_bf16 v208, v128, s84, v208
v_dot2_f32_bf16 v209, v128, s85, v209
v_dot2_f32_bf16 v210, v129, s84, v210
v_dot2_f32_bf16 v211, v129, s85, v211
v_dot2_f32_bf16 v212, v130, s84, v212
v_dot2_f32_bf16 v213, v130, s85, v213
v_dot2_f32_bf16 v214, v131, s84, v214
v_dot2_f32_bf16 v215, v131, s85, v215
v_dot2_f32_bf16 v216, v132, s84, v216
v_dot2_f32_bf16 v217, v132, s85, v217
v_dot2_f32_bf16 v218, v133, s84, v218
v_dot2_f32_bf16 v219, v133, s85, v219
v_dot2_f32_bf16 v220, v134, s84, v220
v_dot2_f32_bf16 v221, v134, s85, v221
v_dot2_f32_bf16 v222, v135, s84, v222
v_dot2_f32_bf16 v223, v135, s85, v223
Lm_ls5:
s_waitcnt vmcnt(2)
v_dot2_f32_bf16 v208, v136, s84, v208
v_dot2_f32_bf16 v209, v136, s85, v209
v_dot2_f32_bf16 v210, v137, s84, v210
v_dot2_f32_bf16 v211, v137, s85, v211
v_dot2_f32_bf16 v212, v138, s84, v212
v_dot2_f32_bf16 v213, v138, s85, v213
v_dot2_f32_bf16 v214, v139, s84, v214
v_dot2_f32_bf16 v215, v139, s85, v215
v_dot2_f32_bf16 v216, v140, s84, v216
v_dot2_f32_bf16 v217, v140, s85, v217
v_dot2_f32_bf16 v218, v141, s84, v218
v_dot2_f32_bf16 v219, v141, s85, v219
v_dot2_f32_bf16 v220, v142, s84, v220
v_dot2_f32_bf16 v221, v142, s85, v221
v_dot2_f32_bf16 v222, v143, s84, v222
v_dot2_f32_bf16 v223, v143, s85, v223
Lm_ls6:
s_waitcnt vmcnt(0)
v_dot2_f32_bf16 v208, v144, s84, v208
v_dot2_f32_bf16 v209, v144, s85, v209
v_dot2_f32_bf16 v210, v145, s84, v210
v_dot2_f32_bf16 v211, v145, s85, v211
v_dot2_f32_bf16 v212, v146, s84, v212
v_dot2_f32_bf16 v213, v146, s85, v213
v_dot2_f32_bf16 v214, v147, s84, v214
v_dot2_f32_bf16 v215, v147, s85, v215
v_dot2_f32_bf16 v216, v148, s84, v216
v_dot2_f32_bf16 v217, v148, s85, v217
v_dot2_f32_bf16 v218, v149, s84, v218
v_dot2_f32_bf16 v219, v149, s85, v219
v_dot2_f32_bf16 v220, v150, s84, v220
v_dot2_f32_bf16 v221, v150, s85, v221
v_dot2_f32_bf16 v222, v151, s84, v222
v_dot2_f32_bf16 v223, v151, s85, v223
Lm_done:
v_cvt_pk_bf16_f32 v96, v208, v209
v_cvt_pk_bf16_f32 v97, v210, v211
v_cvt_pk_bf16_f32 v98, v212, v213
v_cvt_pk_bf16_f32 v99, v214, v215
v_cvt_pk_bf16_f32 v100, v216, v217
v_cvt_pk_bf16_f32 v101, v218, v219
v_cvt_pk_bf16_f32 v102, v220, v221
v_cvt_pk_bf16_f32 v103, v222, v223
s_movk_i32 s96, 14336
v_permlane32_swap_b32 v96, v98
v_permlane32_swap_b32 v100, v102
v_permlane32_swap_b32 v97, v99
v_permlane32_swap_b32 v101, v103
v_permlane16_swap_b32 v96, v100
v_permlane16_swap_b32 v98, v102
v_permlane16_swap_b32 v97, v101
v_permlane16_swap_b32 v99, v103
buffer_store_dwordx4 v[96:99], v176, s[60:63], 0 offen sc0 sc1
buffer_store_dwordx4 v[100:103], v176, s[60:63], s96 offen sc0 sc1
Lm_fin:
s_endpgm
Lattn:
v_lshrrev_b32 v1, 4, v0
v_and_b32 v2, 15, v0
v_lshlrev_b32 v3, 1, v1
v_xor_b32 v3, v2, v3
v_mul_u32_u24 v4, 2688, v1
v_lshl_add_u32 v16, v3, 4, v4
v_add_u32 v17, 9728, v16
v_xor_b32 v3, 8, v3
v_lshl_add_u32 v3, v3, 4, v4
v_add_u32 v18, 19456, v3
v_add_u32 v19, 29184, v3
s_sub_u32 s96, s5, 4
s_mul_i32 s96, s96, 224
s_cmp_eq_u32 s5, 7
s_cselect_b32 s97, 32, 0
s_cselect_b32 s88, 2147483632, 0
s_sub_u32 s30, s96, s97
s_mul_i32 s98, s3, 43008
s_add_u32 s94, s30, s98
s_and_b32 s95, s4, 15
s_lshl_b32 s95, s95, 2
s_add_u32 s95, s95, s3
s_lshl_b32 s96, s4, 6
s_lshl_b32 s97, s3, 4
s_add_u32 s96, s96, s97
v_and_or_b32 v1, v0, 15, s96
v_lshrrev_b32 v118, 4, v0
v_mul_u32_u24 v1, 7, v1
v_add_lshl_u32 v118, v118, v1, 7
s_lshr_b32 s96, s30, 7
s_sub_u32 s97, s5, 5
s_cmp_lt_u32 s97, 2
s_cselect_b32 s97, 3, 2
v_bfe_u32 v1, v0, 2, 3
v_lshl_add_u32 v1, v1, 6, s95
v_mul_u32_u24 v1, 21, v1
v_lshrrev_b32 v2, 5, v0
v_mad_u32_u24 v1, v2, 7, v1
v_and_b32 v2, 3, v0
v_cmp_gt_u32 vcc, s97, v2
v_add3_u32 v1, v1, v2, s96
v_lshlrev_b32 v1, 7, v1
v_mov_b32 v2, 2147483632
v_cndmask_b32 v254, v2, v1, vcc
s_waitcnt lgkmcnt(0)
s_mov_b32 s32, s8
s_mov_b32 s33, s9
s_mov_b32 s34, 1835008
s_mov_b32 s35, 0x20000
s_add_u32 m0, s89, 81920
s_nop 0
buffer_load_dwordx4 v96, s[32:35], 0 offen offset:0 lds
buffer_load_dwordx4 v97, s[32:35], 0 offen offset:1024 lds
s_mov_b32 s36, s10
s_mov_b32 s37, s11
s_mov_b32 s38, 1204224
s_mov_b32 s39, 0x20000
s_add_u32 s7, s94, 0
s_add_u32 m0, s72, 0
s_nop 0
buffer_load_dwordx4 v16, s[36:39], s7 offen offset:0 lds
buffer_load_dwordx4 v17, s[36:39], s7 offen offset:1024 lds
buffer_load_dwordx4 v18, s[36:39], s7 offen offset:2048 lds
buffer_load_dwordx4 v19, s[36:39], s7 offen offset:3072 lds
s_bfm_b64 exec, 20, 8
buffer_load_dword v69, v254, s[36:39], 0 offen
s_mov_b64 exec, -1
s_movk_i32 s7, 128
s_add_u32 m0, s89, 90112
s_nop 0
buffer_load_dwordx4 v96, s[32:35], s7 offen offset:0 lds
buffer_load_dwordx4 v97, s[32:35], s7 offen offset:1024 lds
s_add_u32 s7, s94, 172032
s_add_u32 m0, s72, 16384
s_nop 0
buffer_load_dwordx4 v16, s[36:39], s7 offen offset:0 lds
buffer_load_dwordx4 v17, s[36:39], s7 offen offset:1024 lds
buffer_load_dwordx4 v18, s[36:39], s7 offen offset:2048 lds
buffer_load_dwordx4 v19, s[36:39], s7 offen offset:3072 lds
s_mov_b32 s68, s28
s_mov_b32 s69, s29
s_mov_b32 s70, 268435456
s_mov_b32 s71, 0x20000
s_mov_b32 s48, s18
s_mov_b32 s49, s19
s_mov_b32 s50, 3584
s_mov_b32 s51, 0x20000
s_mov_b32 s56, s22
s_mov_b32 s57, s23
s_mov_b32 s58, 896
s_mov_b32 s59, 0x20000
s_mov_b32 s44, s16
s_mov_b32 s45, s17
s_mov_b32 s46, 1605632
s_mov_b32 s47, 0x20000
s_mov_b32 s52, s20
s_mov_b32 s53, s21
s_mov_b32 s54, 1605632
s_mov_b32 s55, 0x20000
s_mov_b32 s40, s12
s_mov_b32 s41, s13
s_mov_b32 s42, 401408
s_mov_b32 s43, 0x20000
s_mov_b32 s60, s24
s_mov_b32 s61, s25
s_mov_b32 s62, 1835008
s_mov_b32 s63, 0x20000
s_mov_b32 s64, s26
s_mov_b32 s65, s27
s_mov_b32 s66, 256
s_mov_b32 s67, 0x20000
s_mov_b32 s82, 0xbdd2d3e8
s_mov_b32 s83, 0x3f803f80
s_mov_b32 s84, 0x00003f80
s_mov_b32 s85, 0x3f800000
s_cmp_eq_u32 s5, 7
s_cselect_b32 s14, 0, 0x10000
s_cselect_b32 s15, 0, 0xffff0000
v_and_b32 v1, 15, v0
v_lshrrev_b32 v2, 4, v0
v_bfe_u32 v160, v0, 1, 3
v_xor_b32 v2, v2, v160
v_lshlrev_b32 v1, 7, v1
v_lshl_add_u32 v1, v2, 4, v1
v_add_u32 v160, 81920, v1
v_xor_b32 v161, 64, v160
v_add_u32 v162, s89, v160
v_add_u32 v163, s89, v161
v_mov_b32 v156, s83
v_mov_b32 v157, s83
v_mov_b32 v158, s83
v_mov_b32 v159, s83
s_cmp_eq_u32 s5, 7
s_cselect_b32 s97, 32, 0
s_mul_i32 s98, s3, 56
s_add_u32 s97, s97, s98
v_bfe_u32 v1, v0, 2, 2
v_lshrrev_b32 v2, 4, v0
v_lshl_add_u32 v3, v2, 3, v1
v_and_b32 v2, 1, v2
v_lshl_add_u32 v1, v2, 2, v1
v_lshlrev_b32 v1, 5, v1
v_and_b32 v2, 3, v0
v_lshl_add_u32 v2, v2, 3, s97
v_xor_b32 v22, v2, v1
v_add_u32 v2, 32, v2
v_xor_b32 v24, v2, v1
v_lshl_add_u32 v22, v3, 8, v22
v_lshl_add_u32 v24, v3, 8, v24
v_add_u32 v23, 0x10000, v22
v_add_u32 v25, 0x10000, v24
v_bfe_u32 v1, v0, 3, 1
v_bfe_u32 v2, v0, 4, 1
v_lshl_add_u32 v1, v1, 1, v2
v_xor_b32 v1, s3, v1
v_lshlrev_b32 v1, 5, v1
v_and_b32 v2, 3, v0
v_lshl_add_u32 v1, v2, 3, v1
v_lshl_add_u32 v20, v3, 7, v1
v_add_u32 v21, 0x10000, v20
v_lshrrev_b32 v1, 3, v0
v_mul_u32_u24 v1, 3584, v1
v_and_b32 v2, 7, v0
v_bfe_u32 v8, v0, 4, 1
v_lshlrev_b32 v8, 2, v8
v_xor_b32 v2, v2, v8
v_lshl_add_u32 v8, v2, 4, v1
v_xor_b32 v2, 2, v2
v_lshl_add_u32 v2, v2, 4, v1
v_add_u32 v9, 27648, v2
v_add_u32 v10, 55296, v8
v_add_u32 v11, 82944, v2
s_add_u32 s96, s5, 20
s_lshl_b32 s96, s96, 7
s_mul_i32 s97, s3, 114688
s_add_u32 s73, s96, s97
s_mul_i32 s97, s3, 57344
s_add_u32 s31, s96, s97
s_min_u32 s96, s4, 1
s_add_u32 s96, s96, s3
s_mul_i32 s96, s96, 14336
v_subrev_u32 v164, s96, v96
v_subrev_u32 v165, s96, v97
v_and_b32 v1, 15, v0
v_lshlrev_b32 v1, 2, v1
v_add_u32 v30, 153600, v1
s_lshl_b32 s96, s3, 6
s_add_u32 s96, s96, 64
v_add_u32 v1, s96, v30
v_lshlrev_b32 v2, 2, v0
v_add_u32 v2, 154880, v2
v_bfe_u32 v3, v0, 2, 2
v_lshrrev_b32 v167, 4, v0
v_cmp_eq_u32 vcc, v3, v167
s_nop 1
v_cndmask_b32 v167, v2, v1, vcc
s_lshl_b32 s96, s3, 4
s_add_u32 s96, s96, 153600
v_lshl_add_u32 v1, v3, 2, s96
v_cndmask_b32 v168, v2, v1, vcc
s_lshl_b32 s96, s3, 2
v_add_u32 v3, s96, v3
v_and_b32 v1, 1, v0
v_lshrrev_b32 v2, 4, v0
v_lshl_add_u32 v1, v1, 2, v2
v_lshrrev_b32 v2, 1, v3
v_xor_b32 v1, v1, v2
v_lshlrev_b32 v1, 4, v1
v_lshl_add_u32 v1, v3, 7, v1
v_bfe_u32 v2, v0, 1, 1
v_lshl_add_u32 v1, v2, 11, v1
v_add_u32 v166, 139264, v1
s_lshl_b32 s96, s3, 1
v_bfe_u32 v1, v0, 3, 1
v_add_u32 v1, s96, v1
v_min_u32 v1, 6, v1
v_and_b32 v2, 7, v0
v_lshlrev_b32 v2, 4, v2
v_lshl_add_u32 v1, v1, 11, v2
v_add_u32 v169, 139264, v1
v_and_b32 v1, 15, v0
v_bfe_u32 v2, v0, 4, 1
v_lshl_add_u32 v1, v2, 5, v1
v_lshlrev_b32 v1, 4, v1
v_lshrrev_b32 v2, 5, v0
v_lshl_add_u32 v1, v2, 8, v1
v_add_u32 v31, 81920, v1
v_mov_b32 v70, 0xc0135761
v_lshrrev_b32 v1, 3, v0
v_mul_u32_u24 v1, 896, v1
v_and_b32 v2, 7, v0
v_bfe_u32 v12, v0, 4, 1
v_lshlrev_b32 v12, 2, v12
v_xor_b32 v2, v2, v12
v_lshl_add_u32 v12, v2, 4, v1
v_add_u32 v13, 6144, v12
v_add_u32 v14, 12288, v12
v_add_u32 v15, 18432, v12
v_bfe_u32 v1, v0, 2, 2
v_lshrrev_b32 v2, 5, v0
v_lshl_add_u32 v2, v2, 2, v1
v_lshlrev_b32 v2, 7, v2
v_and_b32 v3, 3, v0
v_lshlrev_b32 v3, 3, v3
v_bfe_u32 v1, v0, 4, 1
v_lshl_add_u32 v3, v1, 5, v3
v_bfe_u32 v1, v0, 3, 1
s_and_b32 s96, s3, 1
v_xor_b32 v1, s96, v1
v_lshl_add_u32 v3, v1, 6, v3
v_add_u32 v28, v2, v3
v_add_u32 v29, 0x10000, v28
s_lshr_b32 s97, s3, 1
s_lshl_b32 s98, s97, 13
v_add_u32 v26, s98, v28
v_add_u32 v27, 0x10000, v26
v_lshlrev_b32 v1, 4, v0
s_lshl_b32 s98, s97, 10
s_add_u32 s98, s98, 81920
v_add_u32 v64, s98, v1
v_xor_b32 v65, 1024, v64
s_lshl_b32 s98, s96, 12
s_lshl_b32 s99, s97, 11
s_add_u32 s98, s98, s99
v_add_u32 v66, s98, v1
v_xor_b32 v67, 2048, v66
s_lshl_b32 s98, s4, 6
s_lshl_b32 s99, s97, 5
s_add_u32 s98, s98, s99
v_and_b32 v1, 15, v0
v_add_u32 v1, s98, v1
v_mul_u32_u24 v1, 896, v1
v_lshrrev_b32 v2, 5, v0
s_lshl_b32 s98, s6, 7
s_lshl_b32 s99, s96, 6
s_add_u32 s98, s98, s99
v_lshl_add_u32 v2, v2, 4, s98
v_add_u32 v252, v1, v2
v_and_b32 v2, 16, v0
v_lshl_add_u32 v252, v2, 1, v252
v_and_b32 v1, 15, v0
v_lshrrev_b32 v2, 4, v0
v_cmp_eq_u32 vcc, 3, v2
v_lshlrev_b32 v2, 2, v2
v_and_b32 v3, 1, v0
v_cndmask_b32_e64 v71, -1, 0, vcc
v_cmp_eq_u32 vcc, 1, v3
v_add_u32 v2, v2, v3
v_mov_b32 v5, 0xffff
v_mov_b32 v6, 0xffff0000
v_cndmask_b32 v5, v5, v6, vcc
v_cmp_le_u32 vcc, v2, v1
v_add_u32 v2, 2, v2
v_mov_b32 v6, 0xf149f2ca
v_cndmask_b32 v74, 0, v5, vcc
v_cmp_le_u32 vcc, v2, v1
v_xor_b32 v72, v5, v74
s_nop 0
v_cndmask_b32 v75, 0, v5, vcc
v_xor_b32 v73, v5, v75
v_and_b32 v1, 0xffff, v72
v_cmp_ne_u32 vcc, 0, v1
s_nop 1
v_cndmask_b32_e64 v80, v6, 0, vcc
v_and_b32 v1, 0xffff0000, v72
v_cmp_ne_u32 vcc, 0, v1
s_nop 1
v_cndmask_b32_e64 v81, v6, 0, vcc
v_and_b32 v1, 0xffff, v73
v_cmp_ne_u32 vcc, 0, v1
s_nop 1
v_cndmask_b32_e64 v82, v6, 0, vcc
v_and_b32 v1, 0xffff0000, v73
v_cmp_ne_u32 vcc, 0, v1
s_nop 1
v_cndmask_b32_e64 v83, v6, 0, vcc
v_and_b32 v1, 0xffff, v74
v_cmp_ne_u32 vcc, 0, v1
s_nop 1
v_cndmask_b32_e64 v76, v6, 0, vcc
v_and_b32 v1, 0xffff0000, v74
v_cmp_ne_u32 vcc, 0, v1
s_nop 1
v_cndmask_b32_e64 v77, v6, 0, vcc
v_and_b32 v1, 0xffff, v75
v_cmp_ne_u32 vcc, 0, v1
s_nop 1
v_cndmask_b32_e64 v78, v6, 0, vcc
v_and_b32 v1, 0xffff0000, v75
v_cmp_ne_u32 vcc, 0, v1
s_nop 1
v_cndmask_b32_e64 v79, v6, 0, vcc
v_mov_b32 v1, s4
v_cmp_ne_u32 vcc, 0, v1
s_nop 1
v_cndmask_b32 v84, v6, v80, vcc
v_cndmask_b32 v85, v6, v81, vcc
v_cndmask_b32 v86, v6, v82, vcc
v_cndmask_b32 v87, v6, v83, vcc
s_mov_b32 s96, 0x1076532
s_mov_b32 s97, 0x2a33b19
s_mov_b32 s9, 0
s_cmp_eq_u32 s5, 5
s_cselect_b32 s96, 0x217634, s96
s_cselect_b32 s97, 0x32abb91, s97
s_cselect_b32 s9, 0x0, s9
s_cmp_eq_u32 s5, 6
s_cselect_b32 s96, 0x1073254, s96
s_cselect_b32 s97, 0x3b42a19, s97
s_cselect_b32 s9, 0x0, s9
s_cselect_b32 s98, s3, 0
s_lshr_b32 s98, s98, 1
s_lshl_b32 s98, s98, 19
s_or_b32 s97, s97, s98
v_lshlrev_b32 v1, 2, v0
v_bfe_u32 v2, s96, v1, 3
v_bfe_u32 v253, s97, v1, 3
v_add_u32 v1, 3, v1
v_bfe_u32 v1, s97, v1, 1
s_and_b32 s98, s3, 1
v_lshl_add_u32 v1, v1, 1, s98
v_mul_u32_u24 v1, 512, v1
v_mul_u32_u24 v2, 2048, v2
v_add_u32 v1, v1, v2
v_mul_u32_u24 v2, 128, v253
v_add_u32 v1, v1, v2
v_subrev_u32 v1, 128, v1
v_cmp_gt_u32 vcc, 7, v0
v_mov_b32 v2, 2147483632
s_nop 0
v_cndmask_b32 v68, v2, v1, vcc
s_mov_b32 s25, 0
s_mov_b32 s29, s96
s_add_u32 s86, s86, 524288
v_mov_b32 v200, 0
v_lshrrev_b32 v201, 2, v0
v_and_b32 v202, 3, v0
v_mul_u32_u24 v201, 512, v201
v_mul_u32_u24 v202, 128, v202
v_add_u32 v201, v201, v202
s_mul_i32 s96, s5, 2048
s_add_u32 s96, s96, s86
s_mul_i32 s97, s3, 512
s_add_u32 s24, s96, s97
s_cmp_eq_u32 s3, 0
s_cselect_b32 s96, s96, 2147483632
s_bfm_b64 exec, 16, 0
buffer_store_dword v200, v201, s[68:71], s96 offen sc1
s_mov_b64 exec, -1
s_movk_i32 s7, 256
s_add_u32 m0, s89, 98304
s_nop 0
buffer_load_dwordx4 v96, s[32:35], s7 offen offset:0 lds
buffer_load_dwordx4 v97, s[32:35], s7 offen offset:1024 lds
s_add_u32 s7, s94, 344064
s_add_u32 m0, s72, 32768
s_nop 0
buffer_load_dwordx4 v16, s[36:39], s7 offen offset:0 lds
buffer_load_dwordx4 v17, s[36:39], s7 offen offset:1024 lds
buffer_load_dwordx4 v18, s[36:39], s7 offen offset:2048 lds
buffer_load_dwordx4 v19, s[36:39], s7 offen offset:3072 lds
s_bfm_b64 exec, 48, 0
buffer_load_dword v69, v118, s[32:35], 0 offen offset:512
s_mov_b64 exec, -1
s_waitcnt vmcnt(15)
s_barrier
ds_read_b64_tr_b16 v[32:33], v22 offset:0
ds_read_b64_tr_b16 v[34:35], v22 offset:1024
ds_read_b64_tr_b16 v[36:37], v24 offset:0
ds_read_b64_tr_b16 v[38:39], v24 offset:1024
ds_read_b64_tr_b16 v[40:41], v22 offset:8192
ds_read_b64_tr_b16 v[42:43], v22 offset:9216
ds_read_b64_tr_b16 v[44:45], v24 offset:8192
ds_read_b64_tr_b16 v[46:47], v24 offset:9216
ds_read_b128 a[0:3], v160 offset:0
ds_read_b128 a[4:7], v160 offset:2048
ds_read_b128 a[8:11], v160 offset:4096
ds_read_b128 a[12:15], v160 offset:6144
ds_read_b128 a[16:19], v161 offset:0
ds_read_b128 a[20:23], v161 offset:2048
ds_read_b128 a[24:27], v161 offset:4096
ds_read_b128 a[28:31], v161 offset:6144
ds_read_b128 v[216:219], v162 offset:0
ds_read_b128 v[220:223], v163 offset:0
s_add_u32 s96, s5, 20
s_lshl_b32 s96, s96, 7
s_lshl_b32 s97, s3, 5
s_add_u32 s96, s96, s97
s_lshl_b32 s97, s6, 7
s_add_u32 s97, s97, s88
v_lshrrev_b32 v1, 4, v0
v_lshlrev_b32 v1, 3, v1
v_lshlrev_b32 v2, 2, v0
buffer_load_dwordx2 v[94:95], v1, s[48:51], s96 offen
buffer_load_dword v113, v2, s[56:59], s97 offen
s_movk_i32 s7, 384
s_add_u32 m0, s89, 106496
s_nop 0
buffer_load_dwordx4 v96, s[32:35], s7 offen offset:0 lds
buffer_load_dwordx4 v97, s[32:35], s7 offen offset:1024 lds
s_add_u32 s7, s94, 516096
s_add_u32 m0, s72, 49152
s_nop 0
buffer_load_dwordx4 v16, s[36:39], s7 offen offset:0 lds
buffer_load_dwordx4 v17, s[36:39], s7 offen offset:1024 lds
buffer_load_dwordx4 v18, s[36:39], s7 offen offset:2048 lds
buffer_load_dwordx4 v19, s[36:39], s7 offen offset:3072 lds
s_waitcnt vmcnt(16) lgkmcnt(10)
s_barrier
s_waitcnt lgkmcnt(9)
v_mfma_f32_16x16x32_bf16 v[120:123], v[32:35], a[0:3], 0
ds_read_b64_tr_b16 v[48:49], v22 offset:16384
s_add_u32 s30, s5, 20
s_waitcnt lgkmcnt(9)
v_mfma_f32_16x16x32_bf16 v[124:127], v[32:35], a[4:7], 0
ds_read_b64_tr_b16 v[50:51], v22 offset:17408
s_lshl_b32 s30, s30, 6
s_waitcnt lgkmcnt(9)
v_mfma_f32_16x16x32_bf16 v[128:131], v[32:35], a[8:11], 0
ds_read_b64_tr_b16 v[52:53], v24 offset:16384
s_lshr_b32 s16, s3, 1
s_waitcnt lgkmcnt(9)
v_mfma_f32_16x16x32_bf16 v[132:135], v[32:35], a[12:15], 0
ds_read_b64_tr_b16 v[54:55], v24 offset:17408
s_add_u32 s16, s16, s6
s_add_u32 s16, s16, 1
v_mfma_f32_16x16x32_bf16 v[172:175], v[32:35], v[156:159], 0
ds_read_b64_tr_b16 v[56:57], v22 offset:24576
s_sub_u32 s17, s16, 7
s_waitcnt lgkmcnt(6)
v_mfma_f32_16x16x32_bf16 v[180:183], v[216:219], v[216:219], 0
ds_read_b64_tr_b16 v[58:59], v22 offset:25600
s_movk_i32 s7, 512
s_add_u32 m0, s89, 114688
v_mfma_f32_16x16x32_bf16 v[136:139], v[36:39], a[0:3], 0
ds_read_b64_tr_b16 v[60:61], v24 offset:24576
buffer_load_dwordx4 v96, s[32:35], s7 offen offset:0 lds
v_mfma_f32_16x16x32_bf16 v[140:143], v[36:39], a[4:7], 0
ds_read_b64_tr_b16 v[62:63], v24 offset:25600
s_cmp_ge_u32 s16, 7
s_cselect_b32 s16, s17, s16
v_mfma_f32_16x16x32_bf16 v[144:147], v[36:39], a[8:11], 0
ds_read_b128 a[32:35], v160 offset:8192
v_mfma_f32_16x16x32_bf16 v[148:151], v[36:39], a[12:15], 0
ds_read_b128 a[36:39], v160 offset:10240
buffer_load_dwordx4 v97, s[32:35], s7 offen offset:1024 lds
v_mfma_f32_16x16x32_bf16 v[176:179], v[36:39], v[156:159], 0
ds_read_b128 a[40:43], v160 offset:12288
s_mul_i32 s17, s4, 7
v_mfma_f32_16x16x32_bf16 v[184:187], v[156:159], v[216:219], 0
ds_read_b128 a[44:47], v160 offset:14336
s_add_u32 s17, s17, s16
s_lshl_b32 s17, s17, 3
v_mfma_f32_16x16x32_bf16 v[120:123], v[40:43], a[16:19], v[120:123]
ds_read_b128 a[48:51], v161 offset:8192
s_add_u32 s7, s94, 688128
s_add_u32 m0, s72, 65536
s_nop 0
buffer_load_dwordx4 v16, s[36:39], s7 offen offset:0 lds
v_mfma_f32_16x16x32_bf16 v[124:127], v[40:43], a[20:23], v[124:127]
ds_read_b128 a[52:55], v161 offset:10240
s_add_u32 s17, s17, s5
v_mfma_f32_16x16x32_bf16 v[128:131], v[40:43], a[24:27], v[128:131]
ds_read_b128 a[56:59], v161 offset:12288
s_mul_i32 s17, s17, 8192
v_mfma_f32_16x16x32_bf16 v[132:135], v[40:43], a[28:31], v[132:135]
ds_read_b128 a[60:63], v161 offset:14336
buffer_load_dwordx4 v17, s[36:39], s7 offen offset:1024 lds
v_mfma_f32_16x16x32_bf16 v[172:175], v[40:43], v[156:159], v[172:175]
ds_read_b128 v[224:227], v162 offset:8192
s_add_u32 s78, s17, 1048576
s_waitcnt lgkmcnt(15)
v_mfma_f32_16x16x32_bf16 v[180:183], v[220:223], v[220:223], v[180:183]
ds_read_b128 v[228:231], v163 offset:8192
s_lshl_b32 s16, s16, 7
v_mfma_f32_16x16x32_bf16 v[136:139], v[44:47], a[16:19], v[136:139]
buffer_load_dwordx4 v18, s[36:39], s7 offen offset:2048 lds
v_mfma_f32_16x16x32_bf16 v[140:143], v[44:47], a[20:23], v[140:143]
s_and_b32 s17, s3, 1
s_lshl_b32 s18, s17, 5
v_mfma_f32_16x16x32_bf16 v[144:147], v[44:47], a[24:27], v[144:147]
s_add_u32 s18, s18, s30
s_mul_i32 s18, s18, 896
v_mfma_f32_16x16x32_bf16 v[148:151], v[44:47], a[28:31], v[148:151]
buffer_load_dwordx4 v19, s[36:39], s7 offen offset:3072 lds
v_mfma_f32_16x16x32_bf16 v[176:179], v[44:47], v[156:159], v[176:179]
s_add_u32 s74, s18, s16
v_mfma_f32_16x16x32_bf16 v[184:187], v[156:159], v[220:223], v[184:187]
s_sub_u32 s18, s5, 4
s_waitcnt vmcnt(15) lgkmcnt(10)
s_barrier
s_waitcnt lgkmcnt(9)
v_mfma_f32_16x16x32_bf16 v[120:123], v[48:51], a[32:35], v[120:123]
ds_read_b64_tr_b16 v[32:33], v22 offset:32768
s_mul_i32 s18, s18, 112
s_waitcnt lgkmcnt(9)
v_mfma_f32_16x16x32_bf16 v[124:127], v[48:51], a[36:39], v[124:127]
ds_read_b64_tr_b16 v[34:35], v22 offset:33792
s_mul_i32 s17, s17, 28
s_waitcnt lgkmcnt(9)
v_mfma_f32_16x16x32_bf16 v[128:131], v[48:51], a[40:43], v[128:131]
ds_read_b64_tr_b16 v[36:37], v24 offset:32768
s_add_u32 s18, s18, s17
s_waitcnt lgkmcnt(9)
v_mfma_f32_16x16x32_bf16 v[132:135], v[48:51], a[44:47], v[132:135]
ds_read_b64_tr_b16 v[38:39], v24 offset:33792
s_mul_i32 s18, s18, 896
s_add_u32 s90, s18, s16
v_mfma_f32_16x16x32_bf16 v[172:175], v[48:51], v[156:159], v[172:175]
ds_read_b64_tr_b16 v[40:41], v22 offset:40960
s_lshr_b32 s16, s3, 1
s_waitcnt lgkmcnt(6)
v_mfma_f32_16x16x32_bf16 v[180:183], v[224:227], v[224:227], v[180:183]
ds_read_b64_tr_b16 v[42:43], v22 offset:41984
s_movk_i32 s7, 640
s_add_u32 m0, s89, 122880
v_mfma_f32_16x16x32_bf16 v[136:139], v[52:55], a[32:35], v[136:139]
ds_read_b64_tr_b16 v[44:45], v24 offset:40960
buffer_load_dwordx4 v96, s[32:35], s7 offen offset:0 lds
v_mfma_f32_16x16x32_bf16 v[140:143], v[52:55], a[36:39], v[140:143]
ds_read_b64_tr_b16 v[46:47], v24 offset:41984
s_add_u32 s16, s16, s6
v_mfma_f32_16x16x32_bf16 v[144:147], v[52:55], a[40:43], v[144:147]
ds_read_b128 a[64:67], v160 offset:16384
s_add_u32 s16, s16, 3
v_mfma_f32_16x16x32_bf16 v[148:151], v[52:55], a[44:47], v[148:151]
ds_read_b128 a[68:71], v160 offset:18432
buffer_load_dwordx4 v97, s[32:35], s7 offen offset:1024 lds
v_mfma_f32_16x16x32_bf16 v[176:179], v[52:55], v[156:159], v[176:179]
ds_read_b128 a[72:75], v160 offset:20480
s_sub_u32 s17, s16, 7
v_mfma_f32_16x16x32_bf16 v[184:187], v[156:159], v[224:227], v[184:187]
ds_read_b128 a[76:79], v160 offset:22528
s_cmp_ge_u32 s16, 7
s_cselect_b32 s16, s17, s16
v_mfma_f32_16x16x32_bf16 v[120:123], v[56:59], a[48:51], v[120:123]
ds_read_b128 a[80:83], v161 offset:16384
s_add_u32 s7, s94, 860160
s_add_u32 m0, s72, 0
s_nop 0
buffer_load_dwordx4 v16, s[36:39], s7 offen offset:0 lds
v_mfma_f32_16x16x32_bf16 v[124:127], v[56:59], a[52:55], v[124:127]
ds_read_b128 a[84:87], v161 offset:18432
v_mfma_f32_16x16x32_bf16 v[128:131], v[56:59], a[56:59], v[128:131]
ds_read_b128 a[88:91], v161 offset:20480
s_mul_i32 s17, s4, 7
s_add_u32 s17, s17, s16
v_mfma_f32_16x16x32_bf16 v[132:135], v[56:59], a[60:63], v[132:135]
ds_read_b128 a[92:95], v161 offset:22528
buffer_load_dwordx4 v17, s[36:39], s7 offen offset:1024 lds
v_mfma_f32_16x16x32_bf16 v[172:175], v[56:59], v[156:159], v[172:175]
ds_read_b128 v[216:219], v162 offset:16384
s_lshl_b32 s17, s17, 3
s_waitcnt lgkmcnt(15)
v_mfma_f32_16x16x32_bf16 v[180:183], v[228:231], v[228:231], v[180:183]
ds_read_b128 v[220:223], v163 offset:16384
s_add_u32 s17, s17, s5
v_mfma_f32_16x16x32_bf16 v[136:139], v[60:63], a[48:51], v[136:139]
buffer_load_dwordx4 v18, s[36:39], s7 offen offset:2048 lds
v_mfma_f32_16x16x32_bf16 v[140:143], v[60:63], a[52:55], v[140:143]
s_mul_i32 s17, s17, 8192
s_add_u32 s79, s17, 1048576
v_mfma_f32_16x16x32_bf16 v[144:147], v[60:63], a[56:59], v[144:147]
s_lshl_b32 s16, s16, 7
v_mfma_f32_16x16x32_bf16 v[148:151], v[60:63], a[60:63], v[148:151]
buffer_load_dwordx4 v19, s[36:39], s7 offen offset:3072 lds
v_mfma_f32_16x16x32_bf16 v[176:179], v[60:63], v[156:159], v[176:179]
s_and_b32 s17, s3, 1
s_lshl_b32 s18, s17, 5
v_mfma_f32_16x16x32_bf16 v[184:187], v[156:159], v[228:231], v[184:187]
s_add_u32 s96, s5, 20
s_lshl_b32 s96, s96, 7
v_lshl_add_u32 v4, v0, 6, s95
v_mul_u32_u24 v4, 3584, v4
s_bfm_b64 exec, 7, 0
buffer_load_dword v69, v4, s[44:47], s96 offen
s_mov_b64 exec, -1
v_lshlrev_b32 v4, 7, v0
s_bfm_b64 exec, 4, 0
buffer_load_dword v69, v4, s[68:71], s24 offen sc1
s_mov_b64 exec, -1
s_waitcnt vmcnt(14) lgkmcnt(10)
s_barrier
s_waitcnt lgkmcnt(9)
v_mfma_f32_16x16x32_bf16 v[120:123], v[32:35], a[64:67], v[120:123]
ds_read_b64_tr_b16 v[48:49], v22 offset:49152
s_add_u32 s18, s18, s30
s_waitcnt lgkmcnt(9)
v_mfma_f32_16x16x32_bf16 v[124:127], v[32:35], a[68:71], v[124:127]
ds_read_b64_tr_b16 v[50:51], v22 offset:50176
s_mul_i32 s18, s18, 896
s_waitcnt lgkmcnt(9)
v_mfma_f32_16x16x32_bf16 v[128:131], v[32:35], a[72:75], v[128:131]
ds_read_b64_tr_b16 v[52:53], v24 offset:49152
s_add_u32 s75, s18, s16
s_waitcnt lgkmcnt(9)
v_mfma_f32_16x16x32_bf16 v[132:135], v[32:35], a[76:79], v[132:135]
ds_read_b64_tr_b16 v[54:55], v24 offset:50176
s_sub_u32 s18, s5, 4
s_mul_i32 s18, s18, 112
v_mfma_f32_16x16x32_bf16 v[172:175], v[32:35], v[156:159], v[172:175]
ds_read_b64_tr_b16 v[56:57], v22 offset:57344
s_mul_i32 s17, s17, 28
s_waitcnt lgkmcnt(6)
v_mfma_f32_16x16x32_bf16 v[180:183], v[216:219], v[216:219], v[180:183]
ds_read_b64_tr_b16 v[58:59], v22 offset:58368
s_movk_i32 s7, 768
s_add_u32 m0, s89, 131072
v_mfma_f32_16x16x32_bf16 v[136:139], v[36:39], a[64:67], v[136:139]
ds_read_b64_tr_b16 v[60:61], v24 offset:57344
buffer_load_dwordx4 v96, s[32:35], s7 offen offset:0 lds
v_mfma_f32_16x16x32_bf16 v[140:143], v[36:39], a[68:71], v[140:143]
ds_read_b64_tr_b16 v[62:63], v24 offset:58368
s_add_u32 s18, s18, s17
v_mfma_f32_16x16x32_bf16 v[144:147], v[36:39], a[72:75], v[144:147]
ds_read_b128 a[96:99], v160 offset:24576
s_mul_i32 s18, s18, 896
v_mfma_f32_16x16x32_bf16 v[148:151], v[36:39], a[76:79], v[148:151]
ds_read_b128 a[100:103], v160 offset:26624
buffer_load_dwordx4 v97, s[32:35], s7 offen offset:1024 lds
v_mfma_f32_16x16x32_bf16 v[176:179], v[36:39], v[156:159], v[176:179]
ds_read_b128 a[104:107], v160 offset:28672
s_add_u32 s91, s18, s16
v_mfma_f32_16x16x32_bf16 v[184:187], v[156:159], v[216:219], v[184:187]
ds_read_b128 a[108:111], v160 offset:30720
s_lshr_b32 s16, s3, 1
s_add_u32 s16, s16, s6
v_mfma_f32_16x16x32_bf16 v[120:123], v[40:43], a[80:83], v[120:123]
ds_read_b128 a[112:115], v161 offset:24576
s_add_u32 s7, s94, 1032192
s_add_u32 m0, s72, 16384
s_nop 0
buffer_load_dwordx4 v16, s[36:39], s7 offen offset:0 lds
v_mfma_f32_16x16x32_bf16 v[124:127], v[40:43], a[84:87], v[124:127]
ds_read_b128 a[116:119], v161 offset:26624
s_add_u32 s16, s16, 5
v_mfma_f32_16x16x32_bf16 v[128:131], v[40:43], a[88:91], v[128:131]
ds_read_b128 a[120:123], v161 offset:28672
s_sub_u32 s17, s16, 7
v_mfma_f32_16x16x32_bf16 v[132:135], v[40:43], a[92:95], v[132:135]
ds_read_b128 a[124:127], v161 offset:30720
buffer_load_dwordx4 v17, s[36:39], s7 offen offset:1024 lds
v_mfma_f32_16x16x32_bf16 v[172:175], v[40:43], v[156:159], v[172:175]
ds_read_b128 v[224:227], v162 offset:24576
s_cmp_ge_u32 s16, 7
s_cselect_b32 s16, s17, s16
s_waitcnt lgkmcnt(15)
v_mfma_f32_16x16x32_bf16 v[180:183], v[220:223], v[220:223], v[180:183]
ds_read_b128 v[228:231], v163 offset:24576
v_mfma_f32_16x16x32_bf16 v[136:139], v[44:47], a[80:83], v[136:139]
buffer_load_dwordx4 v18, s[36:39], s7 offen offset:2048 lds
v_mfma_f32_16x16x32_bf16 v[140:143], v[44:47], a[84:87], v[140:143]
s_mul_i32 s17, s4, 7
s_add_u32 s17, s17, s16
v_mfma_f32_16x16x32_bf16 v[144:147], v[44:47], a[88:91], v[144:147]
s_lshl_b32 s17, s17, 3
s_add_u32 s17, s17, s5
v_mfma_f32_16x16x32_bf16 v[148:151], v[44:47], a[92:95], v[148:151]
buffer_load_dwordx4 v19, s[36:39], s7 offen offset:3072 lds
v_mfma_f32_16x16x32_bf16 v[176:179], v[44:47], v[156:159], v[176:179]
s_mul_i32 s17, s17, 8192
v_mfma_f32_16x16x32_bf16 v[184:187], v[156:159], v[220:223], v[184:187]
s_add_u32 s80, s17, 1048576
s_waitcnt vmcnt(14) lgkmcnt(10)
s_barrier
s_waitcnt lgkmcnt(9)
v_mfma_f32_16x16x32_bf16 v[120:123], v[48:51], a[96:99], v[120:123]
ds_read_b64_tr_b16 v[32:33], v23 offset:0
s_lshl_b32 s16, s16, 7
s_waitcnt lgkmcnt(9)
v_mfma_f32_16x16x32_bf16 v[124:127], v[48:51], a[100:103], v[124:127]
ds_read_b64_tr_b16 v[34:35], v23 offset:1024
s_and_b32 s17, s3, 1
s_waitcnt lgkmcnt(9)
v_mfma_f32_16x16x32_bf16 v[128:131], v[48:51], a[104:107], v[128:131]
ds_read_b64_tr_b16 v[36:37], v25 offset:0
s_lshl_b32 s18, s17, 5
s_add_u32 s18, s18, s30
s_waitcnt lgkmcnt(9)
v_mfma_f32_16x16x32_bf16 v[132:135], v[48:51], a[108:111], v[132:135]
ds_read_b64_tr_b16 v[38:39], v25 offset:1024
s_mul_i32 s18, s18, 896
v_mfma_f32_16x16x32_bf16 v[172:175], v[48:51], v[156:159], v[172:175]
ds_read_b64_tr_b16 v[40:41], v23 offset:8192
s_add_u32 s76, s18, s16
s_waitcnt lgkmcnt(6)
v_mfma_f32_16x16x32_bf16 v[180:183], v[224:227], v[224:227], v[180:183]
ds_read_b64_tr_b16 v[42:43], v23 offset:9216
s_lshl_b32 s7, s3, 1
s_lshl_b32 m0, s7, 11
s_add_u32 m0, m0, 139264
s_lshl_b32 s7, s7, 7
v_mfma_f32_16x16x32_bf16 v[136:139], v[52:55], a[96:99], v[136:139]
ds_read_b64_tr_b16 v[44:45], v25 offset:8192
buffer_load_dwordx4 v164, s[32:35], s7 offen offset:0 lds
v_mfma_f32_16x16x32_bf16 v[140:143], v[52:55], a[100:103], v[140:143]
ds_read_b64_tr_b16 v[46:47], v25 offset:9216
s_sub_u32 s18, s5, 4
v_mfma_f32_16x16x32_bf16 v[144:147], v[52:55], a[104:107], v[144:147]
ds_read_b128 a[128:131], v160 offset:32768
s_mul_i32 s18, s18, 112
v_mfma_f32_16x16x32_bf16 v[148:151], v[52:55], a[108:111], v[148:151]
ds_read_b128 a[132:135], v160 offset:34816
buffer_load_dwordx4 v165, s[32:35], s7 offen offset:1024 lds
v_mfma_f32_16x16x32_bf16 v[176:179], v[52:55], v[156:159], v[176:179]
ds_read_b128 a[136:139], v160 offset:36864
s_mul_i32 s17, s17, 28
v_mfma_f32_16x16x32_bf16 v[184:187], v[156:159], v[224:227], v[184:187]
ds_read_b128 a[140:143], v160 offset:38912
s_add_u32 s18, s18, s17
s_mul_i32 s18, s18, 896
v_mfma_f32_16x16x32_bf16 v[120:123], v[56:59], a[112:115], v[120:123]
ds_read_b128 a[144:147], v161 offset:32768
s_lshl_b32 s7, s3, 1
s_min_u32 s7, s7, 5
s_add_u32 s7, s7, 1
s_lshl_b32 m0, s7, 11
s_add_u32 m0, m0, 139264
s_lshl_b32 s7, s7, 7
buffer_load_dwordx4 v164, s[32:35], s7 offen offset:0 lds
v_mfma_f32_16x16x32_bf16 v[124:127], v[56:59], a[116:119], v[124:127]
ds_read_b128 a[148:151], v161 offset:34816
s_add_u32 s92, s18, s16
v_mfma_f32_16x16x32_bf16 v[128:131], v[56:59], a[120:123], v[128:131]
ds_read_b128 a[152:155], v161 offset:36864
s_mul_i32 s17, s4, 7
v_mfma_f32_16x16x32_bf16 v[132:135], v[56:59], a[124:127], v[132:135]
ds_read_b128 a[156:159], v161 offset:38912
buffer_load_dwordx4 v165, s[32:35], s7 offen offset:1024 lds
v_mfma_f32_16x16x32_bf16 v[172:175], v[56:59], v[156:159], v[172:175]
ds_read_b128 v[216:219], v162 offset:32768
s_add_u32 s17, s17, s6
s_waitcnt lgkmcnt(15)
v_mfma_f32_16x16x32_bf16 v[180:183], v[228:231], v[228:231], v[180:183]
ds_read_b128 v[220:223], v163 offset:32768
s_mul_i32 s17, s17, 65536
v_mfma_f32_16x16x32_bf16 v[136:139], v[60:63], a[112:115], v[136:139]
s_add_u32 s7, s73, 0
s_add_u32 m0, s72, 32768
s_nop 0
buffer_load_dwordx4 v8, s[44:47], s7 offen offset:0 lds
v_mfma_f32_16x16x32_bf16 v[140:143], v[60:63], a[116:119], v[140:143]
s_add_u32 s87, s17, 1048576
s_mul_i32 s17, s5, 8192
v_mfma_f32_16x16x32_bf16 v[144:147], v[60:63], a[120:123], v[144:147]
s_add_u32 s81, s87, s17
s_lshl_b32 s16, s6, 7
v_mfma_f32_16x16x32_bf16 v[148:151], v[60:63], a[124:127], v[148:151]
buffer_load_dwordx4 v9, s[44:47], s7 offen offset:1024 lds
v_mfma_f32_16x16x32_bf16 v[176:179], v[60:63], v[156:159], v[176:179]
s_lshl_b32 s18, s3, 4
v_mfma_f32_16x16x32_bf16 v[184:187], v[156:159], v[228:231], v[184:187]
s_add_u32 s18, s18, s30
s_waitcnt vmcnt(14) lgkmcnt(10)
s_barrier
s_waitcnt lgkmcnt(9)
v_mfma_f32_16x16x32_bf16 v[120:123], v[32:35], a[128:131], v[120:123]
ds_read_b64_tr_b16 v[48:49], v22 offset:0
s_mul_i32 s18, s18, 896
s_waitcnt lgkmcnt(9)
v_mfma_f32_16x16x32_bf16 v[124:127], v[32:35], a[132:135], v[124:127]
ds_read_b64_tr_b16 v[50:51], v22 offset:1024
s_add_u32 s77, s18, s16
s_waitcnt lgkmcnt(9)
v_mfma_f32_16x16x32_bf16 v[128:131], v[32:35], a[136:139], v[128:131]
ds_read_b64_tr_b16 v[52:53], v24 offset:0
s_cmp_eq_u32 s5, 7
s_cselect_b32 s88, 2147483632, 0
s_waitcnt lgkmcnt(9)
v_mfma_f32_16x16x32_bf16 v[132:135], v[32:35], a[140:143], v[132:135]
ds_read_b64_tr_b16 v[54:55], v24 offset:1024
s_sub_u32 s18, s5, 4
v_mfma_f32_16x16x32_bf16 v[172:175], v[32:35], v[156:159], v[172:175]
ds_read_b64_tr_b16 v[56:57], v22 offset:8192
s_lshl_b32 s18, s18, 2
s_waitcnt lgkmcnt(6)
v_mfma_f32_16x16x32_bf16 v[180:183], v[216:219], v[216:219], v[180:183]
ds_read_b64_tr_b16 v[58:59], v22 offset:9216
s_add_u32 s7, s73, 0
s_add_u32 m0, s72, 32768
v_mfma_f32_16x16x32_bf16 v[136:139], v[36:39], a[128:131], v[136:139]
ds_read_b64_tr_b16 v[60:61], v24 offset:8192
buffer_load_dwordx4 v10, s[44:47], s7 offen offset:2048 lds
v_mfma_f32_16x16x32_bf16 v[140:143], v[36:39], a[132:135], v[140:143]
ds_read_b64_tr_b16 v[62:63], v24 offset:9216
s_add_u32 s18, s18, s3
v_mfma_f32_16x16x32_bf16 v[144:147], v[36:39], a[136:139], v[144:147]
ds_read_b128 a[160:163], v160 offset:40960
s_mul_i32 s18, s18, 25088
v_mfma_f32_16x16x32_bf16 v[148:151], v[36:39], a[140:143], v[148:151]
ds_read_b128 a[164:167], v160 offset:43008
buffer_load_dwordx4 v11, s[44:47], s7 offen offset:3072 lds
v_mfma_f32_16x16x32_bf16 v[176:179], v[36:39], v[156:159], v[176:179]
ds_read_b128 a[168:171], v160 offset:45056
s_add_u32 s93, s18, s16
v_mfma_f32_16x16x32_bf16 v[184:187], v[156:159], v[216:219], v[184:187]
ds_read_b128 a[172:175], v160 offset:47104
s_bfe_u32 s48, s29, 0x30000
v_mfma_f32_16x16x32_bf16 v[120:123], v[40:43], a[144:147], v[120:123]
ds_read_b128 a[176:179], v161 offset:40960
s_add_u32 s7, s73, 458752
s_add_u32 m0, s72, 49152
s_nop 0
buffer_load_dwordx4 v8, s[44:47], s7 offen offset:0 lds
v_mfma_f32_16x16x32_bf16 v[124:127], v[40:43], a[148:151], v[124:127]
ds_read_b128 a[180:183], v161 offset:43008
s_mul_i32 s48, s48, 8192
v_mfma_f32_16x16x32_bf16 v[128:131], v[40:43], a[152:155], v[128:131]
ds_read_b128 a[184:187], v161 offset:45056
s_add_u32 s48, s48, s87
s_bfe_u32 s49, s29, 0x30004
v_mfma_f32_16x16x32_bf16 v[132:135], v[40:43], a[156:159], v[132:135]
ds_read_b128 a[188:191], v161 offset:47104
buffer_load_dwordx4 v9, s[44:47], s7 offen offset:1024 lds
v_mfma_f32_16x16x32_bf16 v[172:175], v[40:43], v[156:159], v[172:175]
ds_read_b128 v[224:227], v162 offset:40960
s_mul_i32 s49, s49, 8192
s_waitcnt lgkmcnt(15)
v_mfma_f32_16x16x32_bf16 v[180:183], v[220:223], v[220:223], v[180:183]
ds_read_b128 v[228:231], v163 offset:40960
s_add_u32 s49, s49, s87
v_mfma_f32_16x16x32_bf16 v[136:139], v[44:47], a[144:147], v[136:139]
buffer_load_dwordx4 v10, s[44:47], s7 offen offset:2048 lds
v_mfma_f32_16x16x32_bf16 v[140:143], v[44:47], a[148:151], v[140:143]
s_bfe_u32 s50, s29, 0x30008
s_mul_i32 s50, s50, 8192
v_mfma_f32_16x16x32_bf16 v[144:147], v[44:47], a[152:155], v[144:147]
s_add_u32 s50, s50, s87
v_mfma_f32_16x16x32_bf16 v[148:151], v[44:47], a[156:159], v[148:151]
buffer_load_dwordx4 v11, s[44:47], s7 offen offset:3072 lds
v_mfma_f32_16x16x32_bf16 v[176:179], v[44:47], v[156:159], v[176:179]
s_bfe_u32 s51, s29, 0x3000c
s_mul_i32 s51, s51, 8192
v_mfma_f32_16x16x32_bf16 v[184:187], v[156:159], v[220:223], v[184:187]
s_bfm_b64 exec, 28, 32
buffer_load_dword v69, v254, s[36:39], 0 offen
s_mov_b64 exec, -1
s_bfm_b64 exec, 28, 0
buffer_load_dword v69, v254, s[36:39], 0 offen offset:1792
s_mov_b64 exec, -1
s_waitcnt vmcnt(14) lgkmcnt(10)
s_barrier
s_waitcnt lgkmcnt(9)
v_mfma_f32_16x16x32_bf16 v[120:123], v[48:51], a[160:163], v[120:123]
ds_read_b64_tr_b16 v[32:33], v22 offset:16384
s_waitcnt lgkmcnt(9)
v_mfma_f32_16x16x32_bf16 v[124:127], v[48:51], a[164:167], v[124:127]
ds_read_b64_tr_b16 v[34:35], v22 offset:17408
s_add_u32 s51, s51, s87
s_waitcnt lgkmcnt(9)
v_mfma_f32_16x16x32_bf16 v[128:131], v[48:51], a[168:171], v[128:131]
ds_read_b64_tr_b16 v[36:37], v24 offset:16384
s_waitcnt lgkmcnt(9)
v_mfma_f32_16x16x32_bf16 v[132:135], v[48:51], a[172:175], v[132:135]
ds_read_b64_tr_b16 v[38:39], v24 offset:17408
v_mfma_f32_16x16x32_bf16 v[172:175], v[48:51], v[156:159], v[172:175]
ds_read_b64_tr_b16 v[40:41], v22 offset:24576
s_bfe_u32 s56, s29, 0x30010
s_waitcnt lgkmcnt(6)
v_mfma_f32_16x16x32_bf16 v[180:183], v[224:227], v[224:227], v[180:183]
ds_read_b64_tr_b16 v[42:43], v22 offset:25600
v_mfma_f32_16x16x32_bf16 v[136:139], v[52:55], a[160:163], v[136:139]
ds_read_b64_tr_b16 v[44:45], v24 offset:24576
v_mfma_f32_16x16x32_bf16 v[140:143], v[52:55], a[164:167], v[140:143]
ds_read_b64_tr_b16 v[46:47], v24 offset:25600
s_mul_i32 s56, s56, 8192
v_mfma_f32_16x16x32_bf16 v[144:147], v[52:55], a[168:171], v[144:147]
ds_read_b128 v[216:219], v162 offset:49152
v_mfma_f32_16x16x32_bf16 v[148:151], v[52:55], a[172:175], v[148:151]
ds_read_b128 v[220:223], v163 offset:49152
v_mfma_f32_16x16x32_bf16 v[176:179], v[52:55], v[156:159], v[176:179]
ds_read_b128 a[192:195], v160 offset:49152
s_add_u32 s56, s56, s87
v_mfma_f32_16x16x32_bf16 v[184:187], v[156:159], v[224:227], v[184:187]
ds_read_b128 a[196:199], v160 offset:51200
v_mfma_f32_16x16x32_bf16 v[120:123], v[56:59], a[176:179], v[120:123]
ds_read_b128 a[200:203], v160 offset:53248
v_mfma_f32_16x16x32_bf16 v[124:127], v[56:59], a[180:183], v[124:127]
ds_read_b128 a[204:207], v160 offset:55296
s_add_u32 s7, s73, 917504
s_add_u32 m0, s72, 65536
v_mfma_f32_16x16x32_bf16 v[128:131], v[56:59], a[184:187], v[128:131]
ds_read_b128 a[208:211], v161 offset:49152
buffer_load_dwordx4 v8, s[44:47], s7 offen offset:0 lds
v_mfma_f32_16x16x32_bf16 v[132:135], v[56:59], a[188:191], v[132:135]
ds_read_b128 a[212:215], v161 offset:51200
s_bfe_u32 s57, s29, 0x30014
v_mfma_f32_16x16x32_bf16 v[172:175], v[56:59], v[156:159], v[172:175]
ds_read_b128 a[216:219], v161 offset:53248
s_waitcnt lgkmcnt(15)
v_mfma_f32_16x16x32_bf16 v[180:183], v[228:231], v[228:231], v[180:183]
ds_read_b128 a[220:223], v161 offset:55296
buffer_load_dwordx4 v9, s[44:47], s7 offen offset:1024 lds
v_mfma_f32_16x16x32_bf16 v[136:139], v[60:63], a[176:179], v[136:139]
s_mul_i32 s57, s57, 8192
v_mfma_f32_16x16x32_bf16 v[140:143], v[60:63], a[180:183], v[140:143]
s_add_u32 s57, s57, s87
v_mfma_f32_16x16x32_bf16 v[144:147], v[60:63], a[184:187], v[144:147]
v_mfma_f32_16x16x32_bf16 v[148:151], v[60:63], a[188:191], v[148:151]
buffer_load_dwordx4 v10, s[44:47], s7 offen offset:2048 lds
v_mfma_f32_16x16x32_bf16 v[176:179], v[60:63], v[156:159], v[176:179]
s_bfe_u32 s58, s29, 0x30018
v_mfma_f32_16x16x32_bf16 v[184:187], v[156:159], v[228:231], v[184:187]
s_mul_i32 s58, s58, 8192
s_waitcnt lgkmcnt(9)
v_mfma_f32_16x16x32_bf16 v[180:183], v[216:219], v[216:219], v[180:183]
buffer_load_dwordx4 v11, s[44:47], s7 offen offset:3072 lds
v_mfma_f32_16x16x32_bf16 v[184:187], v[156:159], v[216:219], v[184:187]
s_waitcnt lgkmcnt(8)
v_mfma_f32_16x16x32_bf16 v[180:183], v[220:223], v[220:223], v[180:183]
s_add_u32 s58, s58, s87
v_mfma_f32_16x16x32_bf16 v[184:187], v[156:159], v[220:223], v[184:187]
v_mov_b32 v4, 1
s_lshl_b32 s96, s4, 3
s_cmp_eq_u32 s3, 0
s_cselect_b32 s96, s96, 2147483632
buffer_atomic_add v4, v7, s[64:67], s96 offen sc1
s_waitcnt vmcnt(11)
s_barrier
s_waitcnt lgkmcnt(7)
v_mfma_f32_16x16x32_bf16 v[120:123], v[32:35], a[192:195], v[120:123]
ds_read_b64_tr_b16 v[48:49], v20 offset:32768
v_lshlrev_b32 v92, 16, v94
v_and_b32 v93, 0xffff0000, v94
s_waitcnt lgkmcnt(7)
v_mfma_f32_16x16x32_bf16 v[124:127], v[32:35], a[196:199], v[124:127]
ds_read_b64_tr_b16 v[50:51], v20 offset:33280
s_mov_b32 vcc_lo, 0xaaaaaaaa
s_mov_b32 vcc_hi, 0xaaaaaaaa
v_cndmask_b32 v188, v180, v181, vcc
v_cndmask_b32 v189, v182, v183, vcc
s_mov_b32 vcc_lo, 0xcccccccc
s_mov_b32 vcc_hi, 0xcccccccc
v_cndmask_b32 v188, v188, v189, vcc
v_lshlrev_b32 v94, 16, v95
s_waitcnt lgkmcnt(7)
v_mfma_f32_16x16x32_bf16 v[128:131], v[32:35], a[200:203], v[128:131]
ds_read_b64_tr_b16 v[52:53], v20 offset:36864
v_and_b32 v95, 0xffff0000, v95
s_waitcnt lgkmcnt(7)
v_mfma_f32_16x16x32_bf16 v[132:135], v[32:35], a[204:207], v[132:135]
ds_read_b64_tr_b16 v[54:55], v20 offset:37376
v_mul_f32 v189, 0xbb124925, v184
v_add_u32 v160, 57344, v160
v_mfma_f32_16x16x32_bf16 v[172:175], v[32:35], v[156:159], v[172:175]
ds_read_b64_tr_b16 v[56:57], v20 offset:40960
v_mul_f32 v188, 0x3b124925, v188
v_fma_f32 v188, -v189, v189, v188
v_add_u32 v161, 57344, v161
v_mfma_f32_16x16x32_bf16 v[136:139], v[36:39], a[192:195], v[136:139]
ds_read_b64_tr_b16 v[58:59], v20 offset:41472
v_max_f32 v188, 0, v188
v_add_f32 v190, 0x3727c5ac, v188
v_mfma_f32_16x16x32_bf16 v[140:143], v[36:39], a[196:199], v[140:143]
ds_read_b64_tr_b16 v[60:61], v20 offset:45056
v_rsq_f32 v190, v190
s_nop 0
v_mul_f32 v188, v188, v190
v_mfma_f32_16x16x32_bf16 v[144:147], v[36:39], a[200:203], v[144:147]
ds_read_b64_tr_b16 v[62:63], v20 offset:45568
v_mul_f32 v188, v188, v190
v_add_f32 v188, 0x3727c5ac, v188
v_mfma_f32_16x16x32_bf16 v[148:151], v[36:39], a[204:207], v[148:151]
v_rsq_f32 v188, v188
s_nop 0
v_mul_f32 v191, v190, v188
v_mfma_f32_16x16x32_bf16 v[176:179], v[36:39], v[156:159], v[176:179]
s_add_u32 s7, s31, 1376256
s_add_u32 m0, s89, 0
v_mul_f32 v192, 0x3e8b97f6, v190
s_waitcnt lgkmcnt(11)
v_mfma_f32_16x16x32_bf16 v[120:123], v[40:43], a[208:211], v[120:123]
buffer_load_dwordx4 v8, s[44:47], s7 offen offset:0 lds
s_waitcnt lgkmcnt(10)
v_mfma_f32_16x16x32_bf16 v[124:127], v[40:43], a[212:215], v[124:127]
ds_write2_b32 v167, v189, v191 offset0:0 offset1:64
ds_write2_b32 v167, v192, v190 offset0:128 offset1:224
s_waitcnt lgkmcnt(11)
v_mfma_f32_16x16x32_bf16 v[128:131], v[40:43], a[216:219], v[128:131]
buffer_load_dwordx4 v9, s[44:47], s7 offen offset:1024 lds
s_waitcnt lgkmcnt(10)
v_mfma_f32_16x16x32_bf16 v[132:135], v[40:43], a[220:223], v[132:135]
v_mfma_f32_16x16x32_bf16 v[172:175], v[40:43], v[156:159], v[172:175]
v_mfma_f32_16x16x32_bf16 v[136:139], v[44:47], a[208:211], v[136:139]
v_mfma_f32_16x16x32_bf16 v[140:143], v[44:47], a[212:215], v[140:143]
v_mfma_f32_16x16x32_bf16 v[144:147], v[44:47], a[216:219], v[144:147]
v_mfma_f32_16x16x32_bf16 v[148:151], v[44:47], a[220:223], v[148:151]
v_mfma_f32_16x16x32_bf16 v[176:179], v[44:47], v[156:159], v[176:179]
s_waitcnt vmcnt(9) lgkmcnt(0)
s_barrier
v_mfma_f32_16x16x32_bf16 v[200:203], v[48:51], a[0:3], 0
ds_read2_b32 v[152:153], v30 offset0:16 offset1:32
ds_read2_b32 v[154:155], v30 offset0:48 offset1:64
ds_read_b64_tr_b16 v[32:33], v20 offset:49152
v_mfma_f32_16x16x32_bf16 v[204:207], v[48:51], a[4:7], 0
ds_read_b64_tr_b16 v[34:35], v20 offset:49664
v_mfma_f32_16x16x32_bf16 v[208:211], v[48:51], a[8:11], 0
ds_read_b64_tr_b16 v[36:37], v20 offset:53248
v_mfma_f32_16x16x32_bf16 v[212:215], v[48:51], a[12:15], 0
ds_read_b64_tr_b16 v[38:39], v20 offset:53760
v_mfma_f32_16x16x32_bf16 v[248:251], v[48:51], v[156:159], 0
ds_read_b64_tr_b16 v[40:41], v20 offset:57344
s_add_u32 s7, s94, 896
s_add_u32 m0, s72, 16384
v_mfma_f32_16x16x32_bf16 v[200:203], v[52:55], a[16:19], v[200:203]
ds_read_b64_tr_b16 v[42:43], v20 offset:57856
buffer_load_dwordx4 v16, s[36:39], s7 offen offset:0 lds
v_mfma_f32_16x16x32_bf16 v[204:207], v[52:55], a[20:23], v[204:207]
ds_read_b64_tr_b16 v[44:45], v20 offset:61440
ds_write_b128 v169, v[156:159]
v_mfma_f32_16x16x32_bf16 v[208:211], v[52:55], a[24:27], v[208:211]
ds_read_b64_tr_b16 v[46:47], v20 offset:61952
buffer_load_dwordx4 v17, s[36:39], s7 offen offset:1024 lds
v_mfma_f32_16x16x32_bf16 v[212:215], v[52:55], a[28:31], v[212:215]
ds_read2_b32 v[88:89], v30 offset0:80 offset1:96
v_mov_b32 v108, 0
s_waitcnt lgkmcnt(11)
v_fmac_f32 v120, v152, v172
v_fmac_f32 v121, v152, v173
v_mfma_f32_16x16x32_bf16 v[248:251], v[52:55], v[156:159], v[248:251]
ds_read2_b32 v[90:91], v30 offset0:112 offset1:128
v_lshlrev_b32 v2, 16, v113
v_and_b32 v3, 0xffff0000, v113
v_lshlrev_b32 v1, 3, v0
v_add_u32 v1, 156160, v1
ds_write_b64 v1, v[2:3]
v_mfma_f32_16x16x32_bf16 v[200:203], v[56:59], a[32:35], v[200:203]
buffer_load_dwordx4 v18, s[36:39], s7 offen offset:2048 lds
v_fmac_f32 v122, v152, v174
v_mfma_f32_16x16x32_bf16 v[204:207], v[56:59], a[36:39], v[204:207]
v_fmac_f32 v123, v152, v175
v_fmac_f32 v136, v152, v176
v_fmac_f32 v137, v152, v177
v_mov_b32 v109, 0
v_mfma_f32_16x16x32_bf16 v[208:211], v[56:59], a[40:43], v[208:211]
buffer_load_dwordx4 v19, s[36:39], s7 offen offset:3072 lds
v_mfma_f32_16x16x32_bf16 v[212:215], v[56:59], a[44:47], v[212:215]
v_fmac_f32 v138, v152, v178
v_fmac_f32 v139, v152, v179
v_cvt_pk_bf16_f32 v216, v120, v121
v_cvt_pk_bf16_f32 v217, v122, v123
v_mfma_f32_16x16x32_bf16 v[248:251], v[56:59], v[156:159], v[248:251]
v_cvt_pk_bf16_f32 v218, v136, v137
v_cvt_pk_bf16_f32 v219, v138, v139
v_mov_b32 v110, 0
v_and_b32 v218, v71, v218
v_mfma_f32_16x16x32_bf16 v[200:203], v[60:63], a[48:51], v[200:203]
s_add_u32 s7, s94, 172928
s_add_u32 m0, s72, 32768
s_nop 0
buffer_load_dwordx4 v16, s[36:39], s7 offen offset:0 lds
v_mfma_f32_16x16x32_bf16 v[204:207], v[60:63], a[52:55], v[204:207]
v_and_b32 v219, v71, v219
v_fmac_f32 v124, v153, v172
v_fmac_f32 v125, v153, v173
v_fmac_f32 v126, v153, v174
v_mfma_f32_16x16x32_bf16 v[208:211], v[60:63], a[56:59], v[208:211]
buffer_load_dwordx4 v17, s[36:39], s7 offen offset:1024 lds
v_fmac_f32 v127, v153, v175
v_mfma_f32_16x16x32_bf16 v[212:215], v[60:63], a[60:63], v[212:215]
v_mov_b32 v111, 0
v_fmac_f32 v140, v153, v176
v_fmac_f32 v141, v153, v177
v_fmac_f32 v142, v153, v178
v_mfma_f32_16x16x32_bf16 v[248:251], v[60:63], v[156:159], v[248:251]
v_fmac_f32 v143, v153, v179
v_cvt_pk_bf16_f32 v220, v124, v125
s_waitcnt vmcnt(9) lgkmcnt(3)
s_barrier
v_mfma_f32_16x16x32_bf16 v[200:203], v[32:35], a[64:67], v[200:203]
ds_read_b64_tr_b16 v[48:49], v21 offset:0
v_cvt_pk_bf16_f32 v221, v126, v127
v_cvt_pk_bf16_f32 v222, v140, v141
v_mfma_f32_16x16x32_bf16 v[204:207], v[32:35], a[68:71], v[204:207]
ds_read_b64_tr_b16 v[50:51], v21 offset:512
v_cvt_pk_bf16_f32 v223, v142, v143
v_and_b32 v222, v71, v222
v_and_b32 v223, v71, v223
v_mfma_f32_16x16x32_bf16 v[208:211], v[32:35], a[72:75], v[208:211]
ds_read_b64_tr_b16 v[52:53], v21 offset:4096
v_fmac_f32 v128, v154, v172
v_fmac_f32 v129, v154, v173
v_mfma_f32_16x16x32_bf16 v[212:215], v[32:35], a[76:79], v[212:215]
ds_read_b64_tr_b16 v[54:55], v21 offset:4608
v_fmac_f32 v130, v154, v174
v_fmac_f32 v131, v154, v175
v_mfma_f32_16x16x32_bf16 v[248:251], v[32:35], v[156:159], v[248:251]
ds_read_b64_tr_b16 v[56:57], v21 offset:8192
s_add_u32 s7, s94, 172928
s_add_u32 m0, s72, 32768
v_fmac_f32 v144, v154, v176
v_mfma_f32_16x16x32_bf16 v[200:203], v[36:39], a[80:83], v[200:203]
ds_read_b64_tr_b16 v[58:59], v21 offset:8704
buffer_load_dwordx4 v18, s[36:39], s7 offen offset:2048 lds
v_mfma_f32_16x16x32_bf16 v[204:207], v[36:39], a[84:87], v[204:207]
ds_read_b64_tr_b16 v[60:61], v21 offset:12288
v_fmac_f32 v145, v154, v177
v_fmac_f32 v146, v154, v178
v_mfma_f32_16x16x32_bf16 v[208:211], v[36:39], a[88:91], v[208:211]
ds_read_b64_tr_b16 v[62:63], v21 offset:12800
buffer_load_dwordx4 v19, s[36:39], s7 offen offset:3072 lds
v_mfma_f32_16x16x32_bf16 v[212:215], v[36:39], a[92:95], v[212:215]
ds_read_b128 v[96:99], v166 offset:0
v_fmac_f32 v147, v154, v179
v_cvt_pk_bf16_f32 v224, v128, v129
v_cvt_pk_bf16_f32 v225, v130, v131
v_mfma_f32_16x16x32_bf16 v[248:251], v[36:39], v[156:159], v[248:251]
ds_read_b128 v[100:103], v166 offset:4096
v_cvt_pk_bf16_f32 v226, v144, v145
v_cvt_pk_bf16_f32 v227, v146, v147
v_mfma_f32_16x16x32_bf16 v[200:203], v[40:43], a[96:99], v[200:203]
ds_read_b128 v[104:107], v166 offset:8192
s_add_u32 s7, s94, 344960
s_add_u32 m0, s72, 49152
s_nop 0
buffer_load_dwordx4 v16, s[36:39], s7 offen offset:0 lds
v_mfma_f32_16x16x32_bf16 v[204:207], v[40:43], a[100:103], v[204:207]
s_mov_b32 exec_lo, 0x33333333
s_mov_b32 exec_hi, 0x33333333
ds_read_b128 v[108:111], v166 offset:12288
s_mov_b64 exec, -1
v_mfma_f32_16x16x32_bf16 v[208:211], v[40:43], a[104:107], v[208:211]
buffer_load_dwordx4 v17, s[36:39], s7 offen offset:1024 lds
v_mfma_f32_16x16x32_bf16 v[212:215], v[40:43], a[108:111], v[212:215]
v_and_b32 v226, v71, v226
v_and_b32 v227, v71, v227
v_fmac_f32 v132, v155, v172
v_mfma_f32_16x16x32_bf16 v[248:251], v[40:43], v[156:159], v[248:251]
v_fmac_f32 v133, v155, v173
v_fmac_f32 v134, v155, v174
v_fmac_f32 v135, v155, v175
v_mfma_f32_16x16x32_bf16 v[200:203], v[44:47], a[112:115], v[200:203]
buffer_load_dwordx4 v18, s[36:39], s7 offen offset:2048 lds
v_fmac_f32 v148, v155, v176
v_mfma_f32_16x16x32_bf16 v[204:207], v[44:47], a[116:119], v[204:207]
v_fmac_f32 v149, v155, v177
v_fmac_f32 v150, v155, v178
v_fmac_f32 v151, v155, v179
v_mfma_f32_16x16x32_bf16 v[208:211], v[44:47], a[120:123], v[208:211]
buffer_load_dwordx4 v19, s[36:39], s7 offen offset:3072 lds
v_mfma_f32_16x16x32_bf16 v[212:215], v[44:47], a[124:127], v[212:215]
v_cvt_pk_bf16_f32 v228, v132, v133
v_cvt_pk_bf16_f32 v229, v134, v135
v_cvt_pk_bf16_f32 v230, v148, v149
v_mfma_f32_16x16x32_bf16 v[248:251], v[44:47], v[156:159], v[248:251]
v_cvt_pk_bf16_f32 v231, v150, v151
v_and_b32 v230, v71, v230
s_waitcnt vmcnt(12) lgkmcnt(4)
s_barrier
v_mfma_f32_16x16x32_bf16 v[200:203], v[48:51], a[128:131], v[200:203]
ds_read_b64_tr_b16 v[32:33], v20 offset:0
v_mfma_f32_16x16x32_bf16 v[204:207], v[48:51], a[132:135], v[204:207]
ds_read_b64_tr_b16 v[34:35], v20 offset:512
v_mfma_f32_16x16x32_bf16 v[208:211], v[48:51], a[136:139], v[208:211]
ds_read_b64_tr_b16 v[36:37], v20 offset:4096
v_mfma_f32_16x16x32_bf16 v[212:215], v[48:51], a[140:143], v[212:215]
ds_read_b64_tr_b16 v[38:39], v20 offset:4608
v_mfma_f32_16x16x32_bf16 v[248:251], v[48:51], v[156:159], v[248:251]
ds_read_b128 a[224:227], v160 offset:0
v_mfma_f32_16x16x32_bf16 v[200:203], v[52:55], a[144:147], v[200:203]
ds_read_b128 a[228:231], v161 offset:0
v_mfma_f32_16x16x32_bf16 v[204:207], v[52:55], a[148:151], v[204:207]
ds_read_b128 a[232:235], v160 offset:2048
v_mfma_f32_16x16x32_bf16 v[208:211], v[52:55], a[152:155], v[208:211]
ds_read_b128 a[236:239], v161 offset:2048
v_mfma_f32_16x16x32_bf16 v[212:215], v[52:55], a[156:159], v[212:215]
ds_read_b128 a[240:243], v160 offset:4096
v_mfma_f32_16x16x32_bf16 v[248:251], v[52:55], v[156:159], v[248:251]
ds_read_b128 a[244:247], v161 offset:4096
v_mfma_f32_16x16x32_bf16 v[200:203], v[56:59], a[160:163], v[200:203]
ds_read_b128 a[248:251], v160 offset:6144
v_mfma_f32_16x16x32_bf16 v[204:207], v[56:59], a[164:167], v[204:207]
ds_read_b128 a[252:255], v161 offset:6144
v_mfma_f32_16x16x32_bf16 v[208:211], v[56:59], a[168:171], v[208:211]
v_mfma_f32_16x16x32_bf16 v[212:215], v[56:59], a[172:175], v[212:215]
s_add_u32 s7, s94, 516992
s_add_u32 m0, s72, 65536
v_mfma_f32_16x16x32_bf16 v[248:251], v[56:59], v[156:159], v[248:251]
buffer_load_dwordx4 v16, s[36:39], s7 offen offset:0 lds
v_mfma_f32_16x16x32_bf16 v[200:203], v[60:63], a[176:179], v[200:203]
v_mfma_f32_16x16x32_bf16 v[204:207], v[60:63], a[180:183], v[204:207]
v_mfma_f32_16x16x32_bf16 v[208:211], v[60:63], a[184:187], v[208:211]
buffer_load_dwordx4 v17, s[36:39], s7 offen offset:1024 lds
v_mfma_f32_16x16x32_bf16 v[212:215], v[60:63], a[188:191], v[212:215]
v_mfma_f32_16x16x32_bf16 v[248:251], v[60:63], v[156:159], v[248:251]
s_waitcnt lgkmcnt(15)
v_mfma_f32_16x16x32_bf16 v[180:183], v[96:99], v[96:99], 0
v_mfma_f32_16x16x32_bf16 v[184:187], v[156:159], v[96:99], 0
buffer_load_dwordx4 v18, s[36:39], s7 offen offset:2048 lds
s_waitcnt lgkmcnt(14)
v_mfma_f32_16x16x32_bf16 v[180:183], v[100:103], v[100:103], v[180:183]
v_mfma_f32_16x16x32_bf16 v[184:187], v[156:159], v[100:103], v[184:187]
s_waitcnt lgkmcnt(13)
v_mfma_f32_16x16x32_bf16 v[180:183], v[104:107], v[104:107], v[180:183]
buffer_load_dwordx4 v19, s[36:39], s7 offen offset:3072 lds
v_mfma_f32_16x16x32_bf16 v[184:187], v[156:159], v[104:107], v[184:187]
s_waitcnt lgkmcnt(12)
v_mfma_f32_16x16x32_bf16 v[180:183], v[108:111], v[108:111], v[180:183]
v_mfma_f32_16x16x32_bf16 v[184:187], v[156:159], v[108:111], v[184:187]
s_mul_i32 s96, s5, 344064
s_sub_u32 s96, s96, 1376256
s_mul_i32 s97, s95, 5376
s_add_u32 s96, s96, s97
v_lshlrev_b32 v4, 7, v0
s_bfm_b64 exec, 42, 0
buffer_load_dword v69, v4, s[52:55], s96 offen
s_mov_b64 exec, -1
s_add_u32 s96, s5, 20
s_mul_i32 s96, s96, 57344
s_mul_i32 s97, s95, 896
s_add_u32 s96, s96, s97
v_lshlrev_b32 v4, 7, v0
s_bfm_b64 exec, 7, 0
buffer_load_dword v69, v4, s[52:55], s96 offen
s_mov_b64 exec, -1
s_sub_u32 s96, s5, 4
s_mul_i32 s96, s96, 100352
s_mul_i32 s97, s95, 1664
s_add_u32 s96, s96, s97
v_lshlrev_b32 v4, 7, v0
s_bfm_b64 exec, 13, 0
buffer_load_dword v69, v4, s[40:43], s96 offen
s_mov_b64 exec, -1
s_waitcnt vmcnt(15) lgkmcnt(8)
s_barrier
v_mfma_f32_16x16x32_bf16 v[200:203], v[32:35], a[192:195], v[200:203]
ds_read_b64_tr_b16 v[48:49], v22 offset:16384
v_mfma_f32_16x16x32_bf16 v[204:207], v[32:35], a[196:199], v[204:207]
ds_read_b64_tr_b16 v[50:51], v22 offset:17408
s_mov_b32 vcc_lo, 0xaaaaaaaa
s_mov_b32 vcc_hi, 0xaaaaaaaa
v_cndmask_b32 v188, v180, v181, vcc
v_cndmask_b32 v189, v182, v183, vcc
s_mov_b32 vcc_lo, 0xcccccccc
s_mov_b32 vcc_hi, 0xcccccccc
v_cndmask_b32 v188, v188, v189, vcc
v_mfma_f32_16x16x32_bf16 v[208:211], v[32:35], a[200:203], v[208:211]
ds_read_b64_tr_b16 v[52:53], v24 offset:16384
v_add_f32_dpp v188, v188, v188 quad_perm:[1,0,3,2] row_mask:0xf bank_mask:0xf
v_add_f32_dpp v184, v184, v184 quad_perm:[1,0,3,2] row_mask:0xf bank_mask:0xf
s_nop 0
v_add_f32_dpp v188, v188, v188 quad_perm:[2,3,0,1] row_mask:0xf bank_mask:0xf
v_and_b32 v231, v71, v231
v_mfma_f32_16x16x32_bf16 v[212:215], v[32:35], a[204:207], v[212:215]
ds_read_b64_tr_b16 v[54:55], v24 offset:17408
v_add_f32_dpp v184, v184, v184 quad_perm:[2,3,0,1] row_mask:0xf bank_mask:0xf
v_mul_f32 v189, 0xbb124925, v184
v_mul_f32 v188, 0x3b124925, v188
v_fma_f32 v188, -v189, v189, v188
v_mfma_f32_16x16x32_bf16 v[248:251], v[32:35], v[156:159], v[248:251]
ds_read_b64_tr_b16 v[56:57], v22 offset:24576
s_add_u32 s7, s94, 689024
s_add_u32 m0, s72, 0
v_max_f32 v188, 0, v188
v_add_f32 v190, 0x3727c5ac, v188
v_mfma_f32_16x16x32_bf16 v[200:203], v[36:39], a[208:211], v[200:203]
ds_read_b64_tr_b16 v[58:59], v22 offset:25600
buffer_load_dwordx4 v16, s[36:39], s7 offen offset:0 lds
v_mfma_f32_16x16x32_bf16 v[204:207], v[36:39], a[212:215], v[204:207]
ds_read_b64_tr_b16 v[60:61], v24 offset:24576
buffer_load_dwordx4 v17, s[36:39], s7 offen offset:1024 lds
v_rsq_f32 v190, v190
v_mfma_f32_16x16x32_bf16 v[208:211], v[36:39], a[216:219], v[208:211]
ds_read_b64_tr_b16 v[62:63], v24 offset:25600
buffer_load_dwordx4 v18, s[36:39], s7 offen offset:2048 lds
v_mfma_f32_16x16x32_bf16 v[212:215], v[36:39], a[220:223], v[212:215]
ds_write2_b32 v168, v189, v190 offset0:0 offset1:224
ds_read_b128 v[96:99], v160 offset:8192
buffer_load_dwordx4 v19, s[36:39], s7 offen offset:3072 lds
v_mfma_f32_16x16x32_bf16 v[248:251], v[36:39], v[156:159], v[248:251]
ds_read_b128 v[100:103], v161 offset:8192
ds_read_b128 v[104:107], v160 offset:10240
ds_read_b128 v[108:111], v161 offset:10240
ds_read_b128 v[112:115], v160 offset:12288
ds_read_b128 v[116:119], v161 offset:12288
s_waitcnt vmcnt(15) lgkmcnt(6)
s_barrier
v_mfma_f32_16x16x32_bf16 v[160:163], v[48:51], a[224:227], 0
ds_read_b64_tr_b16 v[32:33], v22 offset:32768
s_add_u32 s98, s89, 16384
v_add_u32 v3, s98, v31
v_mfma_f32_16x16x32_bf16 v[164:167], v[48:51], a[0:3], 0
ds_read_b64_tr_b16 v[34:35], v22 offset:33792
v_lshrrev_b32 v10, 4, v0
v_mfma_f32_16x16x32_bf16 v[168:171], v[48:51], a[4:7], 0
ds_read_b64_tr_b16 v[36:37], v24 offset:32768
v_fmac_f32 v200, v152, v248
v_fmac_f32 v201, v152, v249
v_mfma_f32_16x16x32_bf16 v[172:175], v[48:51], a[8:11], 0
ds_read_b64_tr_b16 v[38:39], v24 offset:33792
v_fmac_f32 v202, v152, v250
v_mfma_f32_16x16x32_bf16 v[176:179], v[48:51], a[12:15], 0
ds_read_b64_tr_b16 v[40:41], v22 offset:40960
v_fmac_f32 v203, v152, v251
v_fma_f32 v200, v200, v88, v92
v_mfma_f32_16x16x32_bf16 v[180:183], v[52:55], a[224:227], 0
ds_read_b64_tr_b16 v[42:43], v22 offset:41984
v_fma_f32 v201, v201, v88, v93
v_mfma_f32_16x16x32_bf16 v[184:187], v[52:55], a[0:3], 0
ds_read_b64_tr_b16 v[44:45], v24 offset:40960
v_fma_f32 v202, v202, v88, v94
v_fma_f32 v203, v203, v88, v95
v_mfma_f32_16x16x32_bf16 v[188:191], v[52:55], a[4:7], 0
ds_read_b64_tr_b16 v[46:47], v24 offset:41984
v_mul_f32 v232, v200, v200
v_mfma_f32_16x16x32_bf16 v[192:195], v[52:55], a[8:11], 0
v_mul_f32 v233, v201, v201
v_mul_f32 v234, v202, v202
v_mul_f32 v235, v203, v203
v_mfma_f32_16x16x32_bf16 v[196:199], v[52:55], a[12:15], 0
s_add_u32 s7, s94, 861056
s_add_u32 m0, s72, 16384
v_mfma_f32_16x16x32_bf16 v[160:163], v[56:59], a[228:231], v[160:163]
buffer_load_dwordx4 v16, s[36:39], s7 offen offset:0 lds
v_fma_f32 v232, v232, s82, v70
v_mfma_f32_16x16x32_bf16 v[164:167], v[56:59], a[16:19], v[164:167]
v_lshlrev_b32 v10, 4, v10
v_fma_f32 v233, v233, s82, v70
v_mfma_f32_16x16x32_bf16 v[168:171], v[56:59], a[20:23], v[168:171]
buffer_load_dwordx4 v17, s[36:39], s7 offen offset:1024 lds
v_fma_f32 v234, v234, s82, v70
v_mfma_f32_16x16x32_bf16 v[172:175], v[56:59], a[24:27], v[172:175]
v_fma_f32 v235, v235, s82, v70
v_mul_f32 v232, v232, v200
v_mfma_f32_16x16x32_bf16 v[176:179], v[56:59], a[28:31], v[176:179]
v_mul_f32 v233, v233, v201
v_mul_f32 v234, v234, v202
v_mul_f32 v235, v235, v203
v_mfma_f32_16x16x32_bf16 v[180:183], v[60:63], a[228:231], v[180:183]
buffer_load_dwordx4 v18, s[36:39], s7 offen offset:2048 lds
v_mfma_f32_16x16x32_bf16 v[184:187], v[60:63], a[16:19], v[184:187]
v_exp_f32 v232, v232
v_mfma_f32_16x16x32_bf16 v[188:191], v[60:63], a[20:23], v[188:191]
buffer_load_dwordx4 v19, s[36:39], s7 offen offset:3072 lds
v_mfma_f32_16x16x32_bf16 v[192:195], v[60:63], a[24:27], v[192:195]
v_exp_f32 v233, v233
v_exp_f32 v234, v234
v_mfma_f32_16x16x32_bf16 v[196:199], v[60:63], a[28:31], v[196:199]
s_waitcnt vmcnt(15) lgkmcnt(0)
s_barrier
v_mfma_f32_16x16x32_bf16 v[160:163], v[32:35], a[232:235], v[160:163]
ds_read_b64_tr_b16 v[48:49], v22 offset:49152
v_exp_f32 v235, v235
v_mfma_f32_16x16x32_bf16 v[164:167], v[32:35], a[32:35], v[164:167]
ds_read_b64_tr_b16 v[50:51], v22 offset:50176
v_add_u32 v10, 153600, v10
v_mfma_f32_16x16x32_bf16 v[168:171], v[32:35], a[36:39], v[168:171]
ds_read_b64_tr_b16 v[52:53], v24 offset:49152
v_add_f32 v232, 1.0, v232
v_add_f32 v233, 1.0, v233
v_mfma_f32_16x16x32_bf16 v[172:175], v[32:35], a[40:43], v[172:175]
ds_read_b64_tr_b16 v[54:55], v24 offset:50176
v_add_f32 v234, 1.0, v234
v_mfma_f32_16x16x32_bf16 v[176:179], v[32:35], a[44:47], v[176:179]
ds_read_b64_tr_b16 v[56:57], v22 offset:57344
v_add_f32 v235, 1.0, v235
v_mfma_f32_16x16x32_bf16 v[180:183], v[36:39], a[232:235], v[180:183]
ds_read_b64_tr_b16 v[58:59], v22 offset:58368
v_rcp_f32 v232, v232
v_mfma_f32_16x16x32_bf16 v[184:187], v[36:39], a[32:35], v[184:187]
ds_read_b64_tr_b16 v[60:61], v24 offset:57344
v_rcp_f32 v233, v233
v_mfma_f32_16x16x32_bf16 v[188:191], v[36:39], a[36:39], v[188:191]
ds_read_b64_tr_b16 v[62:63], v24 offset:58368
v_rcp_f32 v234, v234
v_mfma_f32_16x16x32_bf16 v[192:195], v[36:39], a[40:43], v[192:195]
v_rcp_f32 v235, v235
v_mfma_f32_16x16x32_bf16 v[196:199], v[36:39], a[44:47], v[196:199]
s_add_u32 s7, s94, 1033088
s_add_u32 m0, s72, 32768
v_mfma_f32_16x16x32_bf16 v[160:163], v[40:43], a[236:239], v[160:163]
buffer_load_dwordx4 v16, s[36:39], s7 offen offset:0 lds
v_mul_f32 v232, v232, v200
v_mfma_f32_16x16x32_bf16 v[164:167], v[40:43], a[48:51], v[164:167]
v_and_b32 v8, 1, v0
v_mul_f32 v233, v233, v201
v_mfma_f32_16x16x32_bf16 v[168:171], v[40:43], a[52:55], v[168:171]
buffer_load_dwordx4 v17, s[36:39], s7 offen offset:1024 lds
v_mul_f32 v234, v234, v202
v_mfma_f32_16x16x32_bf16 v[172:175], v[40:43], a[56:59], v[172:175]
v_mul_f32 v235, v235, v203
v_cvt_pk_bf16_f32 v240, v232, v233
v_mfma_f32_16x16x32_bf16 v[176:179], v[40:43], a[60:63], v[176:179]
v_cvt_pk_bf16_f32 v241, v234, v235
v_fmac_f32 v204, v153, v248
v_fmac_f32 v205, v153, v249
v_mfma_f32_16x16x32_bf16 v[180:183], v[44:47], a[236:239], v[180:183]
buffer_load_dwordx4 v18, s[36:39], s7 offen offset:2048 lds
v_mfma_f32_16x16x32_bf16 v[184:187], v[44:47], a[48:51], v[184:187]
v_fmac_f32 v206, v153, v250
v_fmac_f32 v207, v153, v251
v_fma_f32 v204, v204, v89, v92
v_mfma_f32_16x16x32_bf16 v[188:191], v[44:47], a[52:55], v[188:191]
buffer_load_dwordx4 v19, s[36:39], s7 offen offset:3072 lds
v_mfma_f32_16x16x32_bf16 v[192:195], v[44:47], a[56:59], v[192:195]
v_fma_f32 v205, v205, v89, v93
v_fma_f32 v206, v206, v89, v94
v_mfma_f32_16x16x32_bf16 v[196:199], v[44:47], a[60:63], v[196:199]
v_fma_f32 v207, v207, v89, v95
s_waitcnt vmcnt(15) lgkmcnt(0)
s_barrier
v_mfma_f32_16x16x32_bf16 v[160:163], v[48:51], a[240:243], v[160:163]
ds_read_b64_tr_b16 v[32:33], v23 offset:0
v_mul_f32 v236, v204, v204
v_lshl_add_u32 v8, v8, 2, v10
v_mfma_f32_16x16x32_bf16 v[164:167], v[48:51], a[64:67], v[164:167]
ds_read_b64_tr_b16 v[34:35], v23 offset:1024
v_mul_f32 v237, v205, v205
v_mfma_f32_16x16x32_bf16 v[168:171], v[48:51], a[68:71], v[168:171]
ds_read_b64_tr_b16 v[36:37], v25 offset:0
v_mul_f32 v238, v206, v206
v_mul_f32 v239, v207, v207
v_mfma_f32_16x16x32_bf16 v[172:175], v[48:51], a[72:75], v[172:175]
ds_read_b64_tr_b16 v[38:39], v25 offset:1024
v_fma_f32 v236, v236, s82, v70
v_mfma_f32_16x16x32_bf16 v[176:179], v[48:51], a[76:79], v[176:179]
ds_read_b64_tr_b16 v[40:41], v23 offset:8192
v_fma_f32 v237, v237, s82, v70
v_fma_f32 v238, v238, s82, v70
v_mfma_f32_16x16x32_bf16 v[180:183], v[52:55], a[240:243], v[180:183]
ds_read_b64_tr_b16 v[42:43], v23 offset:9216
v_fma_f32 v239, v239, s82, v70
v_mfma_f32_16x16x32_bf16 v[184:187], v[52:55], a[64:67], v[184:187]
ds_read_b64_tr_b16 v[44:45], v25 offset:8192
v_mul_f32 v236, v236, v204
v_mul_f32 v237, v237, v205
v_mfma_f32_16x16x32_bf16 v[188:191], v[52:55], a[68:71], v[188:191]
ds_read_b64_tr_b16 v[46:47], v25 offset:9216
v_mul_f32 v238, v238, v206
v_mfma_f32_16x16x32_bf16 v[192:195], v[52:55], a[72:75], v[192:195]
v_mul_f32 v239, v239, v207
v_exp_f32 v236, v236
v_mfma_f32_16x16x32_bf16 v[196:199], v[52:55], a[76:79], v[196:199]
s_add_u32 s7, s94, 1792
s_add_u32 m0, s72, 49152
v_mfma_f32_16x16x32_bf16 v[160:163], v[56:59], a[244:247], v[160:163]
buffer_load_dwordx4 v16, s[36:39], s7 offen offset:0 lds
v_mfma_f32_16x16x32_bf16 v[164:167], v[56:59], a[80:83], v[164:167]
v_exp_f32 v237, v237
v_min_u32 v20, 1, v74
v_mfma_f32_16x16x32_bf16 v[168:171], v[56:59], a[84:87], v[168:171]
buffer_load_dwordx4 v17, s[36:39], s7 offen offset:1024 lds
v_mfma_f32_16x16x32_bf16 v[172:175], v[56:59], a[88:91], v[172:175]
v_exp_f32 v238, v238
v_exp_f32 v239, v239
v_mfma_f32_16x16x32_bf16 v[176:179], v[56:59], a[92:95], v[176:179]
v_add_f32 v236, 1.0, v236
v_add_f32 v237, 1.0, v237
v_mfma_f32_16x16x32_bf16 v[180:183], v[60:63], a[244:247], v[180:183]
buffer_load_dwordx4 v18, s[36:39], s7 offen offset:2048 lds
v_mfma_f32_16x16x32_bf16 v[184:187], v[60:63], a[80:83], v[184:187]
v_add_f32 v238, 1.0, v238
v_add_f32 v239, 1.0, v239
v_mfma_f32_16x16x32_bf16 v[188:191], v[60:63], a[84:87], v[188:191]
buffer_load_dwordx4 v19, s[36:39], s7 offen offset:3072 lds
v_mfma_f32_16x16x32_bf16 v[192:195], v[60:63], a[88:91], v[192:195]
v_rcp_f32 v236, v236
v_rcp_f32 v237, v237
v_mfma_f32_16x16x32_bf16 v[196:199], v[60:63], a[92:95], v[196:199]
s_waitcnt vmcnt(12) lgkmcnt(0)
s_barrier
v_mfma_f32_16x16x32_bf16 v[160:163], v[32:35], a[248:251], v[160:163]
ds_read_b64_tr_b16 v[48:49], v22 offset:0
v_rcp_f32 v238, v238
v_mfma_f32_16x16x32_bf16 v[164:167], v[32:35], a[96:99], v[164:167]
ds_read_b64_tr_b16 v[50:51], v22 offset:1024
v_min_u32 v21, 1, v75
v_mfma_f32_16x16x32_bf16 v[168:171], v[32:35], a[100:103], v[168:171]
ds_read_b64_tr_b16 v[52:53], v24 offset:0
v_rcp_f32 v239, v239
v_mfma_f32_16x16x32_bf16 v[172:175], v[32:35], a[104:107], v[172:175]
ds_read_b64_tr_b16 v[54:55], v24 offset:1024
v_mul_f32 v236, v236, v204
v_mfma_f32_16x16x32_bf16 v[176:179], v[32:35], a[108:111], v[176:179]
ds_read_b64_tr_b16 v[56:57], v22 offset:8192
v_mul_f32 v237, v237, v205
v_mul_f32 v238, v238, v206
v_mfma_f32_16x16x32_bf16 v[180:183], v[36:39], a[248:251], v[180:183]
ds_read_b64_tr_b16 v[58:59], v22 offset:9216
v_mul_f32 v239, v239, v207
v_mfma_f32_16x16x32_bf16 v[184:187], v[36:39], a[96:99], v[184:187]
ds_read_b64_tr_b16 v[60:61], v24 offset:8192
v_cvt_pk_bf16_f32 v242, v236, v237
v_cvt_pk_bf16_f32 v243, v238, v239
v_mfma_f32_16x16x32_bf16 v[188:191], v[36:39], a[100:103], v[188:191]
ds_read_b64_tr_b16 v[62:63], v24 offset:9216
v_fmac_f32 v208, v154, v248
v_mfma_f32_16x16x32_bf16 v[192:195], v[36:39], a[104:107], v[192:195]
v_fmac_f32 v209, v154, v249
v_permlane32_swap_b32 v240, v242
v_permlane32_swap_b32 v241, v243
v_mfma_f32_16x16x32_bf16 v[196:199], v[36:39], a[108:111], v[196:199]
s_add_u32 s7, s94, 173824
s_add_u32 m0, s72, 65536
v_mfma_f32_16x16x32_bf16 v[160:163], v[40:43], a[252:255], v[160:163]
buffer_load_dwordx4 v16, s[36:39], s7 offen offset:0 lds
v_mfma_f32_16x16x32_bf16 v[164:167], v[40:43], a[112:115], v[164:167]
ds_write_b128 v3, v[240:243] offset:0
v_mfma_f32_16x16x32_bf16 v[168:171], v[40:43], a[116:119], v[168:171]
buffer_load_dwordx4 v17, s[36:39], s7 offen offset:1024 lds
v_lshl_add_u32 v20, v20, 6, v8
v_mfma_f32_16x16x32_bf16 v[172:175], v[40:43], a[120:123], v[172:175]
v_fmac_f32 v210, v154, v250
v_fmac_f32 v211, v154, v251
v_mfma_f32_16x16x32_bf16 v[176:179], v[40:43], a[124:127], v[176:179]
v_fma_f32 v208, v208, v90, v92
v_fma_f32 v209, v209, v90, v93
v_fma_f32 v210, v210, v90, v94
v_mfma_f32_16x16x32_bf16 v[180:183], v[44:47], a[252:255], v[180:183]
buffer_load_dwordx4 v18, s[36:39], s7 offen offset:2048 lds
v_mfma_f32_16x16x32_bf16 v[184:187], v[44:47], a[112:115], v[184:187]
v_fma_f32 v211, v211, v90, v95
v_mul_f32 v232, v208, v208
v_mul_f32 v233, v209, v209
v_mfma_f32_16x16x32_bf16 v[188:191], v[44:47], a[116:119], v[188:191]
buffer_load_dwordx4 v19, s[36:39], s7 offen offset:3072 lds
v_mfma_f32_16x16x32_bf16 v[192:195], v[44:47], a[120:123], v[192:195]
v_mul_f32 v234, v210, v210
v_mul_f32 v235, v211, v211
v_mfma_f32_16x16x32_bf16 v[196:199], v[44:47], a[124:127], v[196:199]
v_fma_f32 v232, v232, s82, v70
s_waitcnt vmcnt(12) lgkmcnt(1)
s_barrier
v_mfma_f32_16x16x32_bf16 v[160:163], v[48:51], v[96:99], v[160:163]
ds_read_b64_tr_b16 v[32:33], v22 offset:16384
v_fma_f32 v233, v233, s82, v70
v_lshl_add_u32 v21, v21, 6, v8
v_mfma_f32_16x16x32_bf16 v[164:167], v[48:51], a[128:131], v[164:167]
ds_read_b64_tr_b16 v[34:35], v22 offset:17408
v_fma_f32 v234, v234, s82, v70
v_mfma_f32_16x16x32_bf16 v[168:171], v[48:51], a[132:135], v[168:171]
ds_read_b64_tr_b16 v[36:37], v24 offset:16384
v_fma_f32 v235, v235, s82, v70
v_mul_f32 v232, v232, v208
v_mfma_f32_16x16x32_bf16 v[172:175], v[48:51], a[136:139], v[172:175]
ds_read_b64_tr_b16 v[38:39], v24 offset:17408
v_mul_f32 v233, v233, v209
v_mfma_f32_16x16x32_bf16 v[176:179], v[48:51], a[140:143], v[176:179]
ds_read_b64_tr_b16 v[40:41], v22 offset:24576
v_mul_f32 v234, v234, v210
v_mul_f32 v235, v235, v211
v_mfma_f32_16x16x32_bf16 v[180:183], v[52:55], v[96:99], v[180:183]
ds_read_b64_tr_b16 v[42:43], v22 offset:25600
v_exp_f32 v232, v232
v_mfma_f32_16x16x32_bf16 v[184:187], v[52:55], a[128:131], v[184:187]
ds_read_b64_tr_b16 v[44:45], v24 offset:24576
v_mfma_f32_16x16x32_bf16 v[188:191], v[52:55], a[132:135], v[188:191]
ds_read_b64_tr_b16 v[46:47], v24 offset:25600
v_exp_f32 v233, v233
v_mfma_f32_16x16x32_bf16 v[192:195], v[52:55], a[136:139], v[192:195]
v_exp_f32 v234, v234
v_mfma_f32_16x16x32_bf16 v[196:199], v[52:55], a[140:143], v[196:199]
s_add_u32 s7, s94, 345856
s_add_u32 m0, s72, 0
v_exp_f32 v235, v235
v_mfma_f32_16x16x32_bf16 v[160:163], v[56:59], v[100:103], v[160:163]
buffer_load_dwordx4 v16, s[36:39], s7 offen offset:0 lds
v_mfma_f32_16x16x32_bf16 v[164:167], v[56:59], a[144:147], v[164:167]
v_add_u32 v20, 896, v20
v_add_f32 v232, 1.0, v232
v_mfma_f32_16x16x32_bf16 v[168:171], v[56:59], a[148:151], v[168:171]
buffer_load_dwordx4 v17, s[36:39], s7 offen offset:1024 lds
v_add_f32 v233, 1.0, v233
v_mfma_f32_16x16x32_bf16 v[172:175], v[56:59], a[152:155], v[172:175]
v_add_f32 v234, 1.0, v234
v_add_f32 v235, 1.0, v235
v_mfma_f32_16x16x32_bf16 v[176:179], v[56:59], a[156:159], v[176:179]
v_rcp_f32 v232, v232
v_mfma_f32_16x16x32_bf16 v[180:183], v[60:63], v[100:103], v[180:183]
buffer_load_dwordx4 v18, s[36:39], s7 offen offset:2048 lds
v_rcp_f32 v233, v233
v_mfma_f32_16x16x32_bf16 v[184:187], v[60:63], a[144:147], v[184:187]
v_rcp_f32 v234, v234
v_mfma_f32_16x16x32_bf16 v[188:191], v[60:63], a[148:151], v[188:191]
buffer_load_dwordx4 v19, s[36:39], s7 offen offset:3072 lds
v_mfma_f32_16x16x32_bf16 v[192:195], v[60:63], a[152:155], v[192:195]
v_rcp_f32 v235, v235
v_mul_f32 v232, v232, v208
v_mfma_f32_16x16x32_bf16 v[196:199], v[60:63], a[156:159], v[196:199]
s_lshl_b32 s96, s4, 3
buffer_load_dword v69, v7, s[64:67], s96 offen sc1
s_waitcnt vmcnt(13) lgkmcnt(0)
s_barrier
v_mfma_f32_16x16x32_bf16 v[160:163], v[32:35], v[104:107], v[160:163]
ds_read_b64_tr_b16 v[48:49], v22 offset:32768
v_mul_f32 v233, v233, v209
v_add_u32 v21, 904, v21
v_mfma_f32_16x16x32_bf16 v[164:167], v[32:35], a[160:163], v[164:167]
ds_read_b64_tr_b16 v[50:51], v22 offset:33792
v_mul_f32 v234, v234, v210
v_mfma_f32_16x16x32_bf16 v[168:171], v[32:35], a[164:167], v[168:171]
ds_read_b64_tr_b16 v[52:53], v24 offset:32768
v_mul_f32 v235, v235, v211
v_cvt_pk_bf16_f32 v244, v232, v233
v_mfma_f32_16x16x32_bf16 v[172:175], v[32:35], a[168:171], v[172:175]
ds_read_b64_tr_b16 v[54:55], v24 offset:33792
v_cvt_pk_bf16_f32 v245, v234, v235
v_mfma_f32_16x16x32_bf16 v[176:179], v[32:35], a[172:175], v[176:179]
ds_read_b64_tr_b16 v[56:57], v22 offset:40960
v_fmac_f32 v212, v155, v248
v_fmac_f32 v213, v155, v249
v_mfma_f32_16x16x32_bf16 v[180:183], v[36:39], v[104:107], v[180:183]
ds_read_b64_tr_b16 v[58:59], v22 offset:41984
v_fmac_f32 v214, v155, v250
v_mfma_f32_16x16x32_bf16 v[184:187], v[36:39], a[160:163], v[184:187]
ds_read_b64_tr_b16 v[60:61], v24 offset:40960
v_fmac_f32 v215, v155, v251
v_fma_f32 v212, v212, v91, v92
v_mfma_f32_16x16x32_bf16 v[188:191], v[36:39], a[164:167], v[188:191]
ds_read_b64_tr_b16 v[62:63], v24 offset:41984
v_fma_f32 v213, v213, v91, v93
v_mfma_f32_16x16x32_bf16 v[192:195], v[36:39], a[168:171], v[192:195]
v_fma_f32 v214, v214, v91, v94
v_fma_f32 v215, v215, v91, v95
v_mul_f32 v236, v212, v212
v_mfma_f32_16x16x32_bf16 v[196:199], v[36:39], a[172:175], v[196:199]
s_add_u32 s7, s94, 517888
s_add_u32 m0, s72, 16384
v_mfma_f32_16x16x32_bf16 v[160:163], v[40:43], v[108:111], v[160:163]
buffer_load_dwordx4 v16, s[36:39], s7 offen offset:0 lds
v_mul_f32 v237, v213, v213
v_mfma_f32_16x16x32_bf16 v[164:167], v[40:43], a[176:179], v[164:167]
v_mul_f32 v238, v214, v214
v_mul_f32 v239, v215, v215
v_mfma_f32_16x16x32_bf16 v[168:171], v[40:43], a[180:183], v[168:171]
buffer_load_dwordx4 v17, s[36:39], s7 offen offset:1024 lds
v_fma_f32 v236, v236, s82, v70
v_mfma_f32_16x16x32_bf16 v[172:175], v[40:43], a[184:187], v[172:175]
v_fma_f32 v237, v237, s82, v70
v_fma_f32 v238, v238, s82, v70
v_mfma_f32_16x16x32_bf16 v[176:179], v[40:43], a[188:191], v[176:179]
v_fma_f32 v239, v239, s82, v70
v_mul_f32 v236, v236, v212
v_mul_f32 v237, v237, v213
v_mfma_f32_16x16x32_bf16 v[180:183], v[44:47], v[108:111], v[180:183]
buffer_load_dwordx4 v18, s[36:39], s7 offen offset:2048 lds
v_mfma_f32_16x16x32_bf16 v[184:187], v[44:47], a[176:179], v[184:187]
v_mul_f32 v238, v238, v214
v_mul_f32 v239, v239, v215
v_mfma_f32_16x16x32_bf16 v[188:191], v[44:47], a[180:183], v[188:191]
buffer_load_dwordx4 v19, s[36:39], s7 offen offset:3072 lds
v_mfma_f32_16x16x32_bf16 v[192:195], v[44:47], a[184:187], v[192:195]
v_exp_f32 v236, v236
v_exp_f32 v237, v237
v_mfma_f32_16x16x32_bf16 v[196:199], v[44:47], a[188:191], v[196:199]
s_waitcnt vmcnt(13) lgkmcnt(0)
s_barrier
v_mfma_f32_16x16x32_bf16 v[160:163], v[48:51], v[112:115], v[160:163]
ds_read_b64_tr_b16 v[32:33], v22 offset:49152
v_exp_f32 v238, v238
v_mfma_f32_16x16x32_bf16 v[164:167], v[48:51], a[192:195], v[164:167]
ds_read_b64_tr_b16 v[34:35], v22 offset:50176
v_mfma_f32_16x16x32_bf16 v[168:171], v[48:51], a[196:199], v[168:171]
ds_read_b64_tr_b16 v[36:37], v24 offset:49152
v_exp_f32 v239, v239
v_mfma_f32_16x16x32_bf16 v[172:175], v[48:51], a[200:203], v[172:175]
ds_read_b64_tr_b16 v[38:39], v24 offset:50176
v_add_f32 v236, 1.0, v236
v_mfma_f32_16x16x32_bf16 v[176:179], v[48:51], a[204:207], v[176:179]
ds_read_b64_tr_b16 v[40:41], v22 offset:57344
v_add_f32 v237, 1.0, v237
v_add_f32 v238, 1.0, v238
v_mfma_f32_16x16x32_bf16 v[180:183], v[52:55], v[112:115], v[180:183]
ds_read_b64_tr_b16 v[42:43], v22 offset:58368
v_add_f32 v239, 1.0, v239
v_mfma_f32_16x16x32_bf16 v[184:187], v[52:55], a[192:195], v[184:187]
ds_read_b64_tr_b16 v[44:45], v24 offset:57344
v_rcp_f32 v236, v236
v_mfma_f32_16x16x32_bf16 v[188:191], v[52:55], a[196:199], v[188:191]
ds_read_b64_tr_b16 v[46:47], v24 offset:58368
v_mfma_f32_16x16x32_bf16 v[192:195], v[52:55], a[200:203], v[192:195]
v_rcp_f32 v237, v237
v_rcp_f32 v238, v238
v_mfma_f32_16x16x32_bf16 v[196:199], v[52:55], a[204:207], v[196:199]
s_add_u32 s7, s94, 689920
s_add_u32 m0, s72, 32768
v_mfma_f32_16x16x32_bf16 v[160:163], v[56:59], v[116:119], v[160:163]
buffer_load_dwordx4 v16, s[36:39], s7 offen offset:0 lds
v_mfma_f32_16x16x32_bf16 v[164:167], v[56:59], a[208:211], v[164:167]
v_rcp_f32 v239, v239
v_mfma_f32_16x16x32_bf16 v[168:171], v[56:59], a[212:215], v[168:171]
buffer_load_dwordx4 v17, s[36:39], s7 offen offset:1024 lds
v_mul_f32 v236, v236, v212
v_mfma_f32_16x16x32_bf16 v[172:175], v[56:59], a[216:219], v[172:175]
v_mul_f32 v237, v237, v213
v_mul_f32 v238, v238, v214
v_mfma_f32_16x16x32_bf16 v[176:179], v[56:59], a[220:223], v[176:179]
v_mul_f32 v239, v239, v215
v_cvt_pk_bf16_f32 v246, v236, v237
v_mfma_f32_16x16x32_bf16 v[180:183], v[60:63], v[116:119], v[180:183]
buffer_load_dwordx4 v18, s[36:39], s7 offen offset:2048 lds
v_cvt_pk_bf16_f32 v247, v238, v239
v_mfma_f32_16x16x32_bf16 v[184:187], v[60:63], a[208:211], v[184:187]
v_permlane32_swap_b32 v244, v246
v_permlane32_swap_b32 v245, v247
v_mfma_f32_16x16x32_bf16 v[188:191], v[60:63], a[212:215], v[188:191]
buffer_load_dwordx4 v19, s[36:39], s7 offen offset:3072 lds
v_mfma_f32_16x16x32_bf16 v[192:195], v[60:63], a[216:219], v[192:195]
ds_write_b128 v3, v[244:247] offset:1024
v_mfma_f32_16x16x32_bf16 v[196:199], v[60:63], a[220:223], v[196:199]
s_waitcnt vmcnt(13) lgkmcnt(1)
s_barrier
v_mfma_f32_16x16x32_bf16 v[120:123], a[224:227], v[32:35], 0
ds_read2_b32 v[200:201], v30 offset0:16 offset1:32
ds_read2_b32 v[202:203], v30 offset0:48 offset1:64
ds_read_b32 v204, v30
ds_read_b64_tr_b16 v[48:49], v23 offset:0
v_mfma_f32_16x16x32_bf16 v[124:127], a[0:3], v[32:35], 0
ds_read_b64_tr_b16 v[50:51], v23 offset:1024
v_mfma_f32_16x16x32_bf16 v[128:131], a[4:7], v[32:35], 0
ds_read_b64_tr_b16 v[52:53], v25 offset:0
v_mfma_f32_16x16x32_bf16 v[132:135], a[8:11], v[32:35], 0
ds_read_b64_tr_b16 v[54:55], v25 offset:1024
v_mfma_f32_16x16x32_bf16 v[136:139], a[12:15], v[32:35], 0
ds_read_b64_tr_b16 v[56:57], v23 offset:8192
v_mfma_f32_16x16x32_bf16 v[140:143], a[224:227], v[36:39], 0
ds_read_b64_tr_b16 v[58:59], v23 offset:9216
s_waitcnt lgkmcnt(8)
v_fmac_f32_dpp v164, v160, v200 row_newbcast:0 row_mask:0xf bank_mask:0xf
v_fmac_f32_dpp v165, v161, v200 row_newbcast:0 row_mask:0xf bank_mask:0xf
v_mfma_f32_16x16x32_bf16 v[144:147], a[0:3], v[36:39], 0
ds_read_b64_tr_b16 v[60:61], v25 offset:8192
v_fmac_f32_dpp v166, v162, v200 row_newbcast:0 row_mask:0xf bank_mask:0xf
v_mfma_f32_16x16x32_bf16 v[148:151], a[4:7], v[36:39], 0
ds_read_b64_tr_b16 v[62:63], v25 offset:9216
v_fmac_f32_dpp v167, v163, v200 row_newbcast:0 row_mask:0xf bank_mask:0xf
v_fmac_f32_dpp v184, v180, v200 row_newbcast:0 row_mask:0xf bank_mask:0xf
v_mfma_f32_16x16x32_bf16 v[152:155], a[8:11], v[36:39], 0
v_fmac_f32_dpp v185, v181, v200 row_newbcast:0 row_mask:0xf bank_mask:0xf
v_fmac_f32_dpp v186, v182, v200 row_newbcast:0 row_mask:0xf bank_mask:0xf
v_fmac_f32_dpp v187, v183, v200 row_newbcast:0 row_mask:0xf bank_mask:0xf
v_mfma_f32_16x16x32_bf16 v[156:159], a[12:15], v[36:39], 0
s_add_u32 s7, s94, 861952
s_add_u32 m0, s72, 49152
v_cvt_pk_bf16_f32 v236, v164, v165
v_mfma_f32_16x16x32_bf16 v[120:123], a[228:231], v[40:43], v[120:123]
buffer_load_dwordx4 v16, s[36:39], s7 offen offset:0 lds
v_mfma_f32_16x16x32_bf16 v[124:127], a[16:19], v[40:43], v[124:127]
v_cvt_pk_bf16_f32 v237, v166, v167
v_cvt_pk_bf16_f32 v238, v184, v185
v_cvt_pk_bf16_f32 v239, v186, v187
v_mfma_f32_16x16x32_bf16 v[128:131], a[20:23], v[40:43], v[128:131]
buffer_load_dwordx4 v17, s[36:39], s7 offen offset:1024 lds
v_and_b32 v238, v71, v238
v_mfma_f32_16x16x32_bf16 v[132:135], a[24:27], v[40:43], v[132:135]
v_and_b32 v239, v71, v239
v_fmac_f32_dpp v168, v160, v201 row_newbcast:0 row_mask:0xf bank_mask:0xf
v_fmac_f32_dpp v169, v161, v201 row_newbcast:0 row_mask:0xf bank_mask:0xf
v_mfma_f32_16x16x32_bf16 v[136:139], a[28:31], v[40:43], v[136:139]
v_fmac_f32_dpp v170, v162, v201 row_newbcast:0 row_mask:0xf bank_mask:0xf
v_fmac_f32_dpp v171, v163, v201 row_newbcast:0 row_mask:0xf bank_mask:0xf
v_mfma_f32_16x16x32_bf16 v[140:143], a[228:231], v[44:47], v[140:143]
buffer_load_dwordx4 v18, s[36:39], s7 offen offset:2048 lds
v_fmac_f32_dpp v188, v180, v201 row_newbcast:0 row_mask:0xf bank_mask:0xf
v_mfma_f32_16x16x32_bf16 v[144:147], a[16:19], v[44:47], v[144:147]
v_fmac_f32_dpp v189, v181, v201 row_newbcast:0 row_mask:0xf bank_mask:0xf
v_fmac_f32_dpp v190, v182, v201 row_newbcast:0 row_mask:0xf bank_mask:0xf
v_fmac_f32_dpp v191, v183, v201 row_newbcast:0 row_mask:0xf bank_mask:0xf
v_mfma_f32_16x16x32_bf16 v[148:151], a[20:23], v[44:47], v[148:151]
buffer_load_dwordx4 v19, s[36:39], s7 offen offset:3072 lds
v_cvt_pk_bf16_f32 v240, v168, v169
v_mfma_f32_16x16x32_bf16 v[152:155], a[24:27], v[44:47], v[152:155]
v_cvt_pk_bf16_f32 v241, v170, v171
v_cvt_pk_bf16_f32 v242, v188, v189
v_mfma_f32_16x16x32_bf16 v[156:159], a[28:31], v[44:47], v[156:159]
v_cvt_pk_bf16_f32 v243, v190, v191
s_waitcnt vmcnt(13) lgkmcnt(0)
s_barrier
v_mfma_f32_16x16x32_bf16 v[120:123], a[232:235], v[48:51], v[120:123]
ds_read2_b32 v[208:209], v30 offset0:144 offset1:160
ds_read2_b32 v[210:211], v30 offset0:176 offset1:192
ds_read_b64_tr_b16 v[32:33], v22 offset:0
v_and_b32 v242, v71, v242
v_mfma_f32_16x16x32_bf16 v[124:127], a[32:35], v[48:51], v[124:127]
ds_read_b64_tr_b16 v[34:35], v22 offset:1024
v_and_b32 v243, v71, v243
v_fmac_f32_dpp v172, v160, v202 row_newbcast:0 row_mask:0xf bank_mask:0xf
v_fmac_f32_dpp v173, v161, v202 row_newbcast:0 row_mask:0xf bank_mask:0xf
v_mfma_f32_16x16x32_bf16 v[128:131], a[36:39], v[48:51], v[128:131]
ds_read_b64_tr_b16 v[36:37], v24 offset:0
v_fmac_f32_dpp v174, v162, v202 row_newbcast:0 row_mask:0xf bank_mask:0xf
v_fmac_f32_dpp v175, v163, v202 row_newbcast:0 row_mask:0xf bank_mask:0xf
v_mfma_f32_16x16x32_bf16 v[132:135], a[40:43], v[48:51], v[132:135]
ds_read_b64_tr_b16 v[38:39], v24 offset:1024
v_fmac_f32_dpp v192, v180, v202 row_newbcast:0 row_mask:0xf bank_mask:0xf
v_fmac_f32_dpp v193, v181, v202 row_newbcast:0 row_mask:0xf bank_mask:0xf
v_mfma_f32_16x16x32_bf16 v[136:139], a[44:47], v[48:51], v[136:139]
ds_read_b64_tr_b16 v[40:41], v22 offset:8192
v_fmac_f32_dpp v194, v182, v202 row_newbcast:0 row_mask:0xf bank_mask:0xf
v_fmac_f32_dpp v195, v183, v202 row_newbcast:0 row_mask:0xf bank_mask:0xf
v_cvt_pk_bf16_f32 v244, v172, v173
v_mfma_f32_16x16x32_bf16 v[140:143], a[232:235], v[52:55], v[140:143]
ds_read_b64_tr_b16 v[42:43], v22 offset:9216
v_cvt_pk_bf16_f32 v245, v174, v175
v_cvt_pk_bf16_f32 v246, v192, v193
v_mfma_f32_16x16x32_bf16 v[144:147], a[32:35], v[52:55], v[144:147]
ds_read_b64_tr_b16 v[44:45], v24 offset:8192
v_cvt_pk_bf16_f32 v247, v194, v195
v_and_b32 v246, v71, v246
v_mfma_f32_16x16x32_bf16 v[148:151], a[36:39], v[52:55], v[148:151]
ds_read_b64_tr_b16 v[46:47], v24 offset:9216
v_and_b32 v247, v71, v247
v_fmac_f32_dpp v176, v160, v203 row_newbcast:0 row_mask:0xf bank_mask:0xf
v_fmac_f32_dpp v177, v161, v203 row_newbcast:0 row_mask:0xf bank_mask:0xf
v_mfma_f32_16x16x32_bf16 v[152:155], a[40:43], v[52:55], v[152:155]
v_fmac_f32_dpp v178, v162, v203 row_newbcast:0 row_mask:0xf bank_mask:0xf
v_fmac_f32_dpp v179, v163, v203 row_newbcast:0 row_mask:0xf bank_mask:0xf
v_fmac_f32_dpp v196, v180, v203 row_newbcast:0 row_mask:0xf bank_mask:0xf
v_mfma_f32_16x16x32_bf16 v[156:159], a[44:47], v[52:55], v[156:159]
v_fmac_f32_dpp v197, v181, v203 row_newbcast:0 row_mask:0xf bank_mask:0xf
v_fmac_f32_dpp v198, v182, v203 row_newbcast:0 row_mask:0xf bank_mask:0xf
v_fmac_f32_dpp v199, v183, v203 row_newbcast:0 row_mask:0xf bank_mask:0xf
v_cvt_pk_bf16_f32 v248, v176, v177
v_mfma_f32_16x16x32_bf16 v[120:123], a[236:239], v[56:59], v[120:123]
v_cvt_pk_bf16_f32 v249, v178, v179
v_cvt_pk_bf16_f32 v250, v196, v197
v_cvt_pk_bf16_f32 v251, v198, v199
v_mfma_f32_16x16x32_bf16 v[124:127], a[48:51], v[56:59], v[124:127]
v_and_b32 v250, v71, v250
v_and_b32 v251, v71, v251
v_fmac_f32_dpp v160, v160, v204 row_newbcast:0 row_mask:0xf bank_mask:0xf
v_mfma_f32_16x16x32_bf16 v[128:131], a[52:55], v[56:59], v[128:131]
v_fmac_f32_dpp v161, v161, v204 row_newbcast:0 row_mask:0xf bank_mask:0xf
v_fmac_f32_dpp v162, v162, v204 row_newbcast:0 row_mask:0xf bank_mask:0xf
v_fmac_f32_dpp v163, v163, v204 row_newbcast:0 row_mask:0xf bank_mask:0xf
v_fmac_f32_dpp v180, v180, v204 row_newbcast:0 row_mask:0xf bank_mask:0xf
v_mfma_f32_16x16x32_bf16 v[132:135], a[56:59], v[56:59], v[132:135]
s_add_u32 s7, s94, 1033984
s_add_u32 m0, s72, 65536
v_fmac_f32_dpp v181, v181, v204 row_newbcast:0 row_mask:0xf bank_mask:0xf
v_mfma_f32_16x16x32_bf16 v[136:139], a[60:63], v[56:59], v[136:139]
buffer_load_dwordx4 v16, s[36:39], s7 offen offset:0 lds
v_fmac_f32_dpp v182, v182, v204 row_newbcast:0 row_mask:0xf bank_mask:0xf
v_mfma_f32_16x16x32_bf16 v[140:143], a[236:239], v[60:63], v[140:143]
v_fmac_f32_dpp v183, v183, v204 row_newbcast:0 row_mask:0xf bank_mask:0xf
v_cvt_pk_bf16_f32 v232, v160, v161
v_cvt_pk_bf16_f32 v233, v162, v163
v_cvt_pk_bf16_f32 v234, v180, v181
v_mfma_f32_16x16x32_bf16 v[144:147], a[48:51], v[60:63], v[144:147]
v_cvt_pk_bf16_f32 v235, v182, v183
v_and_b32 v234, v71, v234
v_and_b32 v235, v71, v235
v_mfma_f32_16x16x32_bf16 v[148:151], a[52:55], v[60:63], v[148:151]
buffer_load_dwordx4 v17, s[36:39], s7 offen offset:1024 lds
v_mfma_f32_16x16x32_bf16 v[152:155], a[56:59], v[60:63], v[152:155]
v_mfma_f32_16x16x32_bf16 v[156:159], a[60:63], v[60:63], v[156:159]
v_mfma_f32_16x16x32_bf16 v[160:163], v[232:235], v[216:219], v[84:87]
v_mfma_f32_16x16x32_bf16 v[164:167], v[236:239], v[216:219], v[76:79]
buffer_load_dwordx4 v18, s[36:39], s7 offen offset:2048 lds
v_mfma_f32_16x16x32_bf16 v[168:171], v[236:239], v[220:223], v[80:83]
v_mfma_f32_16x16x32_bf16 v[172:175], v[240:243], v[220:223], v[76:79]
v_mfma_f32_16x16x32_bf16 v[176:179], v[240:243], v[224:227], v[80:83]
buffer_load_dwordx4 v19, s[36:39], s7 offen offset:3072 lds
v_mfma_f32_16x16x32_bf16 v[180:183], v[244:247], v[224:227], v[76:79]
v_mfma_f32_16x16x32_bf16 v[184:187], v[244:247], v[228:231], v[80:83]
v_mfma_f32_16x16x32_bf16 v[188:191], v[248:251], v[228:231], v[76:79]
s_waitcnt vmcnt(12) lgkmcnt(0)
s_barrier
v_mfma_f32_16x16x32_bf16 v[120:123], a[240:243], v[32:35], v[120:123]
ds_read2_b32 v[192:193], v20 offset0:0 offset1:16
ds_read2_b32 v[194:195], v20 offset0:32 offset1:48
ds_read2_b32 v[196:197], v21 offset0:0 offset1:16
ds_read2_b32 v[198:199], v21 offset0:32 offset1:48
ds_read_b64_tr_b16 v[48:49], v22 offset:16384
v_mfma_f32_16x16x32_bf16 v[124:127], a[64:67], v[32:35], v[124:127]
ds_read_b64_tr_b16 v[50:51], v22 offset:17408
v_mfma_f32_16x16x32_bf16 v[128:131], a[68:71], v[32:35], v[128:131]
ds_read_b64_tr_b16 v[52:53], v24 offset:16384
v_max3_f32 v216, v160, v161, v164
v_max3_f32 v220, v168, v169, v172
v_mfma_f32_16x16x32_bf16 v[132:135], a[72:75], v[32:35], v[132:135]
ds_read_b64_tr_b16 v[54:55], v24 offset:17408
v_max3_f32 v224, v176, v177, v180
v_mfma_f32_16x16x32_bf16 v[136:139], a[76:79], v[32:35], v[136:139]
ds_read_b64_tr_b16 v[56:57], v22 offset:24576
v_max3_f32 v228, v184, v185, v188
v_max3_f32 v217, v162, v163, v166
v_mfma_f32_16x16x32_bf16 v[140:143], a[240:243], v[36:39], v[140:143]
ds_read_b64_tr_b16 v[58:59], v22 offset:25600
v_max3_f32 v221, v170, v171, v174
v_max3_f32 v225, v178, v179, v182
v_mfma_f32_16x16x32_bf16 v[144:147], a[64:67], v[36:39], v[144:147]
ds_read_b64_tr_b16 v[60:61], v24 offset:24576
v_max3_f32 v229, v186, v187, v190
v_mfma_f32_16x16x32_bf16 v[148:151], a[68:71], v[36:39], v[148:151]
ds_read_b64_tr_b16 v[62:63], v24 offset:25600
v_max_f32 v216, v216, v165
v_max_f32 v220, v220, v173
v_mfma_f32_16x16x32_bf16 v[152:155], a[72:75], v[36:39], v[152:155]
v_max_f32 v224, v224, v181
v_max_f32 v228, v228, v189
v_max_f32 v217, v217, v167
v_mfma_f32_16x16x32_bf16 v[156:159], a[76:79], v[36:39], v[156:159]
s_add_u32 s7, s74, 0
s_add_u32 m0, s72, 0
v_mfma_f32_16x16x32_bf16 v[120:123], a[244:247], v[40:43], v[120:123]
buffer_load_dwordx4 v12, s[52:55], s7 offen offset:0 lds
v_max_f32 v221, v221, v175
v_mfma_f32_16x16x32_bf16 v[124:127], a[80:83], v[40:43], v[124:127]
v_max_f32 v225, v225, v183
v_max_f32 v229, v229, v191
s_waitcnt lgkmcnt(11)
v_mul_f32 v216, v216, v192
v_mfma_f32_16x16x32_bf16 v[128:131], a[84:87], v[40:43], v[128:131]
buffer_load_dwordx4 v13, s[52:55], s7 offen offset:1024 lds
v_mfma_f32_16x16x32_bf16 v[132:135], a[88:91], v[40:43], v[132:135]
v_mul_f32 v220, v220, v193
s_waitcnt lgkmcnt(10)
v_mul_f32 v224, v224, v194
v_mul_f32 v228, v228, v195
v_mfma_f32_16x16x32_bf16 v[136:139], a[92:95], v[40:43], v[136:139]
s_waitcnt lgkmcnt(9)
v_mul_f32 v217, v217, v196
v_mul_f32 v221, v221, v197
s_waitcnt lgkmcnt(8)
v_mul_f32 v225, v225, v198
v_mfma_f32_16x16x32_bf16 v[140:143], a[244:247], v[44:47], v[140:143]
buffer_load_dwordx4 v14, s[52:55], s7 offen offset:2048 lds
v_mfma_f32_16x16x32_bf16 v[144:147], a[80:83], v[44:47], v[144:147]
v_mul_f32 v229, v229, v199
v_max_f32 v218, v216, v217
v_max_f32 v222, v220, v221
v_mfma_f32_16x16x32_bf16 v[148:151], a[84:87], v[44:47], v[148:151]
buffer_load_dwordx4 v15, s[52:55], s7 offen offset:3072 lds
v_max_f32 v226, v224, v225
v_mfma_f32_16x16x32_bf16 v[152:155], a[88:91], v[44:47], v[152:155]
v_max_f32 v230, v228, v229
v_mov_b32 v219, v218
v_mfma_f32_16x16x32_bf16 v[156:159], a[92:95], v[44:47], v[156:159]
v_mov_b32 v223, v222
s_waitcnt vmcnt(12) lgkmcnt(0)
s_barrier
v_mfma_f32_16x16x32_bf16 v[120:123], a[248:251], v[48:51], v[120:123]
ds_read_b64_tr_b16 v[32:33], v22 offset:32768
ds_read_b128 a[0:3], v64 offset:16384
v_mov_b32 v227, v226
v_mfma_f32_16x16x32_bf16 v[124:127], a[96:99], v[48:51], v[124:127]
ds_read_b64_tr_b16 v[34:35], v22 offset:33792
v_mov_b32 v231, v230
v_permlane32_swap_b32 v218, v219
v_mfma_f32_16x16x32_bf16 v[128:131], a[100:103], v[48:51], v[128:131]
ds_read_b64_tr_b16 v[36:37], v24 offset:32768
v_permlane32_swap_b32 v222, v223
v_mfma_f32_16x16x32_bf16 v[132:135], a[104:107], v[48:51], v[132:135]
ds_read_b64_tr_b16 v[38:39], v24 offset:33792
v_permlane32_swap_b32 v226, v227
v_permlane32_swap_b32 v230, v231
v_mfma_f32_16x16x32_bf16 v[136:139], a[108:111], v[48:51], v[136:139]
ds_read_b64_tr_b16 v[40:41], v22 offset:40960
v_max_f32 v218, v218, v219
v_max_f32 v222, v222, v223
v_mfma_f32_16x16x32_bf16 v[140:143], a[248:251], v[52:55], v[140:143]
ds_read_b64_tr_b16 v[42:43], v22 offset:41984
v_max_f32 v226, v226, v227
v_max_f32 v230, v230, v231
v_mfma_f32_16x16x32_bf16 v[144:147], a[96:99], v[52:55], v[144:147]
ds_read_b64_tr_b16 v[44:45], v24 offset:40960
v_mov_b32 v219, v218
v_mfma_f32_16x16x32_bf16 v[148:151], a[100:103], v[52:55], v[148:151]
ds_read_b64_tr_b16 v[46:47], v24 offset:41984
ds_read_b128 a[4:7], v65 offset:16384
v_mov_b32 v223, v222
v_mfma_f32_16x16x32_bf16 v[152:155], a[104:107], v[52:55], v[152:155]
v_mov_b32 v227, v226
v_mov_b32 v231, v230
v_permlane16_swap_b32 v218, v219
v_mfma_f32_16x16x32_bf16 v[156:159], a[108:111], v[52:55], v[156:159]
s_add_u32 s7, s75, 0
s_add_u32 m0, s72, 16384
v_permlane16_swap_b32 v222, v223
v_mfma_f32_16x16x32_bf16 v[120:123], a[252:255], v[56:59], v[120:123]
buffer_load_dwordx4 v12, s[52:55], s7 offen offset:0 lds
v_mfma_f32_16x16x32_bf16 v[124:127], a[112:115], v[56:59], v[124:127]
v_permlane16_swap_b32 v226, v227
v_permlane16_swap_b32 v230, v231
v_max_f32 v218, v218, v219
v_mfma_f32_16x16x32_bf16 v[128:131], a[116:119], v[56:59], v[128:131]
buffer_load_dwordx4 v13, s[52:55], s7 offen offset:1024 lds
v_max_f32 v222, v222, v223
v_mfma_f32_16x16x32_bf16 v[132:135], a[120:123], v[56:59], v[132:135]
v_max_f32 v226, v226, v227
v_max_f32 v230, v230, v231
ds_read_b128 a[8:11], v64 offset:18432
v_mfma_f32_16x16x32_bf16 v[136:139], a[124:127], v[56:59], v[136:139]
v_sub_f32 v216, v216, v218
v_sub_f32 v220, v220, v222
v_mfma_f32_16x16x32_bf16 v[140:143], a[252:255], v[60:63], v[140:143]
buffer_load_dwordx4 v14, s[52:55], s7 offen offset:2048 lds
v_sub_f32 v224, v224, v226
v_mfma_f32_16x16x32_bf16 v[144:147], a[112:115], v[60:63], v[144:147]
v_sub_f32 v228, v228, v230
v_sub_f32 v217, v217, v218
v_sub_f32 v221, v221, v222
v_mfma_f32_16x16x32_bf16 v[148:151], a[116:119], v[60:63], v[148:151]
buffer_load_dwordx4 v15, s[52:55], s7 offen offset:3072 lds
v_mfma_f32_16x16x32_bf16 v[152:155], a[120:123], v[60:63], v[152:155]
v_sub_f32 v225, v225, v226
v_sub_f32 v229, v229, v230
v_mul_f32 v216, v208, v216
v_mfma_f32_16x16x32_bf16 v[156:159], a[124:127], v[60:63], v[156:159]
v_mul_f32 v220, v209, v220
s_waitcnt vmcnt(12) lgkmcnt(2)
s_barrier
v_mfma_f32_16x16x32_bf16 v[120:123], v[96:99], v[32:35], v[120:123]
ds_read_b64_tr_b16 v[48:49], v22 offset:49152
ds_read_b128 a[12:15], v65 offset:18432
v_mul_f32 v224, v210, v224
v_mfma_f32_16x16x32_bf16 v[124:127], a[128:131], v[32:35], v[124:127]
ds_read_b64_tr_b16 v[50:51], v22 offset:50176
v_mul_f32 v228, v211, v228
v_mfma_f32_16x16x32_bf16 v[128:131], a[132:135], v[32:35], v[128:131]
ds_read_b64_tr_b16 v[52:53], v24 offset:49152
v_mul_f32 v217, v208, v217
v_mul_f32 v221, v209, v221
v_mfma_f32_16x16x32_bf16 v[132:135], a[136:139], v[32:35], v[132:135]
ds_read_b64_tr_b16 v[54:55], v24 offset:50176
v_mul_f32 v225, v210, v225
v_mul_f32 v229, v211, v229
v_mfma_f32_16x16x32_bf16 v[136:139], a[140:143], v[32:35], v[136:139]
ds_read_b64_tr_b16 v[56:57], v22 offset:57344
v_exp_f32 v216, v216
v_mfma_f32_16x16x32_bf16 v[140:143], v[96:99], v[36:39], v[140:143]
ds_read_b64_tr_b16 v[58:59], v22 offset:58368
v_exp_f32 v220, v220
v_mfma_f32_16x16x32_bf16 v[144:147], a[128:131], v[36:39], v[144:147]
ds_read_b64_tr_b16 v[60:61], v24 offset:57344
v_mfma_f32_16x16x32_bf16 v[148:151], a[132:135], v[36:39], v[148:151]
ds_read_b64_tr_b16 v[62:63], v24 offset:58368
v_exp_f32 v224, v224
v_mfma_f32_16x16x32_bf16 v[152:155], a[136:139], v[36:39], v[152:155]
v_exp_f32 v228, v228
v_exp_f32 v217, v217
v_mfma_f32_16x16x32_bf16 v[156:159], a[140:143], v[36:39], v[156:159]
s_add_u32 s7, s76, 0
s_add_u32 m0, s72, 32768
v_mfma_f32_16x16x32_bf16 v[120:123], v[100:103], v[40:43], v[120:123]
buffer_load_dwordx4 v12, s[52:55], s7 offen offset:0 lds
ds_read_b128 a[16:19], v64 offset:20480
v_mfma_f32_16x16x32_bf16 v[124:127], a[144:147], v[40:43], v[124:127]
v_exp_f32 v221, v221
v_mfma_f32_16x16x32_bf16 v[128:131], a[148:151], v[40:43], v[128:131]
buffer_load_dwordx4 v13, s[52:55], s7 offen offset:1024 lds
v_exp_f32 v225, v225
v_mfma_f32_16x16x32_bf16 v[132:135], a[152:155], v[40:43], v[132:135]
v_exp_f32 v229, v229
v_mfma_f32_16x16x32_bf16 v[136:139], a[156:159], v[40:43], v[136:139]
v_add_f32 v218, v216, v217
v_add_f32 v222, v220, v221
v_add_f32 v226, v224, v225
v_mfma_f32_16x16x32_bf16 v[140:143], v[100:103], v[44:47], v[140:143]
buffer_load_dwordx4 v14, s[52:55], s7 offen offset:2048 lds
v_mfma_f32_16x16x32_bf16 v[144:147], a[144:147], v[44:47], v[144:147]
v_add_f32 v230, v228, v229
v_mul_f32 v216, v216, v192
v_mul_f32 v220, v220, v193
v_mfma_f32_16x16x32_bf16 v[148:151], a[148:151], v[44:47], v[148:151]
buffer_load_dwordx4 v15, s[52:55], s7 offen offset:3072 lds
v_mul_f32 v224, v224, v194
v_mfma_f32_16x16x32_bf16 v[152:155], a[152:155], v[44:47], v[152:155]
v_mul_f32 v228, v228, v195
v_mul_f32 v217, v217, v196
v_mfma_f32_16x16x32_bf16 v[156:159], a[156:159], v[44:47], v[156:159]
v_mul_f32 v221, v221, v197
s_waitcnt vmcnt(12) lgkmcnt(1)
s_barrier
v_mfma_f32_16x16x32_bf16 v[120:123], v[104:107], v[48:51], v[120:123]
ds_read_b64_tr_b16 v[32:33], v23 offset:0
ds_read_b128 a[20:23], v65 offset:20480
v_mul_f32 v225, v225, v198
v_mfma_f32_16x16x32_bf16 v[124:127], a[160:163], v[48:51], v[124:127]
ds_read_b64_tr_b16 v[34:35], v23 offset:1024
v_mul_f32 v229, v229, v199
v_mov_b32 v219, v218
v_mfma_f32_16x16x32_bf16 v[128:131], a[164:167], v[48:51], v[128:131]
ds_read_b64_tr_b16 v[36:37], v25 offset:0
v_mov_b32 v223, v222
v_mfma_f32_16x16x32_bf16 v[132:135], a[168:171], v[48:51], v[132:135]
ds_read_b64_tr_b16 v[38:39], v25 offset:1024
v_mov_b32 v227, v226
v_mov_b32 v231, v230
v_mfma_f32_16x16x32_bf16 v[136:139], a[172:175], v[48:51], v[136:139]
ds_read_b64_tr_b16 v[40:41], v23 offset:8192
v_permlane32_swap_b32 v218, v219
v_permlane32_swap_b32 v222, v223
v_mfma_f32_16x16x32_bf16 v[140:143], v[104:107], v[52:55], v[140:143]
ds_read_b64_tr_b16 v[42:43], v23 offset:9216
v_permlane32_swap_b32 v226, v227
v_permlane32_swap_b32 v230, v231
v_mfma_f32_16x16x32_bf16 v[144:147], a[160:163], v[52:55], v[144:147]
ds_read_b64_tr_b16 v[44:45], v25 offset:8192
v_add_f32 v218, v218, v219
v_mfma_f32_16x16x32_bf16 v[148:151], a[164:167], v[52:55], v[148:151]
ds_read_b64_tr_b16 v[46:47], v25 offset:9216
ds_read_b128 a[24:27], v64 offset:22528
v_add_f32 v222, v222, v223
v_mfma_f32_16x16x32_bf16 v[152:155], a[168:171], v[52:55], v[152:155]
v_add_f32 v226, v226, v227
v_add_f32 v230, v230, v231
v_mov_b32 v219, v218
v_mfma_f32_16x16x32_bf16 v[156:159], a[172:175], v[52:55], v[156:159]
s_add_u32 s7, s90, 0
s_add_u32 m0, s72, 49152
v_mov_b32 v223, v222
v_mfma_f32_16x16x32_bf16 v[120:123], v[108:111], v[56:59], v[120:123]
buffer_load_dwordx4 v12, s[40:43], s7 offen offset:0 lds
v_mfma_f32_16x16x32_bf16 v[124:127], a[176:179], v[56:59], v[124:127]
v_mov_b32 v227, v226
v_mov_b32 v231, v230
v_permlane16_swap_b32 v218, v219
v_mfma_f32_16x16x32_bf16 v[128:131], a[180:183], v[56:59], v[128:131]
buffer_load_dwordx4 v13, s[40:43], s7 offen offset:1024 lds
v_permlane16_swap_b32 v222, v223
v_mfma_f32_16x16x32_bf16 v[132:135], a[184:187], v[56:59], v[132:135]
v_permlane16_swap_b32 v226, v227
v_permlane16_swap_b32 v230, v231
ds_read_b128 a[28:31], v65 offset:22528
v_mfma_f32_16x16x32_bf16 v[136:139], a[188:191], v[56:59], v[136:139]
v_add_f32 v218, v218, v219
v_add_f32 v222, v222, v223
v_mfma_f32_16x16x32_bf16 v[140:143], v[108:111], v[60:63], v[140:143]
buffer_load_dwordx4 v14, s[40:43], s7 offen offset:2048 lds
v_add_f32 v226, v226, v227
v_mfma_f32_16x16x32_bf16 v[144:147], a[176:179], v[60:63], v[144:147]
v_add_f32 v230, v230, v231
v_rcp_f32 v218, v218
v_mfma_f32_16x16x32_bf16 v[148:151], a[180:183], v[60:63], v[148:151]
buffer_load_dwordx4 v15, s[40:43], s7 offen offset:3072 lds
v_mfma_f32_16x16x32_bf16 v[152:155], a[184:187], v[60:63], v[152:155]
v_rcp_f32 v222, v222
v_rcp_f32 v226, v226
v_mfma_f32_16x16x32_bf16 v[156:159], a[188:191], v[60:63], v[156:159]
s_waitcnt vmcnt(12) lgkmcnt(2)
s_barrier
v_mfma_f32_16x16x32_bf16 v[120:123], v[112:115], v[32:35], v[120:123]
ds_read_b64_tr_b16 v[48:49], v26 offset:0
v_rcp_f32 v230, v230
v_mfma_f32_16x16x32_bf16 v[124:127], a[192:195], v[32:35], v[124:127]
ds_read_b64_tr_b16 v[50:51], v26 offset:1024
v_mul_f32 v216, v216, v218
v_mul_f32 v220, v220, v222
v_mfma_f32_16x16x32_bf16 v[128:131], a[196:199], v[32:35], v[128:131]
ds_read_b64_tr_b16 v[52:53], v26 offset:2048
v_mul_f32 v224, v224, v226
v_mfma_f32_16x16x32_bf16 v[132:135], a[200:203], v[32:35], v[132:135]
ds_read_b64_tr_b16 v[54:55], v26 offset:3072
v_mul_f32 v228, v228, v230
v_mul_f32 v217, v217, v218
v_mfma_f32_16x16x32_bf16 v[136:139], a[204:207], v[32:35], v[136:139]
ds_read_b64_tr_b16 v[56:57], v26 offset:4096
v_mul_f32 v221, v221, v222
v_mul_f32 v225, v225, v226
v_mfma_f32_16x16x32_bf16 v[140:143], v[112:115], v[36:39], v[140:143]
ds_read_b64_tr_b16 v[58:59], v26 offset:5120
v_mul_f32 v229, v229, v230
v_cvt_pk_bf16_f32 v216, v216, v216
v_mfma_f32_16x16x32_bf16 v[144:147], a[192:195], v[36:39], v[144:147]
ds_read_b64_tr_b16 v[60:61], v26 offset:6144
v_cvt_pk_bf16_f32 v220, v220, v220
v_cvt_pk_bf16_f32 v224, v224, v224
v_mfma_f32_16x16x32_bf16 v[148:151], a[196:199], v[36:39], v[148:151]
ds_read_b64_tr_b16 v[62:63], v26 offset:7168
v_cvt_pk_bf16_f32 v228, v228, v228
v_cvt_pk_bf16_f32 v217, v217, v217
v_mfma_f32_16x16x32_bf16 v[152:155], a[200:203], v[36:39], v[152:155]
ds_read_b128 v[76:79], v10 offset:0
v_cvt_pk_bf16_f32 v221, v221, v221
v_mfma_f32_16x16x32_bf16 v[156:159], a[204:207], v[36:39], v[156:159]
ds_read_b128 v[80:83], v10 offset:64
s_add_u32 s7, s90, 50176
s_add_u32 m0, s72, 65536
v_cvt_pk_bf16_f32 v225, v225, v225
v_mfma_f32_16x16x32_bf16 v[120:123], v[116:119], v[40:43], v[120:123]
ds_read_b128 v[84:87], v10 offset:128
buffer_load_dwordx4 v12, s[40:43], s7 offen offset:0 lds
v_cvt_pk_bf16_f32 v229, v229, v229
v_mfma_f32_16x16x32_bf16 v[124:127], a[208:211], v[40:43], v[124:127]
ds_read_b128 v[88:91], v10 offset:192
v_and_b32 v200, v72, v216
v_and_b32 v204, v72, v220
v_mfma_f32_16x16x32_bf16 v[128:131], a[212:215], v[40:43], v[128:131]
ds_read_b128 v[92:95], v10 offset:256
buffer_load_dwordx4 v13, s[40:43], s7 offen offset:1024 lds
v_mfma_f32_16x16x32_bf16 v[132:135], a[216:219], v[40:43], v[132:135]
v_and_b32 v208, v72, v224
v_and_b32 v212, v72, v228
v_and_b32 v201, v73, v217
v_mfma_f32_16x16x32_bf16 v[136:139], a[220:223], v[40:43], v[136:139]
v_and_b32 v205, v73, v221
v_and_b32 v209, v73, v225
v_and_b32 v213, v73, v229
v_mfma_f32_16x16x32_bf16 v[140:143], v[116:119], v[44:47], v[140:143]
buffer_load_dwordx4 v14, s[40:43], s7 offen offset:2048 lds
v_and_b32 v202, v74, v216
v_mfma_f32_16x16x32_bf16 v[144:147], a[208:211], v[44:47], v[144:147]
v_and_b32 v206, v74, v220
v_and_b32 v210, v74, v224
v_and_b32 v214, v74, v228
v_mfma_f32_16x16x32_bf16 v[148:151], a[212:215], v[44:47], v[148:151]
buffer_load_dwordx4 v15, s[40:43], s7 offen offset:3072 lds
v_mfma_f32_16x16x32_bf16 v[152:155], a[216:219], v[44:47], v[152:155]
v_and_b32 v203, v75, v217
v_and_b32 v207, v75, v221
v_and_b32 v211, v75, v225
v_mfma_f32_16x16x32_bf16 v[156:159], a[220:223], v[44:47], v[156:159]
v_and_b32 v215, v75, v229
s_waitcnt vmcnt(12) lgkmcnt(5)
s_barrier
v_mfma_f32_32x32x16_bf16 v[160:175], v[48:51], a[0:3], 0
v_mov_b32 v8, v120
v_mov_b32 v9, v140
v_mov_b32 v216, v120
v_mov_b32 v217, v140
s_nop 0
v_permlane16_swap_b32 v8, v216
v_permlane16_swap_b32 v9, v217
ds_read_b64_tr_b16 v[32:33], v26 offset:16384
ds_read_b64_tr_b16 v[34:35], v26 offset:17408
v_mfma_f32_32x32x16_bf16 v[176:191], v[48:51], a[4:7], 0
ds_read_b64_tr_b16 v[36:37], v26 offset:18432
ds_read_b64_tr_b16 v[38:39], v26 offset:19456
v_mov_b32 v216, v8
v_mov_b32 v217, v9
v_mfma_f32_32x32x16_bf16 v[160:175], v[52:55], a[8:11], v[160:175]
v_permlane32_swap_b32 v8, v216
v_permlane32_swap_b32 v9, v217
ds_read_b64_tr_b16 v[40:41], v26 offset:20480
ds_read_b64_tr_b16 v[42:43], v26 offset:21504
s_waitcnt lgkmcnt(10)
v_fmac_f32 v120, v76, v8
v_fmac_f32 v121, v77, v8
v_fmac_f32 v122, v78, v8
v_fmac_f32 v123, v79, v8
v_cvt_pk_bf16_f32 v232, v120, v121
v_cvt_pk_bf16_f32 v233, v122, v123
s_waitcnt lgkmcnt(9)
v_fmac_f32 v124, v80, v8
v_fmac_f32 v125, v81, v8
v_fmac_f32 v126, v82, v8
v_fmac_f32 v127, v83, v8
v_mfma_f32_32x32x16_bf16 v[176:191], v[52:55], a[12:15], v[176:191]
ds_read_b64_tr_b16 v[44:45], v26 offset:22528
ds_read_b64_tr_b16 v[46:47], v26 offset:23552
s_add_u32 s7, s91, 0
s_add_u32 m0, s72, 0
v_cvt_pk_bf16_f32 v234, v124, v125
v_cvt_pk_bf16_f32 v235, v126, v127
s_waitcnt lgkmcnt(10)
v_fmac_f32 v128, v84, v8
v_fmac_f32 v129, v85, v8
v_fmac_f32 v130, v86, v8
v_fmac_f32 v131, v87, v8
v_cvt_pk_bf16_f32 v236, v128, v129
v_cvt_pk_bf16_f32 v237, v130, v131
s_waitcnt lgkmcnt(9)
v_fmac_f32 v132, v88, v8
v_mfma_f32_32x32x16_bf16 v[160:175], v[56:59], a[16:19], v[160:175]
buffer_load_dwordx4 v12, s[40:43], s7 offen offset:0 lds
v_fmac_f32 v133, v89, v8
v_fmac_f32 v134, v90, v8
v_fmac_f32 v135, v91, v8
v_cvt_pk_bf16_f32 v238, v132, v133
v_cvt_pk_bf16_f32 v239, v134, v135
s_waitcnt lgkmcnt(8)
v_fmac_f32 v136, v92, v8
v_fmac_f32 v137, v93, v8
v_fmac_f32 v138, v94, v8
v_fmac_f32 v139, v95, v8
v_cvt_pk_bf16_f32 v240, v136, v137
v_cvt_pk_bf16_f32 v241, v138, v139
v_mfma_f32_32x32x16_bf16 v[176:191], v[56:59], a[20:23], v[176:191]
buffer_load_dwordx4 v13, s[40:43], s7 offen offset:1024 lds
v_fmac_f32 v140, v76, v9
v_fmac_f32 v141, v77, v9
v_fmac_f32 v142, v78, v9
v_fmac_f32 v143, v79, v9
v_cvt_pk_bf16_f32 v242, v140, v141
v_cvt_pk_bf16_f32 v243, v142, v143
v_fmac_f32 v144, v80, v9
v_fmac_f32 v145, v81, v9
v_fmac_f32 v146, v82, v9
v_fmac_f32 v147, v83, v9
v_mfma_f32_32x32x16_bf16 v[160:175], v[60:63], a[24:27], v[160:175]
buffer_load_dwordx4 v14, s[40:43], s7 offen offset:2048 lds
v_cvt_pk_bf16_f32 v244, v144, v145
v_cvt_pk_bf16_f32 v245, v146, v147
v_fmac_f32 v148, v84, v9
v_fmac_f32 v149, v85, v9
v_fmac_f32 v150, v86, v9
v_fmac_f32 v151, v87, v9
v_cvt_pk_bf16_f32 v246, v148, v149
v_cvt_pk_bf16_f32 v247, v150, v151
v_fmac_f32 v152, v88, v9
v_fmac_f32 v153, v89, v9
v_mfma_f32_32x32x16_bf16 v[176:191], v[60:63], a[28:31], v[176:191]
buffer_load_dwordx4 v15, s[40:43], s7 offen offset:3072 lds
v_fmac_f32 v154, v90, v9
v_fmac_f32 v155, v91, v9
v_cvt_pk_bf16_f32 v248, v152, v153
v_cvt_pk_bf16_f32 v249, v154, v155
v_fmac_f32 v156, v92, v9
v_fmac_f32 v157, v93, v9
v_fmac_f32 v158, v94, v9
v_fmac_f32 v159, v95, v9
v_cvt_pk_bf16_f32 v250, v156, v157
v_cvt_pk_bf16_f32 v251, v158, v159
v_mfma_f32_16x16x32_bf16 v[120:123], v[232:235], v[200:203], 0
v_mfma_f32_16x16x32_bf16 v[124:127], v[234:237], v[204:207], 0
v_mfma_f32_16x16x32_bf16 v[128:131], v[236:239], v[208:211], 0
v_mfma_f32_16x16x32_bf16 v[132:135], v[238:241], v[212:215], 0
v_mfma_f32_16x16x32_bf16 v[136:139], v[242:245], v[200:203], 0
v_mfma_f32_16x16x32_bf16 v[140:143], v[244:247], v[204:207], 0
v_mfma_f32_16x16x32_bf16 v[144:147], v[246:249], v[208:211], 0
v_mfma_f32_16x16x32_bf16 v[148:151], v[248:251], v[212:215], 0
s_waitcnt vmcnt(12) lgkmcnt(0)
s_barrier
v_mfma_f32_32x32x16_bf16 v[80:95], v[32:35], a[0:3], 0
ds_read_b64_tr_b16 v[48:49], v26 offset:32768
ds_read_b64_tr_b16 v[50:51], v26 offset:33792
v_add_u32 v3, s72, v31
v_cvt_pk_bf16_f32 v216, v120, v121
v_cvt_pk_bf16_f32 v217, v122, v123
v_cvt_pk_bf16_f32 v218, v124, v125
v_cvt_pk_bf16_f32 v219, v126, v127
v_cvt_pk_bf16_f32 v220, v128, v129
v_cvt_pk_bf16_f32 v221, v130, v131
v_permlane32_swap_b32 v216, v218
v_mfma_f32_32x32x16_bf16 v[96:111], v[32:35], a[4:7], 0
ds_read_b64_tr_b16 v[52:53], v26 offset:34816
ds_read_b64_tr_b16 v[54:55], v26 offset:35840
v_permlane32_swap_b32 v217, v219
ds_write_b128 v3, v[216:219] offset:0
v_cvt_pk_bf16_f32 v222, v132, v133
v_cvt_pk_bf16_f32 v223, v134, v135
v_cvt_pk_bf16_f32 v224, v136, v137
v_cvt_pk_bf16_f32 v225, v138, v139
v_and_b32 v224, v71, v224
v_mfma_f32_32x32x16_bf16 v[80:95], v[36:39], a[8:11], v[80:95]
ds_read_b64_tr_b16 v[56:57], v26 offset:36864
ds_read_b64_tr_b16 v[58:59], v26 offset:37888
v_and_b32 v225, v71, v225
v_permlane32_swap_b32 v220, v222
v_permlane32_swap_b32 v221, v223
ds_write_b128 v3, v[220:223] offset:1024
v_cvt_pk_bf16_f32 v226, v140, v141
v_cvt_pk_bf16_f32 v227, v142, v143
v_mfma_f32_32x32x16_bf16 v[96:111], v[36:39], a[12:15], v[96:111]
ds_read_b64_tr_b16 v[60:61], v26 offset:38912
ds_read_b64_tr_b16 v[62:63], v26 offset:39936
s_add_u32 s7, s91, 50176
s_add_u32 m0, s72, 16384
v_and_b32 v226, v71, v226
v_and_b32 v227, v71, v227
v_cvt_pk_bf16_f32 v228, v144, v145
v_cvt_pk_bf16_f32 v229, v146, v147
v_and_b32 v228, v71, v228
v_and_b32 v229, v71, v229
v_mfma_f32_32x32x16_bf16 v[80:95], v[40:43], a[16:19], v[80:95]
buffer_load_dwordx4 v12, s[40:43], s7 offen offset:0 lds
v_permlane32_swap_b32 v224, v226
v_permlane32_swap_b32 v225, v227
ds_write_b128 v3, v[224:227] offset:2048
v_cvt_pk_bf16_f32 v230, v148, v149
v_cvt_pk_bf16_f32 v231, v150, v151
v_mfma_f32_32x32x16_bf16 v[96:111], v[40:43], a[20:23], v[96:111]
buffer_load_dwordx4 v13, s[40:43], s7 offen offset:1024 lds
v_and_b32 v230, v71, v230
v_and_b32 v231, v71, v231
s_nop 0
v_permlane32_swap_b32 v228, v230
v_permlane32_swap_b32 v229, v231
ds_write_b128 v3, v[228:231] offset:3072
v_mfma_f32_32x32x16_bf16 v[80:95], v[44:47], a[24:27], v[80:95]
buffer_load_dwordx4 v14, s[40:43], s7 offen offset:2048 lds
v_mfma_f32_32x32x16_bf16 v[96:111], v[44:47], a[28:31], v[96:111]
buffer_load_dwordx4 v15, s[40:43], s7 offen offset:3072 lds
s_waitcnt vmcnt(12) lgkmcnt(0)
s_barrier
v_mfma_f32_32x32x16_bf16 v[120:135], v[48:51], a[0:3], 0
ds_read_b64_tr_b16 v[32:33], v26 offset:49152
ds_read_b64_tr_b16 v[34:35], v26 offset:50176
ds_read_b128 a[32:35], v64 offset:0
v_mfma_f32_32x32x16_bf16 v[136:151], v[48:51], a[4:7], 0
ds_read_b64_tr_b16 v[36:37], v26 offset:51200
ds_read_b64_tr_b16 v[38:39], v26 offset:52224
ds_read_b128 a[36:39], v65 offset:0
s_and_b32 s96, s3, 1
s_lshl_b32 s97, s96, 2
v_bfe_u32 v2, v0, 1, 3
v_xor_b32 v2, s97, v2
s_lshl_b32 s96, s96, 7
s_add_u32 s96, s96, 156160
v_lshrrev_b32 v3, 5, v0
v_lshl_add_u32 v5, v3, 4, s96
s_lshr_b32 s96, s3, 1
s_lshl_b32 s97, s6, 1
s_add_u32 s96, s96, s97
s_lshl_b32 s96, s96, 12
s_add_u32 s96, s96, 81920
v_lshl_add_u32 v3, v3, 3, s96
v_mfma_f32_32x32x16_bf16 v[120:135], v[52:55], a[8:11], v[120:135]
ds_read_b64_tr_b16 v[40:41], v26 offset:53248
ds_read_b64_tr_b16 v[42:43], v26 offset:54272
ds_read_b128 a[40:43], v64 offset:2048
v_mfma_f32_32x32x16_bf16 v[136:151], v[52:55], a[12:15], v[136:151]
ds_read_b64_tr_b16 v[44:45], v26 offset:55296
ds_read_b64_tr_b16 v[46:47], v26 offset:56320
ds_read_b128 a[44:47], v65 offset:2048
s_add_u32 s7, s92, 0
s_add_u32 m0, s72, 32768
v_mfma_f32_32x32x16_bf16 v[120:135], v[56:59], a[16:19], v[120:135]
ds_read_b128 a[48:51], v64 offset:4096
ds_read_b128 a[52:55], v65 offset:4096
buffer_load_dwordx4 v12, s[40:43], s7 offen offset:0 lds
v_and_b32 v1, 31, v0
v_lshl_add_u32 v2, v2, 4, v3
v_mfma_f32_32x32x16_bf16 v[136:151], v[56:59], a[20:23], v[136:151]
ds_read_b128 a[56:59], v64 offset:6144
ds_read_b128 a[60:63], v65 offset:6144
buffer_load_dwordx4 v13, s[40:43], s7 offen offset:1024 lds
v_lshl_add_u32 v1, v1, 7, v2
v_xor_b32 v2, 16, v1
v_mfma_f32_32x32x16_bf16 v[120:135], v[60:63], a[24:27], v[120:135]
ds_read_b128 a[64:67], v64 offset:8192
ds_read_b128 a[68:71], v65 offset:8192
buffer_load_dwordx4 v14, s[40:43], s7 offen offset:2048 lds
v_xor_b32 v3, 32, v1
v_xor_b32 v6, 48, v1
v_mfma_f32_32x32x16_bf16 v[136:151], v[60:63], a[28:31], v[136:151]
ds_read_b128 a[72:75], v64 offset:10240
ds_read_b128 a[76:79], v65 offset:10240
ds_read_b128 a[80:83], v64 offset:12288
ds_read_b128 a[84:87], v65 offset:12288
ds_read_b128 a[88:91], v64 offset:14336
ds_read_b128 a[92:95], v65 offset:14336
buffer_load_dwordx4 v15, s[40:43], s7 offen offset:3072 lds
s_waitcnt vmcnt(12) lgkmcnt(13)
s_barrier
v_mfma_f32_32x32x16_bf16 v[160:175], v[32:35], a[32:35], v[160:175]
ds_read_b64_tr_b16 v[48:49], v27 offset:0
ds_read_b64_tr_b16 v[50:51], v27 offset:1024
ds_read_b128 v[200:203], v5 offset:0
v_mfma_f32_32x32x16_bf16 v[176:191], v[32:35], a[36:39], v[176:191]
ds_read_b64_tr_b16 v[52:53], v27 offset:2048
ds_read_b64_tr_b16 v[54:55], v27 offset:3072
ds_read_b128 v[204:207], v5 offset:32
v_mfma_f32_32x32x16_bf16 v[160:175], v[36:39], a[40:43], v[160:175]
ds_read_b64_tr_b16 v[56:57], v27 offset:4096
ds_read_b64_tr_b16 v[58:59], v27 offset:5120
ds_read_b128 v[208:211], v5 offset:64
s_waitcnt lgkmcnt(15)
v_mfma_f32_32x32x16_bf16 v[176:191], v[36:39], a[44:47], v[176:191]
ds_read_b64_tr_b16 v[60:61], v27 offset:6144
ds_read_b64_tr_b16 v[62:63], v27 offset:7168
ds_read_b128 v[212:215], v5 offset:96
s_add_u32 s7, s92, 50176
s_add_u32 m0, s72, 49152
v_mfma_f32_32x32x16_bf16 v[160:175], v[40:43], a[48:51], v[160:175]
ds_read_b64 v[216:217], v1
ds_read_b64 v[218:219], v2
buffer_load_dwordx4 v12, s[40:43], s7 offen offset:0 lds
v_mfma_f32_32x32x16_bf16 v[176:191], v[40:43], a[52:55], v[176:191]
ds_read_b64 v[220:221], v3
ds_read_b64 v[222:223], v6
buffer_load_dwordx4 v13, s[40:43], s7 offen offset:1024 lds
v_mfma_f32_32x32x16_bf16 v[160:175], v[44:47], a[56:59], v[160:175]
buffer_load_dwordx4 v14, s[40:43], s7 offen offset:2048 lds
v_mfma_f32_32x32x16_bf16 v[176:191], v[44:47], a[60:63], v[176:191]
buffer_load_dwordx4 v15, s[40:43], s7 offen offset:3072 lds
s_waitcnt vmcnt(12) lgkmcnt(5)
s_barrier
v_mfma_f32_32x32x16_bf16 v[160:175], v[48:51], a[64:67], v[160:175]
ds_read_b64_tr_b16 v[32:33], v26 offset:0
ds_read_b64_tr_b16 v[34:35], v26 offset:1024
s_waitcnt lgkmcnt(5)
v_mul_u32_u24 v224, s14, v216
v_mfma_f32_32x32x16_bf16 v[176:191], v[48:51], a[68:71], v[176:191]
ds_read_b64_tr_b16 v[36:37], v26 offset:2048
ds_read_b64_tr_b16 v[38:39], v26 offset:3072
v_and_b32 v225, s15, v216
v_mfma_f32_32x32x16_bf16 v[160:175], v[52:55], a[72:75], v[160:175]
ds_read_b64_tr_b16 v[40:41], v26 offset:4096
ds_read_b64_tr_b16 v[42:43], v26 offset:5120
v_add_f32 v200, v200, v224
v_mfma_f32_32x32x16_bf16 v[176:191], v[52:55], a[76:79], v[176:191]
ds_read_b64_tr_b16 v[44:45], v26 offset:6144
ds_read_b64_tr_b16 v[46:47], v26 offset:7168
s_add_u32 s7, s77, 0
s_add_u32 m0, s89, 65536
v_mfma_f32_32x32x16_bf16 v[160:175], v[56:59], a[80:83], v[160:175]
buffer_load_dwordx4 v12, s[52:55], s7 offen offset:0 lds
v_add_f32 v201, v201, v225
v_mfma_f32_32x32x16_bf16 v[176:191], v[56:59], a[84:87], v[176:191]
buffer_load_dwordx4 v13, s[52:55], s7 offen offset:1024 lds
v_mul_u32_u24 v226, s14, v217
v_mfma_f32_32x32x16_bf16 v[160:175], v[60:63], a[88:91], v[160:175]
v_and_b32 v227, s15, v217
v_mfma_f32_32x32x16_bf16 v[176:191], v[60:63], a[92:95], v[176:191]
v_add_f32 v202, v202, v226
s_waitcnt vmcnt(10) lgkmcnt(0)
s_barrier
v_mfma_f32_32x32x16_bf16 v[80:95], v[32:35], a[32:35], v[80:95]
ds_read_b64_tr_b16 v[48:49], v26 offset:16384
ds_read_b64_tr_b16 v[50:51], v26 offset:17408
v_add_f32 v203, v203, v227
v_mfma_f32_32x32x16_bf16 v[96:111], v[32:35], a[36:39], v[96:111]
ds_read_b64_tr_b16 v[52:53], v26 offset:18432
ds_read_b64_tr_b16 v[54:55], v26 offset:19456
v_cvt_pk_bf16_f32 v232, v160, v161
v_cvt_pk_bf16_f32 v233, v162, v163
v_mul_u32_u24 v224, s14, v218
v_mfma_f32_32x32x16_bf16 v[80:95], v[36:39], a[40:43], v[80:95]
ds_read_b64_tr_b16 v[56:57], v26 offset:20480
ds_read_b64_tr_b16 v[58:59], v26 offset:21504
v_cvt_pk_bf16_f32 v234, v164, v165
v_cvt_pk_bf16_f32 v235, v166, v167
v_and_b32 v225, s15, v218
v_mfma_f32_32x32x16_bf16 v[96:111], v[36:39], a[44:47], v[96:111]
ds_read_b64_tr_b16 v[60:61], v26 offset:22528
ds_read_b64_tr_b16 v[62:63], v26 offset:23552
s_add_u32 s7, s93, 0
s_add_u32 m0, s72, 0
v_add_f32 v204, v204, v224
buffer_store_dwordx4 v[232:235], v66, s[68:71], s78 offen offset:0 sc1
v_mfma_f32_32x32x16_bf16 v[80:95], v[40:43], a[48:51], v[80:95]
buffer_load_dwordx4 v12, s[40:43], s7 offen offset:0 lds
v_add_f32 v205, v205, v225
v_mfma_f32_32x32x16_bf16 v[96:111], v[40:43], a[52:55], v[96:111]
buffer_load_dwordx4 v13, s[40:43], s7 offen offset:1024 lds
v_cvt_pk_bf16_f32 v236, v168, v169
v_cvt_pk_bf16_f32 v237, v170, v171
v_mul_u32_u24 v226, s14, v219
v_mfma_f32_32x32x16_bf16 v[80:95], v[44:47], a[56:59], v[80:95]
buffer_load_dwordx4 v14, s[40:43], s7 offen offset:2048 lds
v_cvt_pk_bf16_f32 v238, v172, v173
v_cvt_pk_bf16_f32 v239, v174, v175
v_and_b32 v227, s15, v219
v_mfma_f32_32x32x16_bf16 v[96:111], v[44:47], a[60:63], v[96:111]
buffer_load_dwordx4 v15, s[40:43], s7 offen offset:3072 lds
buffer_store_dwordx4 v[236:239], v66, s[68:71], s78 offen offset:1024 sc1
s_waitcnt vmcnt(12) lgkmcnt(0)
s_barrier
v_mfma_f32_32x32x16_bf16 v[80:95], v[48:51], a[64:67], v[80:95]
ds_read_b64_tr_b16 v[32:33], v26 offset:32768
ds_read_b64_tr_b16 v[34:35], v26 offset:33792
v_add_f32 v206, v206, v226
v_mfma_f32_32x32x16_bf16 v[96:111], v[48:51], a[68:71], v[96:111]
ds_read_b64_tr_b16 v[36:37], v26 offset:34816
ds_read_b64_tr_b16 v[38:39], v26 offset:35840
v_cvt_pk_bf16_f32 v240, v176, v177
v_cvt_pk_bf16_f32 v241, v178, v179
v_mfma_f32_32x32x16_bf16 v[80:95], v[52:55], a[72:75], v[80:95]
ds_read_b64_tr_b16 v[40:41], v26 offset:36864
ds_read_b64_tr_b16 v[42:43], v26 offset:37888
v_cvt_pk_bf16_f32 v242, v180, v181
v_cvt_pk_bf16_f32 v243, v182, v183
v_add_f32 v207, v207, v227
v_mfma_f32_32x32x16_bf16 v[96:111], v[52:55], a[76:79], v[96:111]
ds_read_b64_tr_b16 v[44:45], v26 offset:38912
ds_read_b64_tr_b16 v[46:47], v26 offset:39936
buffer_store_dwordx4 v[240:243], v67, s[68:71], s78 offen offset:0 sc1
v_mfma_f32_32x32x16_bf16 v[80:95], v[56:59], a[80:83], v[80:95]
v_mul_u32_u24 v224, s14, v220
v_and_b32 v225, s15, v220
v_mfma_f32_32x32x16_bf16 v[96:111], v[56:59], a[84:87], v[96:111]
v_cvt_pk_bf16_f32 v244, v184, v185
v_cvt_pk_bf16_f32 v245, v186, v187
v_add_f32 v208, v208, v224
v_mfma_f32_32x32x16_bf16 v[80:95], v[60:63], a[88:91], v[80:95]
v_cvt_pk_bf16_f32 v246, v188, v189
v_cvt_pk_bf16_f32 v247, v190, v191
v_mfma_f32_32x32x16_bf16 v[96:111], v[60:63], a[92:95], v[96:111]
v_add_f32 v209, v209, v225
buffer_store_dwordx4 v[244:247], v67, s[68:71], s78 offen offset:1024 sc1
s_waitcnt vmcnt(10) lgkmcnt(0)
s_barrier
v_mfma_f32_32x32x16_bf16 v[120:135], v[32:35], a[32:35], v[120:135]
ds_read_b64_tr_b16 v[48:49], v26 offset:49152
ds_read_b64_tr_b16 v[50:51], v26 offset:50176
v_mul_u32_u24 v226, s14, v221
v_mfma_f32_32x32x16_bf16 v[136:151], v[32:35], a[36:39], v[136:151]
ds_read_b64_tr_b16 v[52:53], v26 offset:51200
ds_read_b64_tr_b16 v[54:55], v26 offset:52224
v_cvt_pk_bf16_f32 v232, v80, v81
v_cvt_pk_bf16_f32 v233, v82, v83
v_mfma_f32_32x32x16_bf16 v[120:135], v[36:39], a[40:43], v[120:135]
ds_read_b64_tr_b16 v[56:57], v26 offset:53248
ds_read_b64_tr_b16 v[58:59], v26 offset:54272
v_cvt_pk_bf16_f32 v234, v84, v85
v_cvt_pk_bf16_f32 v235, v86, v87
v_and_b32 v227, s15, v221
v_mfma_f32_32x32x16_bf16 v[136:151], v[36:39], a[44:47], v[136:151]
ds_read_b64_tr_b16 v[60:61], v26 offset:55296
ds_read_b64_tr_b16 v[62:63], v26 offset:56320
buffer_store_dwordx4 v[232:235], v66, s[68:71], s79 offen offset:0 sc1
v_mfma_f32_32x32x16_bf16 v[120:135], v[40:43], a[48:51], v[120:135]
v_add_f32 v210, v210, v226
v_add_f32 v211, v211, v227
v_mfma_f32_32x32x16_bf16 v[136:151], v[40:43], a[52:55], v[136:151]
v_cvt_pk_bf16_f32 v236, v88, v89
v_cvt_pk_bf16_f32 v237, v90, v91
v_mul_u32_u24 v224, s14, v222
v_mfma_f32_32x32x16_bf16 v[120:135], v[44:47], a[56:59], v[120:135]
v_cvt_pk_bf16_f32 v238, v92, v93
v_cvt_pk_bf16_f32 v239, v94, v95
v_mfma_f32_32x32x16_bf16 v[136:151], v[44:47], a[60:63], v[136:151]
v_and_b32 v225, s15, v222
buffer_store_dwordx4 v[236:239], v66, s[68:71], s79 offen offset:1024 sc1
s_waitcnt vmcnt(10) lgkmcnt(0)
s_barrier
v_mfma_f32_32x32x16_bf16 v[120:135], v[48:51], a[64:67], v[120:135]
ds_read_b64_tr_b16 a[192:193], v29 offset:0
ds_read_b64_tr_b16 a[194:195], v29 offset:1024
v_add_f32 v212, v212, v224
v_mfma_f32_32x32x16_bf16 v[136:151], v[48:51], a[68:71], v[136:151]
ds_read_b64_tr_b16 a[196:197], v29 offset:2048
ds_read_b64_tr_b16 a[198:199], v29 offset:3072
v_cvt_pk_bf16_f32 v240, v96, v97
v_cvt_pk_bf16_f32 v241, v98, v99
v_mfma_f32_32x32x16_bf16 v[120:135], v[52:55], a[72:75], v[120:135]
ds_read_b64_tr_b16 a[200:201], v29 offset:4096
ds_read_b64_tr_b16 a[202:203], v29 offset:5120
v_cvt_pk_bf16_f32 v242, v100, v101
v_cvt_pk_bf16_f32 v243, v102, v103
v_add_f32 v213, v213, v225
v_mfma_f32_32x32x16_bf16 v[136:151], v[52:55], a[76:79], v[136:151]
ds_read_b64_tr_b16 a[204:205], v29 offset:6144
ds_read_b64_tr_b16 a[206:207], v29 offset:7168
buffer_store_dwordx4 v[240:243], v67, s[68:71], s79 offen offset:0 sc1
v_mfma_f32_32x32x16_bf16 v[120:135], v[56:59], a[80:83], v[120:135]
v_mul_u32_u24 v226, s14, v223
v_and_b32 v227, s15, v223
v_mfma_f32_32x32x16_bf16 v[136:151], v[56:59], a[84:87], v[136:151]
v_cvt_pk_bf16_f32 v244, v104, v105
v_cvt_pk_bf16_f32 v245, v106, v107
v_add_f32 v214, v214, v226
v_mfma_f32_32x32x16_bf16 v[120:135], v[60:63], a[88:91], v[120:135]
v_cvt_pk_bf16_f32 v246, v108, v109
v_cvt_pk_bf16_f32 v247, v110, v111
v_mfma_f32_32x32x16_bf16 v[136:151], v[60:63], a[92:95], v[136:151]
v_add_f32 v215, v215, v227
buffer_store_dwordx4 v[244:247], v67, s[68:71], s79 offen offset:1024 sc1
s_waitcnt vmcnt(7) lgkmcnt(0)
s_barrier
v_mfma_f32_32x32x16_bf16 v[200:215], a[192:195], a[0:3], v[200:215]
ds_read_b64_tr_b16 a[224:225], v28 offset:0
ds_read_b64_tr_b16 a[226:227], v28 offset:1024
s_nop 1
v_cvt_pk_bf16_f32 v232, v120, v121
v_cvt_pk_bf16_f32 v233, v122, v123
v_cvt_pk_bf16_f32 v234, v124, v125
v_cvt_pk_bf16_f32 v235, v126, v127
v_mfma_f32_32x32x16_bf16 v[200:215], a[196:199], a[8:11], v[200:215]
ds_read_b64_tr_b16 a[228:229], v28 offset:2048
ds_read_b64_tr_b16 a[230:231], v28 offset:3072
buffer_store_dwordx4 v[232:235], v66, s[68:71], s80 offen offset:0 sc1
v_mfma_f32_32x32x16_bf16 v[200:215], a[200:203], a[16:19], v[200:215]
ds_read_b64_tr_b16 a[232:233], v28 offset:4096
ds_read_b64_tr_b16 a[234:235], v28 offset:5120
v_cvt_pk_bf16_f32 v236, v128, v129
v_cvt_pk_bf16_f32 v237, v130, v131
v_cvt_pk_bf16_f32 v238, v132, v133
v_cvt_pk_bf16_f32 v239, v134, v135
v_mfma_f32_32x32x16_bf16 v[200:215], a[204:207], a[24:27], v[200:215]
ds_read_b64_tr_b16 a[236:237], v28 offset:6144
ds_read_b64_tr_b16 a[238:239], v28 offset:7168
ds_read_b64_tr_b16 a[240:241], v28 offset:8192
ds_read_b64_tr_b16 a[242:243], v28 offset:9216
ds_read_b64_tr_b16 a[244:245], v28 offset:10240
ds_read_b64_tr_b16 a[246:247], v28 offset:11264
ds_read_b64_tr_b16 a[248:249], v28 offset:12288
ds_read_b64_tr_b16 a[250:251], v28 offset:13312
ds_read_b64_tr_b16 a[252:253], v28 offset:14336
ds_read_b64_tr_b16 a[254:255], v28 offset:15360
buffer_store_dwordx4 v[236:239], v66, s[68:71], s80 offen offset:1024 sc1
v_mov_b32 v4, 1
s_waitcnt vmcnt(6)
buffer_store_dword v4, v7, s[68:71], s24 offen sc1
s_waitcnt lgkmcnt(14)
v_mfma_f32_32x32x16_bf16 v[200:215], a[224:227], a[32:35], v[200:215]
s_waitcnt lgkmcnt(12)
v_mfma_f32_32x32x16_bf16 v[200:215], a[228:231], a[40:43], v[200:215]
v_cvt_pk_bf16_f32 v240, v136, v137
v_cvt_pk_bf16_f32 v241, v138, v139
s_waitcnt lgkmcnt(10)
v_mfma_f32_32x32x16_bf16 v[200:215], a[232:235], a[48:51], v[200:215]
v_cvt_pk_bf16_f32 v242, v140, v141
v_cvt_pk_bf16_f32 v243, v142, v143
s_waitcnt lgkmcnt(8)
v_mfma_f32_32x32x16_bf16 v[200:215], a[236:239], a[56:59], v[200:215]
buffer_store_dwordx4 v[240:243], v67, s[68:71], s80 offen offset:0 sc1
s_waitcnt lgkmcnt(6)
v_mfma_f32_32x32x16_bf16 v[200:215], a[240:243], a[64:67], v[200:215]
s_waitcnt lgkmcnt(4)
v_mfma_f32_32x32x16_bf16 v[200:215], a[244:247], a[72:75], v[200:215]
v_cvt_pk_bf16_f32 v244, v144, v145
v_cvt_pk_bf16_f32 v245, v146, v147
s_waitcnt lgkmcnt(2)
v_mfma_f32_32x32x16_bf16 v[200:215], a[248:251], a[80:83], v[200:215]
v_cvt_pk_bf16_f32 v246, v148, v149
v_cvt_pk_bf16_f32 v247, v150, v151
s_waitcnt lgkmcnt(0)
v_mfma_f32_32x32x16_bf16 v[200:215], a[252:255], a[88:91], v[200:215]
buffer_store_dwordx4 v[244:247], v67, s[68:71], s80 offen offset:1024 sc1
s_nop 7
s_nop 3
s_cmp_lg_u32 s5, 7
s_cbranch_scc1 La_own
v_cvt_pk_bf16_f32 v232, v200, v201
v_cvt_pk_bf16_f32 v233, v202, v203
v_cvt_pk_bf16_f32 v234, v204, v205
v_cvt_pk_bf16_f32 v235, v206, v207
buffer_store_dwordx4 v[232:235], v66, s[68:71], s81 offen offset:0 sc1
v_cvt_pk_bf16_f32 v236, v208, v209
v_cvt_pk_bf16_f32 v237, v210, v211
v_cvt_pk_bf16_f32 v238, v212, v213
v_cvt_pk_bf16_f32 v239, v214, v215
buffer_store_dwordx4 v[236:239], v66, s[68:71], s81 offen offset:1024 sc1
v_mov_b32 v4, 2
s_waitcnt vmcnt(7)
buffer_store_dword v4, v7, s[68:71], s24 offen offset:128 sc1
v_mov_b32 v4, 3
s_waitcnt vmcnt(3)
buffer_store_dword v4, v7, s[68:71], s24 offen offset:256 sc1
v_mov_b32 v4, 4
s_waitcnt vmcnt(2)
buffer_store_dword v4, v7, s[68:71], s24 offen offset:384 sc1
s_branch La_fin
La_own:
v_mov_b32 v4, 2
s_waitcnt vmcnt(5)
buffer_store_dword v4, v7, s[68:71], s24 offen offset:128 sc1
v_readfirstlane_b32 s28, v69
v_mov_b32 v4, 3
s_waitcnt vmcnt(1)
buffer_load_dword v254, v68, s[68:71], s86 offen sc1
buffer_store_dword v4, v7, s[68:71], s24 offen offset:256 sc1
s_mov_b32 s30, 2097152
s_mov_b32 s59, 127
s_mov_b32 s26, 0
s_mov_b32 s27, 0
s_cmp_ge_u32 s28, 8
s_waitcnt vmcnt(1)
s_cbranch_scc1 La_see
s_lshl_b32 s97, s4, 3
La_dbg:
v_readfirstlane_b32 s96, v69
s_sub_u32 s30, s30, 1
s_cselect_b32 s96, 8, s96
s_cmp_ge_u32 s96, 8
s_cbranch_scc1 La_go
buffer_load_dword v69, v7, s[64:67], s97 offen sc1
s_waitcnt vmcnt(0)
s_branch La_dbg
La_go:
s_mov_b32 s30, 2097152
s_mov_b32 s27, 0
buffer_load_dword v254, v68, s[68:71], s86 offen sc1
La_wait:
s_waitcnt vmcnt(0)
La_see:
s_and_b32 s98, s27, s9
s_or_b32 s25, s25, s27
s_andn2_b32 s59, s59, s27
s_cbranch_scc0 La_disp
v_cmp_le_u32 vcc, v253, v254
s_sub_u32 s30, s30, 1
s_cselect_b32 s96, -1, 0
s_andn2_b32 s9, s9, s96
s_or_b32 s27, vcc_lo, s96
s_and_b32 s27, s27, s59
s_cbranch_scc0 La_nl6
s_cmp_eq_u32 s27, s59
s_cbranch_scc1 La_last
s_bitcmp1_b32 s27, 0
s_cbranch_scc0 La_nl0
buffer_load_dwordx4 v[80:83], v66, s[68:71], s48 offen offset:0 sc1
buffer_load_dwordx4 v[84:87], v66, s[68:71], s48 offen offset:1024 sc1
La_nl0:
s_bitcmp1_b32 s27, 1
s_cbranch_scc0 La_nl1
buffer_load_dwordx4 v[88:91], v66, s[68:71], s49 offen offset:0 sc1
buffer_load_dwordx4 v[92:95], v66, s[68:71], s49 offen offset:1024 sc1
La_nl1:
s_bitcmp1_b32 s27, 2
s_cbranch_scc0 La_nl2
buffer_load_dwordx4 v[96:99], v66, s[68:71], s50 offen offset:0 sc1
buffer_load_dwordx4 v[100:103], v66, s[68:71], s50 offen offset:1024 sc1
La_nl2:
s_bitcmp1_b32 s27, 3
s_cbranch_scc0 La_nl3
buffer_load_dwordx4 v[104:107], v66, s[68:71], s51 offen offset:0 sc1
buffer_load_dwordx4 v[108:111], v66, s[68:71], s51 offen offset:1024 sc1
La_nl3:
s_bitcmp1_b32 s27, 4
s_cbranch_scc0 La_nl4
buffer_load_dwordx4 v[112:115], v66, s[68:71], s56 offen offset:0 sc1
buffer_load_dwordx4 v[116:119], v66, s[68:71], s56 offen offset:1024 sc1
La_nl4:
s_bitcmp1_b32 s27, 5
s_cbranch_scc0 La_nl5
buffer_load_dwordx4 v[120:123], v66, s[68:71], s57 offen offset:0 sc1
buffer_load_dwordx4 v[124:127], v66, s[68:71], s57 offen offset:1024 sc1
La_nl5:
s_bitcmp1_b32 s27, 6
s_cbranch_scc0 La_nl6
buffer_load_dwordx4 v[128:131], v66, s[68:71], s58 offen offset:0 sc1
buffer_load_dwordx4 v[132:135], v66, s[68:71], s58 offen offset:1024 sc1
La_nl6:
buffer_load_dword v254, v68, s[68:71], s86 offen sc1
La_disp:
s_cmp_eq_u32 s26, 5
s_cbranch_scc1 La_sum5
s_cmp_eq_u32 s26, 6
s_cbranch_scc1 La_sum6
s_cmp_eq_u32 s26, 4
s_cbranch_scc1 La_sum4
s_cmp_eq_u32 s26, 3
s_cbranch_scc1 La_sum3
s_cmp_eq_u32 s26, 2
s_cbranch_scc1 La_sum2
s_cmp_eq_u32 s26, 1
s_cbranch_scc1 La_sum1
La_sum0:
s_mov_b32 s26, 0
s_bitcmp1_b32 s25, 0
s_cbranch_scc0 La_wait
v_dot2_f32_bf16 v200, v80, s84, v200
v_dot2_f32_bf16 v201, v80, s85, v201
v_dot2_f32_bf16 v202, v81, s84, v202
v_dot2_f32_bf16 v203, v81, s85, v203
v_dot2_f32_bf16 v204, v82, s84, v204
v_dot2_f32_bf16 v205, v82, s85, v205
v_dot2_f32_bf16 v206, v83, s84, v206
v_dot2_f32_bf16 v207, v83, s85, v207
v_dot2_f32_bf16 v208, v84, s84, v208
v_dot2_f32_bf16 v209, v84, s85, v209
v_dot2_f32_bf16 v210, v85, s84, v210
v_dot2_f32_bf16 v211, v85, s85, v211
v_dot2_f32_bf16 v212, v86, s84, v212
v_dot2_f32_bf16 v213, v86, s85, v213
v_dot2_f32_bf16 v214, v87, s84, v214
v_dot2_f32_bf16 v215, v87, s85, v215
La_sum1:
s_mov_b32 s26, 1
s_bitcmp1_b32 s25, 1
s_cbranch_scc0 La_wait
v_dot2_f32_bf16 v200, v88, s84, v200
v_dot2_f32_bf16 v201, v88, s85, v201
v_dot2_f32_bf16 v202, v89, s84, v202
v_dot2_f32_bf16 v203, v89, s85, v203
v_dot2_f32_bf16 v204, v90, s84, v204
v_dot2_f32_bf16 v205, v90, s85, v205
v_dot2_f32_bf16 v206, v91, s84, v206
v_dot2_f32_bf16 v207, v91, s85, v207
v_dot2_f32_bf16 v208, v92, s84, v208
v_dot2_f32_bf16 v209, v92, s85, v209
v_dot2_f32_bf16 v210, v93, s84, v210
v_dot2_f32_bf16 v211, v93, s85, v211
v_dot2_f32_bf16 v212, v94, s84, v212
v_dot2_f32_bf16 v213, v94, s85, v213
v_dot2_f32_bf16 v214, v95, s84, v214
v_dot2_f32_bf16 v215, v95, s85, v215
La_sum2:
s_mov_b32 s26, 2
s_bitcmp1_b32 s25, 2
s_cbranch_scc0 La_wait
v_dot2_f32_bf16 v200, v96, s84, v200
v_dot2_f32_bf16 v201, v96, s85, v201
v_dot2_f32_bf16 v202, v97, s84, v202
v_dot2_f32_bf16 v203, v97, s85, v203
v_dot2_f32_bf16 v204, v98, s84, v204
v_dot2_f32_bf16 v205, v98, s85, v205
v_dot2_f32_bf16 v206, v99, s84, v206
v_dot2_f32_bf16 v207, v99, s85, v207
v_dot2_f32_bf16 v208, v100, s84, v208
v_dot2_f32_bf16 v209, v100, s85, v209
v_dot2_f32_bf16 v210, v101, s84, v210
v_dot2_f32_bf16 v211, v101, s85, v211
v_dot2_f32_bf16 v212, v102, s84, v212
v_dot2_f32_bf16 v213, v102, s85, v213
v_dot2_f32_bf16 v214, v103, s84, v214
v_dot2_f32_bf16 v215, v103, s85, v215
La_sum3:
s_mov_b32 s26, 3
s_bitcmp1_b32 s25, 3
s_cbranch_scc0 La_wait
v_dot2_f32_bf16 v200, v104, s84, v200
v_dot2_f32_bf16 v201, v104, s85, v201
v_dot2_f32_bf16 v202, v105, s84, v202
v_dot2_f32_bf16 v203, v105, s85, v203
v_dot2_f32_bf16 v204, v106, s84, v204
v_dot2_f32_bf16 v205, v106, s85, v205
v_dot2_f32_bf16 v206, v107, s84, v206
v_dot2_f32_bf16 v207, v107, s85, v207
v_dot2_f32_bf16 v208, v108, s84, v208
v_dot2_f32_bf16 v209, v108, s85, v209
v_dot2_f32_bf16 v210, v109, s84, v210
v_dot2_f32_bf16 v211, v109, s85, v211
v_dot2_f32_bf16 v212, v110, s84, v212
v_dot2_f32_bf16 v213, v110, s85, v213
v_dot2_f32_bf16 v214, v111, s84, v214
v_dot2_f32_bf16 v215, v111, s85, v215
La_sum4:
s_mov_b32 s26, 4
s_bitcmp1_b32 s25, 4
s_cbranch_scc0 La_wait
v_dot2_f32_bf16 v200, v112, s84, v200
v_dot2_f32_bf16 v201, v112, s85, v201
v_dot2_f32_bf16 v202, v113, s84, v202
v_dot2_f32_bf16 v203, v113, s85, v203
v_dot2_f32_bf16 v204, v114, s84, v204
v_dot2_f32_bf16 v205, v114, s85, v205
v_dot2_f32_bf16 v206, v115, s84, v206
v_dot2_f32_bf16 v207, v115, s85, v207
v_dot2_f32_bf16 v208, v116, s84, v208
v_dot2_f32_bf16 v209, v116, s85, v209
v_dot2_f32_bf16 v210, v117, s84, v210
v_dot2_f32_bf16 v211, v117, s85, v211
v_dot2_f32_bf16 v212, v118, s84, v212
v_dot2_f32_bf16 v213, v118, s85, v213
v_dot2_f32_bf16 v214, v119, s84, v214
v_dot2_f32_bf16 v215, v119, s85, v215
La_sum5:
s_mov_b32 s26, 5
s_bitcmp1_b32 s25, 5
s_cbranch_scc0 La_wait
v_dot2_f32_bf16 v200, v120, s84, v200
v_dot2_f32_bf16 v201, v120, s85, v201
v_dot2_f32_bf16 v202, v121, s84, v202
v_dot2_f32_bf16 v203, v121, s85, v203
v_dot2_f32_bf16 v204, v122, s84, v204
v_dot2_f32_bf16 v205, v122, s85, v205
v_dot2_f32_bf16 v206, v123, s84, v206
v_dot2_f32_bf16 v207, v123, s85, v207
v_dot2_f32_bf16 v208, v124, s84, v208
v_dot2_f32_bf16 v209, v124, s85, v209
v_dot2_f32_bf16 v210, v125, s84, v210
v_dot2_f32_bf16 v211, v125, s85, v211
v_dot2_f32_bf16 v212, v126, s84, v212
v_dot2_f32_bf16 v213, v126, s85, v213
v_dot2_f32_bf16 v214, v127, s84, v214
v_dot2_f32_bf16 v215, v127, s85, v215
La_sum6:
s_mov_b32 s26, 6
s_bitcmp1_b32 s25, 6
s_cbranch_scc0 La_wait
v_dot2_f32_bf16 v200, v128, s84, v200
v_dot2_f32_bf16 v201, v128, s85, v201
v_dot2_f32_bf16 v202, v129, s84, v202
v_dot2_f32_bf16 v203, v129, s85, v203
v_dot2_f32_bf16 v204, v130, s84, v204
v_dot2_f32_bf16 v205, v130, s85, v205
v_dot2_f32_bf16 v206, v131, s84, v206
v_dot2_f32_bf16 v207, v131, s85, v207
v_dot2_f32_bf16 v208, v132, s84, v208
v_dot2_f32_bf16 v209, v132, s85, v209
v_dot2_f32_bf16 v210, v133, s84, v210
v_dot2_f32_bf16 v211, v133, s85, v211
v_dot2_f32_bf16 v212, v134, s84, v212
v_dot2_f32_bf16 v213, v134, s85, v213
v_dot2_f32_bf16 v214, v135, s84, v214
v_dot2_f32_bf16 v215, v135, s85, v215
s_branch La_done
La_last:
s_ff1_i32_b32 s97, s27
s_mov_b32 s96, 2147483632
s_cmp_eq_u32 s97, 5
s_cbranch_scc1 La_r5
s_cmp_eq_u32 s97, 6
s_cbranch_scc1 La_r6
s_cmp_eq_u32 s97, 2
s_cbranch_scc1 La_r2
s_cmp_eq_u32 s97, 3
s_cbranch_scc1 La_r3
s_cmp_eq_u32 s97, 4
s_cbranch_scc1 La_r4
s_cmp_eq_u32 s97, 1
s_cbranch_scc1 La_r1
buffer_load_dwordx4 v[80:83], v66, s[68:71], s48 offen offset:0 sc1
buffer_load_dwordx4 v[84:87], v66, s[68:71], s48 offen offset:1024 sc1
La_f0:
s_bitcmp1_b32 s27, 1
s_cbranch_scc1 La_r1
buffer_load_dword v254, v7, s[68:71], s96 offen
buffer_load_dword v254, v7, s[68:71], s96 offen
s_branch La_f1
La_r1:
buffer_load_dwordx4 v[88:91], v66, s[68:71], s49 offen offset:0 sc1
buffer_load_dwordx4 v[92:95], v66, s[68:71], s49 offen offset:1024 sc1
La_f1:
s_bitcmp1_b32 s27, 2
s_cbranch_scc1 La_r2
buffer_load_dword v254, v7, s[68:71], s96 offen
buffer_load_dword v254, v7, s[68:71], s96 offen
s_branch La_f2
La_r2:
buffer_load_dwordx4 v[96:99], v66, s[68:71], s50 offen offset:0 sc1
buffer_load_dwordx4 v[100:103], v66, s[68:71], s50 offen offset:1024 sc1
La_f2:
s_bitcmp1_b32 s27, 3
s_cbranch_scc1 La_r3
buffer_load_dword v254, v7, s[68:71], s96 offen
buffer_load_dword v254, v7, s[68:71], s96 offen
s_branch La_f3
La_r3:
buffer_load_dwordx4 v[104:107], v66, s[68:71], s51 offen offset:0 sc1
buffer_load_dwordx4 v[108:111], v66, s[68:71], s51 offen offset:1024 sc1
La_f3:
s_bitcmp1_b32 s27, 4
s_cbranch_scc1 La_r4
buffer_load_dword v254, v7, s[68:71], s96 offen
buffer_load_dword v254, v7, s[68:71], s96 offen
s_branch La_f4
La_r4:
buffer_load_dwordx4 v[112:115], v66, s[68:71], s56 offen offset:0 sc1
buffer_load_dwordx4 v[116:119], v66, s[68:71], s56 offen offset:1024 sc1
La_f4:
s_bitcmp1_b32 s27, 5
s_cbranch_scc1 La_r5
buffer_load_dword v254, v7, s[68:71], s96 offen
buffer_load_dword v254, v7, s[68:71], s96 offen
s_branch La_f5
La_r5:
buffer_load_dwordx4 v[120:123], v66, s[68:71], s57 offen offset:0 sc1
buffer_load_dwordx4 v[124:127], v66, s[68:71], s57 offen offset:1024 sc1
La_f5:
s_bitcmp1_b32 s27, 6
s_cbranch_scc1 La_r6
buffer_load_dword v254, v7, s[68:71], s96 offen
buffer_load_dword v254, v7, s[68:71], s96 offen
s_branch La_f6
La_r6:
buffer_load_dwordx4 v[128:131], v66, s[68:71], s58 offen offset:0 sc1
buffer_load_dwordx4 v[132:135], v66, s[68:71], s58 offen offset:1024 sc1
La_f6:
s_cmp_eq_u32 s26, 6
s_cbranch_scc1 La_ls6
s_cmp_eq_u32 s26, 5
s_cbranch_scc1 La_ls5
s_cmp_eq_u32 s26, 4
s_cbranch_scc1 La_ls4
s_cmp_eq_u32 s26, 3
s_cbranch_scc1 La_ls3
s_cmp_eq_u32 s26, 2
s_cbranch_scc1 La_ls2
s_cmp_eq_u32 s26, 1
s_cbranch_scc1 La_ls1
La_ls0:
s_waitcnt vmcnt(12)
v_dot2_f32_bf16 v200, v80, s84, v200
v_dot2_f32_bf16 v201, v80, s85, v201
v_dot2_f32_bf16 v202, v81, s84, v202
v_dot2_f32_bf16 v203, v81, s85, v203
v_dot2_f32_bf16 v204, v82, s84, v204
v_dot2_f32_bf16 v205, v82, s85, v205
v_dot2_f32_bf16 v206, v83, s84, v206
v_dot2_f32_bf16 v207, v83, s85, v207
v_dot2_f32_bf16 v208, v84, s84, v208
v_dot2_f32_bf16 v209, v84, s85, v209
v_dot2_f32_bf16 v210, v85, s84, v210
v_dot2_f32_bf16 v211, v85, s85, v211
v_dot2_f32_bf16 v212, v86, s84, v212
v_dot2_f32_bf16 v213, v86, s85, v213
v_dot2_f32_bf16 v214, v87, s84, v214
v_dot2_f32_bf16 v215, v87, s85, v215
La_ls1:
s_waitcnt vmcnt(10)
v_dot2_f32_bf16 v200, v88, s84, v200
v_dot2_f32_bf16 v201, v88, s85, v201
v_dot2_f32_bf16 v202, v89, s84, v202
v_dot2_f32_bf16 v203, v89, s85, v203
v_dot2_f32_bf16 v204, v90, s84, v204
v_dot2_f32_bf16 v205, v90, s85, v205
v_dot2_f32_bf16 v206, v91, s84, v206
v_dot2_f32_bf16 v207, v91, s85, v207
v_dot2_f32_bf16 v208, v92, s84, v208
v_dot2_f32_bf16 v209, v92, s85, v209
v_dot2_f32_bf16 v210, v93, s84, v210
v_dot2_f32_bf16 v211, v93, s85, v211
v_dot2_f32_bf16 v212, v94, s84, v212
v_dot2_f32_bf16 v213, v94, s85, v213
v_dot2_f32_bf16 v214, v95, s84, v214
v_dot2_f32_bf16 v215, v95, s85, v215
La_ls2:
s_waitcnt vmcnt(8)
v_dot2_f32_bf16 v200, v96, s84, v200
v_dot2_f32_bf16 v201, v96, s85, v201
v_dot2_f32_bf16 v202, v97, s84, v202
v_dot2_f32_bf16 v203, v97, s85, v203
v_dot2_f32_bf16 v204, v98, s84, v204
v_dot2_f32_bf16 v205, v98, s85, v205
v_dot2_f32_bf16 v206, v99, s84, v206
v_dot2_f32_bf16 v207, v99, s85, v207
v_dot2_f32_bf16 v208, v100, s84, v208
v_dot2_f32_bf16 v209, v100, s85, v209
v_dot2_f32_bf16 v210, v101, s84, v210
v_dot2_f32_bf16 v211, v101, s85, v211
v_dot2_f32_bf16 v212, v102, s84, v212
v_dot2_f32_bf16 v213, v102, s85, v213
v_dot2_f32_bf16 v214, v103, s84, v214
v_dot2_f32_bf16 v215, v103, s85, v215
La_ls3:
s_waitcnt vmcnt(6)
v_dot2_f32_bf16 v200, v104, s84, v200
v_dot2_f32_bf16 v201, v104, s85, v201
v_dot2_f32_bf16 v202, v105, s84, v202
v_dot2_f32_bf16 v203, v105, s85, v203
v_dot2_f32_bf16 v204, v106, s84, v204
v_dot2_f32_bf16 v205, v106, s85, v205
v_dot2_f32_bf16 v206, v107, s84, v206
v_dot2_f32_bf16 v207, v107, s85, v207
v_dot2_f32_bf16 v208, v108, s84, v208
v_dot2_f32_bf16 v209, v108, s85, v209
v_dot2_f32_bf16 v210, v109, s84, v210
v_dot2_f32_bf16 v211, v109, s85, v211
v_dot2_f32_bf16 v212, v110, s84, v212
v_dot2_f32_bf16 v213, v110, s85, v213
v_dot2_f32_bf16 v214, v111, s84, v214
v_dot2_f32_bf16 v215, v111, s85, v215
La_ls4:
s_waitcnt vmcnt(4)
v_dot2_f32_bf16 v200, v112, s84, v200
v_dot2_f32_bf16 v201, v112, s85, v201
v_dot2_f32_bf16 v202, v113, s84, v202
v_dot2_f32_bf16 v203, v113, s85, v203
v_dot2_f32_bf16 v204, v114, s84, v204
v_dot2_f32_bf16 v205, v114, s85, v205
v_dot2_f32_bf16 v206, v115, s84, v206
v_dot2_f32_bf16 v207, v115, s85, v207
v_dot2_f32_bf16 v208, v116, s84, v208
v_dot2_f32_bf16 v209, v116, s85, v209
v_dot2_f32_bf16 v210, v117, s84, v210
v_dot2_f32_bf16 v211, v117, s85, v211
v_dot2_f32_bf16 v212, v118, s84, v212
v_dot2_f32_bf16 v213, v118, s85, v213
v_dot2_f32_bf16 v214, v119, s84, v214
v_dot2_f32_bf16 v215, v119, s85, v215
La_ls5:
s_waitcnt vmcnt(2)
v_dot2_f32_bf16 v200, v120, s84, v200
v_dot2_f32_bf16 v201, v120, s85, v201
v_dot2_f32_bf16 v202, v121, s84, v202
v_dot2_f32_bf16 v203, v121, s85, v203
v_dot2_f32_bf16 v204, v122, s84, v204
v_dot2_f32_bf16 v205, v122, s85, v205
v_dot2_f32_bf16 v206, v123, s84, v206
v_dot2_f32_bf16 v207, v123, s85, v207
v_dot2_f32_bf16 v208, v124, s84, v208
v_dot2_f32_bf16 v209, v124, s85, v209
v_dot2_f32_bf16 v210, v125, s84, v210
v_dot2_f32_bf16 v211, v125, s85, v211
v_dot2_f32_bf16 v212, v126, s84, v212
v_dot2_f32_bf16 v213, v126, s85, v213
v_dot2_f32_bf16 v214, v127, s84, v214
v_dot2_f32_bf16 v215, v127, s85, v215
La_ls6:
s_waitcnt vmcnt(0)
v_dot2_f32_bf16 v200, v128, s84, v200
v_dot2_f32_bf16 v201, v128, s85, v201
v_dot2_f32_bf16 v202, v129, s84, v202
v_dot2_f32_bf16 v203, v129, s85, v203
v_dot2_f32_bf16 v204, v130, s84, v204
v_dot2_f32_bf16 v205, v130, s85, v205
v_dot2_f32_bf16 v206, v131, s84, v206
v_dot2_f32_bf16 v207, v131, s85, v207
v_dot2_f32_bf16 v208, v132, s84, v208
v_dot2_f32_bf16 v209, v132, s85, v209
v_dot2_f32_bf16 v210, v133, s84, v210
v_dot2_f32_bf16 v211, v133, s85, v211
v_dot2_f32_bf16 v212, v134, s84, v212
v_dot2_f32_bf16 v213, v134, s85, v213
v_dot2_f32_bf16 v214, v135, s84, v214
v_dot2_f32_bf16 v215, v135, s85, v215
La_done:
v_cvt_pk_bf16_f32 v80, v200, v201
v_cvt_pk_bf16_f32 v81, v202, v203
v_cvt_pk_bf16_f32 v82, v204, v205
v_cvt_pk_bf16_f32 v83, v206, v207
v_cvt_pk_bf16_f32 v84, v208, v209
v_cvt_pk_bf16_f32 v85, v210, v211
v_cvt_pk_bf16_f32 v86, v212, v213
v_cvt_pk_bf16_f32 v87, v214, v215
s_movk_i32 s96, 14336
v_permlane32_swap_b32 v80, v82
v_permlane32_swap_b32 v84, v86
v_permlane32_swap_b32 v81, v83
v_permlane32_swap_b32 v85, v87
v_permlane16_swap_b32 v80, v84
v_permlane16_swap_b32 v82, v86
v_permlane16_swap_b32 v81, v85
v_permlane16_swap_b32 v83, v87
buffer_store_dwordx4 v[80:83], v252, s[60:63], 0 offen sc0 sc1
buffer_store_dwordx4 v[84:87], v252, s[60:63], s96 offen sc0 sc1
La_fin:
s_endpgm
Lend:
s_endpgm
.section .rodata,"a"
.p2align 6
.amdhsa_kernel parallel_sum__sliding_local_dilated__mixer_channel_mlp__prompt_kernel
  .amdhsa_next_free_vgpr 512
  .amdhsa_next_free_sgpr 102
  .amdhsa_accum_offset 256
  .amdhsa_group_segment_fixed_size 0
  .amdhsa_kernarg_size 88
  .amdhsa_user_sgpr_count 2
  .amdhsa_user_sgpr_kernarg_segment_ptr 1
  .amdhsa_system_sgpr_workgroup_id_x 1
.end_amdhsa_kernel
```
